```python
import torch

def _softmax(x, axis=-1):
    return torch.softmax(x, dim=axis)
def _gelu(x):
    return torch.nn.functional.gelu(x, approximate="tanh")
def _silu(x):
    return torch.nn.functional.silu(x)
def _sigmoid(x):
    return torch.sigmoid(x)
def _layernorm(x, axis=-1, eps=1e-5):
    m = x.mean(dim=axis, keepdim=True)
    v = x.var(dim=axis, keepdim=True, unbiased=False)
    return (x - m) / torch.sqrt(v + eps)
def _scatter_add(tgt, idx, src, axis=0):
    return tgt.clone().index_add_(axis, idx, src)
def _segment_sum(src, seg, n):
    out = torch.zeros((n,) + src.shape[1:], dtype=src.dtype)
    return out.index_add_(0, seg, src)
def _pad(x, pw):
    flat = tuple(v for pair in reversed(pw) for v in pair)
    return torch.nn.functional.pad(x, flat)

kernel_name = 'sequential_preLN__softmax_full_mha__mixer_s_mlp__prompt'

def setup_inputs():

    _w = (lambda a: (lambda t: t.to(torch.bfloat16) if t.is_floating_point() else t)(torch.as_tensor(a)))
    def _A_setup():
        B, S, D = 1, 2048, 640
        return {
            "x": _w((lambda *s: torch.randn(*s, dtype=torch.bfloat16) * 0.05)(B, S, D)),
            "wqkv": _w((lambda *s: torch.randn(*s, dtype=torch.bfloat16) * 0.05)(D, 3 * D)),
            "wo": _w((lambda *s: torch.randn(*s, dtype=torch.bfloat16) * 0.05)(D, D)),
        }
    _A_in = _A_setup()

    def _B_setup():
        B, S, D, F = 1, 2048, 640, 1536
        return {
            "x":  _w((lambda *s: torch.randn(*s, dtype=torch.bfloat16) * 0.05)(B, S, D)),
            "w1": _w((lambda *s: torch.randn(*s, dtype=torch.bfloat16) * 3.2)(D, D) * (D ** -0.5)),
            "w2": _w((lambda *s: torch.randn(*s, dtype=torch.bfloat16) * 3.2)(D, D) * (D ** -0.5)),
            "w3": _w((lambda *s: torch.randn(*s, dtype=torch.bfloat16) * 3.2)(D, F) * (D ** -0.5)),
            "w4": _w((lambda *s: torch.randn(*s, dtype=torch.bfloat16) * 3.2)(F, D) * (F ** -0.5)),
        }
    _B_in = _B_setup()

    return {
        "A_x": _A_in["x"],
        "A_wqkv": _A_in["wqkv"],
        "A_wo": _A_in["wo"],
        "B_x": _B_in["x"],
        "B_w1": _B_in["w1"],
        "B_w2": _B_in["w2"],
        "B_w3": _B_in["w3"],
        "B_w4": _B_in["w4"],
    }

def reference(A_x, A_wqkv, A_wo, B_x, B_w1, B_w2, B_w3, B_w4):
    def _A_ref(x, wqkv, wo):
        B, S, D = x.shape
        H = 32; Dh = D // H
        qkv = (lambda x, *d: x.permute(*d))((x @ wqkv).reshape(B, S, 3, H, Dh), 2, 0, 3, 1, 4)
        q, k, v = qkv[0], qkv[1], qkv[2]
        scale = Dh ** -0.5
        scores = torch.einsum("bhqd,bhkd->bhqk", q, k) * scale
        p = _softmax(scores, axis=-1)
        o = torch.einsum("bhqk,bhkd->bhqd", p, v)
        return (lambda x, *d: x.permute(*d))(o, 0, 2, 1, 3).reshape(B, S, D) @ wo

    def _B_ref(x, w1, w2, w3, w4):
        B, S, D = x.shape
        h = _gelu(_layernorm(x, axis=-1) @ w1)
        c = D // 4
        g0 = _pad(h[:, :, 0*c:1*c], ((0, 0), (1, 0), (0, 0)))[:, :S, :]
        g1 = _pad(h[:, :, 1*c:2*c], ((0, 0), (0, 1), (0, 0)))[:, 1:, :]
        g2 = _pad(h[:, :, 2*c:3*c], ((0, 0), (2, 0), (0, 0)))[:, :S, :]
        g3 = _pad(h[:, :, 3*c:   ], ((0, 0), (0, 2), (0, 0)))[:, 2:, :]
        hs = torch.concatenate([g0, g1, g2, g3], axis=-1) @ w2
        x1 = x + hs
        h2 = _gelu(_layernorm(x1, axis=-1) @ w3) @ w4
        return x1 + h2

    x = A_x
    h = x + _A_ref(_layernorm(x, axis=-1), A_wqkv, A_wo)
    h2 = h + _B_ref(_layernorm(h, axis=-1), B_w1, B_w2, B_w3, B_w4)
    return h2
```

```asm
; @launch grid=(256,1,1) block=(512,1,1) lds=163840
.amdgcn_target "amdgcn-amd-amdhsa--gfx950"
.text
.globl sequential_preLN__softmax_full_mha__mixer_s_mlp__prompt_kernel
.p2align 8
.type sequential_preLN__softmax_full_mha__mixer_s_mlp__prompt_kernel,@function
sequential_preLN__softmax_full_mha__mixer_s_mlp__prompt_kernel:
    s_load_dwordx4 s[4:7], s[0:1], 0
    s_load_dwordx4 s[8:11], s[0:1], 72
    s_load_dwordx2 s[64:65], s[0:1], 16
    s_load_dwordx8 s[44:51], s[0:1], 32
    v_lshrrev_b32 v4, 6, v0
    v_and_b32 v1, 63, v0
    v_readfirstlane_b32 s26, v4
    v_lshrrev_b32 v2, 4, v1
    v_and_b32 v3, 15, v1
    s_cmp_ge_u32 s2, 240
    s_cbranch_scc1 L_p1_aux
    s_and_b32 s27, s2, 7
    s_lshr_b32 s28, s2, 3
    s_and_b32 s29, s27, 1
    s_mul_i32 s29, s29, 30
    s_add_u32 s28, s28, s29
    s_lshr_b32 s25, s28, 2
    s_and_b32 s28, s28, 3
    s_lshr_b32 s27, s27, 1
    s_lshl_b32 s27, s27, 2
    s_add_u32 s24, s27, s28
    s_mov_b32 s14, 2621440
    s_mov_b32 s15, 0x20000
    s_mov_b32 s18, 2457600
    s_mov_b32 s19, 0x20000
    s_and_b32 s40, s26, 3
    s_cmp_lt_u32 s26, 4
    s_cbranch_scc1 L_p1_cmp
    s_lshl_b32 s27, s24, 7
    s_lshl_b32 s28, s40, 5
    s_add_u32 s30, s27, s28
    v_lshrrev_b32 v4, 3, v1
    v_lshlrev_b32 v5, 1, v4
    v_lshrrev_b32 v6, 2, v4
    v_and_b32 v7, 3, v4
    v_lshl_add_u32 v6, v6, 3, v7
    s_cmp_ge_u32 s25, 10
    s_cselect_b64 vcc, -1, 0
    s_cselect_b32 s41, 4, 1
    v_cndmask_b32 v5, v5, v6, vcc
    v_add_u32 v5, s30, v5
    v_mul_u32_u24 v5, 1280, v5
    v_and_b32 v6, 7, v1
    v_xor_b32 v6, v6, v2
    v_lshl_add_u32 v12, v6, 4, v5
    v_xor_b32 v13, 64, v12
    v_add_u32 v13, 20480, v13
    s_mul_i32 s41, s41, 1280
    v_add_u32 v14, s41, v12
    v_add_u32 v15, s41, v13
    s_and_b32 s27, s40, 1
    s_lshl_b32 s27, s27, 3
    v_lshlrev_b32 v4, 1, v2
    v_or_b32 v4, s27, v4
    v_xor_b32 v4, v4, v3
    v_lshlrev_b32 v4, 4, v4
    s_lshl_b32 s27, s40, 3
    v_add_u32 v5, s27, v2
    v_mul_u32_u24 v5, 3840, v5
    s_lshl_b32 s27, s25, 8
    v_add3_u32 v16, v4, v5, s27
    s_lshl_b32 s31, s40, 11
    s_lshl_b32 s39, s40, 12
    s_waitcnt lgkmcnt(0)
    s_mov_b32 s12, s4
    s_mov_b32 s13, s5
    s_mov_b32 s16, s6
    s_mov_b32 s17, s7
    s_add_u32 m0, s39, 147456
    s_mov_b32 s32, 0
    buffer_load_dwordx4 v12, s[12:15], s32 offen lds
    s_add_u32 m0, s31, 131072
    s_mov_b32 s32, 0
    buffer_load_dwordx4 v16, s[16:19], s32 offen lds
    s_add_u32 m0, s39, 148480
    s_mov_b32 s32, 0
    buffer_load_dwordx4 v13, s[12:15], s32 offen lds
    s_add_u32 m0, s31, 132096
    s_mov_b32 s32, 15360
    buffer_load_dwordx4 v16, s[16:19], s32 offen lds
    s_add_u32 m0, s39, 149504
    s_mov_b32 s32, 0
    buffer_load_dwordx4 v14, s[12:15], s32 offen lds
    s_add_u32 m0, s31, 139264
    s_mov_b32 s32, 122880
    buffer_load_dwordx4 v16, s[16:19], s32 offen lds
    s_add_u32 m0, s39, 150528
    s_mov_b32 s32, 0
    buffer_load_dwordx4 v15, s[12:15], s32 offen lds
    s_add_u32 m0, s31, 140288
    s_mov_b32 s32, 138240
    buffer_load_dwordx4 v16, s[16:19], s32 offen lds
    s_and_b32 s27, s24, 3
    s_lshl_b32 s27, s27, 2
    s_add_u32 s27, s27, s40
    s_lshl_b32 s27, s27, 2
    v_add_u32 v4, s27, v2
    v_mul_u32_u24 v4, 3840, v4
    s_lshl_b32 s27, s25, 8
    v_lshl_add_u32 v5, v3, 4, s27
    v_add_u32 v17, v4, v5
    s_and_b32 s27, s25, 7
    s_lshl_b32 s27, s27, 2
    s_add_u32 s27, s27, s40
    s_lshl_b32 s27, s27, 2
    s_lshl_b32 s28, s24, 7
    s_add_u32 s27, s27, s28
    v_add_u32 v4, s27, v2
    v_mul_u32_u24 v4, 1280, v4
    v_lshl_add_u32 v18, v3, 4, v4
    s_add_u32 m0, s39, 114688
    s_mov_b32 s32, 128
    buffer_load_dwordx4 v12, s[12:15], s32 offen lds
    s_add_u32 m0, s31, 98304
    s_mov_b32 s32, 245760
    buffer_load_dwordx4 v16, s[16:19], s32 offen lds
    s_add_u32 m0, s39, 115712
    s_mov_b32 s32, 128
    buffer_load_dwordx4 v13, s[12:15], s32 offen lds
    s_add_u32 m0, s31, 99328
    s_mov_b32 s32, 261120
    buffer_load_dwordx4 v16, s[16:19], s32 offen lds
    s_add_u32 m0, s39, 116736
    s_mov_b32 s32, 128
    buffer_load_dwordx4 v14, s[12:15], s32 offen lds
    s_add_u32 m0, s31, 106496
    s_mov_b32 s32, 368640
    buffer_load_dwordx4 v16, s[16:19], s32 offen lds
    s_add_u32 m0, s39, 117760
    s_mov_b32 s32, 128
    buffer_load_dwordx4 v15, s[12:15], s32 offen lds
    s_add_u32 m0, s31, 107520
    s_mov_b32 s32, 384000
    buffer_load_dwordx4 v16, s[16:19], s32 offen lds
    s_waitcnt vmcnt(8)
    s_barrier
    s_add_u32 m0, s39, 81920
    s_mov_b32 s32, 256
    buffer_load_dwordx4 v12, s[12:15], s32 offen lds
    s_add_u32 m0, s31, 65536
    s_mov_b32 s32, 491520
    buffer_load_dwordx4 v16, s[16:19], s32 offen lds
    s_add_u32 m0, s39, 82944
    s_mov_b32 s32, 256
    buffer_load_dwordx4 v13, s[12:15], s32 offen lds
    s_add_u32 m0, s31, 66560
    s_mov_b32 s32, 506880
    buffer_load_dwordx4 v16, s[16:19], s32 offen lds
    s_add_u32 m0, s39, 83968
    s_mov_b32 s32, 256
    buffer_load_dwordx4 v14, s[12:15], s32 offen lds
    s_add_u32 m0, s31, 73728
    s_mov_b32 s32, 614400
    buffer_load_dwordx4 v16, s[16:19], s32 offen lds
    s_add_u32 m0, s39, 84992
    s_mov_b32 s32, 256
    buffer_load_dwordx4 v15, s[12:15], s32 offen lds
    s_add_u32 m0, s31, 74752
    s_mov_b32 s32, 629760
    buffer_load_dwordx4 v16, s[16:19], s32 offen lds
    s_add_u32 m0, s39, 16384
    s_mov_b32 s32, 384
    buffer_load_dwordx4 v12, s[12:15], s32 offen lds
    s_add_u32 m0, s31, 0
    s_mov_b32 s32, 737280
    buffer_load_dwordx4 v16, s[16:19], s32 offen lds
    s_add_u32 m0, s39, 17408
    s_mov_b32 s32, 384
    buffer_load_dwordx4 v13, s[12:15], s32 offen lds
    s_add_u32 m0, s31, 1024
    s_mov_b32 s32, 752640
    buffer_load_dwordx4 v16, s[16:19], s32 offen lds
    s_add_u32 m0, s39, 18432
    s_mov_b32 s32, 384
    buffer_load_dwordx4 v14, s[12:15], s32 offen lds
    s_add_u32 m0, s31, 8192
    s_mov_b32 s32, 860160
    buffer_load_dwordx4 v16, s[16:19], s32 offen lds
    s_add_u32 m0, s39, 19456
    s_mov_b32 s32, 384
    buffer_load_dwordx4 v15, s[12:15], s32 offen lds
    s_add_u32 m0, s31, 9216
    s_mov_b32 s32, 875520
    buffer_load_dwordx4 v16, s[16:19], s32 offen lds
    s_waitcnt vmcnt(16)
    s_barrier
    s_add_u32 m0, s39, 49152
    s_mov_b32 s32, 512
    buffer_load_dwordx4 v12, s[12:15], s32 offen lds
    s_add_u32 m0, s31, 32768
    s_mov_b32 s32, 983040
    buffer_load_dwordx4 v16, s[16:19], s32 offen lds
    s_add_u32 m0, s39, 50176
    s_mov_b32 s32, 512
    buffer_load_dwordx4 v13, s[12:15], s32 offen lds
    s_add_u32 m0, s31, 33792
    s_mov_b32 s32, 998400
    buffer_load_dwordx4 v16, s[16:19], s32 offen lds
    s_add_u32 m0, s39, 51200
    s_mov_b32 s32, 512
    buffer_load_dwordx4 v14, s[12:15], s32 offen lds
    s_add_u32 m0, s31, 40960
    s_mov_b32 s32, 1105920
    buffer_load_dwordx4 v16, s[16:19], s32 offen lds
    s_add_u32 m0, s39, 52224
    s_mov_b32 s32, 512
    buffer_load_dwordx4 v15, s[12:15], s32 offen lds
    s_add_u32 m0, s31, 41984
    s_mov_b32 s32, 1121280
    buffer_load_dwordx4 v16, s[16:19], s32 offen lds
    s_waitcnt vmcnt(16)
    s_barrier
    s_add_u32 m0, s39, 147456
    s_mov_b32 s32, 640
    buffer_load_dwordx4 v12, s[12:15], s32 offen lds
    s_add_u32 m0, s31, 131072
    s_mov_b32 s32, 1228800
    buffer_load_dwordx4 v16, s[16:19], s32 offen lds
    s_add_u32 m0, s39, 148480
    s_mov_b32 s32, 640
    buffer_load_dwordx4 v13, s[12:15], s32 offen lds
    s_add_u32 m0, s31, 132096
    s_mov_b32 s32, 1244160
    buffer_load_dwordx4 v16, s[16:19], s32 offen lds
    s_add_u32 m0, s39, 149504
    s_mov_b32 s32, 640
    buffer_load_dwordx4 v14, s[12:15], s32 offen lds
    s_add_u32 m0, s31, 139264
    s_mov_b32 s32, 1351680
    buffer_load_dwordx4 v16, s[16:19], s32 offen lds
    s_add_u32 m0, s39, 150528
    s_mov_b32 s32, 640
    buffer_load_dwordx4 v15, s[12:15], s32 offen lds
    s_add_u32 m0, s31, 140288
    s_mov_b32 s32, 1367040
    buffer_load_dwordx4 v16, s[16:19], s32 offen lds
    s_waitcnt vmcnt(16)
    s_barrier
    s_add_u32 m0, s39, 114688
    s_mov_b32 s32, 768
    buffer_load_dwordx4 v12, s[12:15], s32 offen lds
    s_add_u32 m0, s31, 98304
    s_mov_b32 s32, 1474560
    buffer_load_dwordx4 v16, s[16:19], s32 offen lds
    s_add_u32 m0, s39, 115712
    s_mov_b32 s32, 768
    buffer_load_dwordx4 v13, s[12:15], s32 offen lds
    s_add_u32 m0, s31, 99328
    s_mov_b32 s32, 1489920
    buffer_load_dwordx4 v16, s[16:19], s32 offen lds
    s_add_u32 m0, s39, 116736
    s_mov_b32 s32, 768
    buffer_load_dwordx4 v14, s[12:15], s32 offen lds
    s_add_u32 m0, s31, 106496
    s_mov_b32 s32, 1597440
    buffer_load_dwordx4 v16, s[16:19], s32 offen lds
    s_add_u32 m0, s39, 117760
    s_mov_b32 s32, 768
    buffer_load_dwordx4 v15, s[12:15], s32 offen lds
    s_add_u32 m0, s31, 107520
    s_mov_b32 s32, 1612800
    buffer_load_dwordx4 v16, s[16:19], s32 offen lds
    s_waitcnt vmcnt(16)
    s_barrier
    s_add_u32 m0, s39, 81920
    s_mov_b32 s32, 896
    buffer_load_dwordx4 v12, s[12:15], s32 offen lds
    s_add_u32 m0, s31, 65536
    s_mov_b32 s32, 1720320
    buffer_load_dwordx4 v16, s[16:19], s32 offen lds
    s_add_u32 m0, s39, 82944
    s_mov_b32 s32, 896
    buffer_load_dwordx4 v13, s[12:15], s32 offen lds
    s_add_u32 m0, s31, 66560
    s_mov_b32 s32, 1735680
    buffer_load_dwordx4 v16, s[16:19], s32 offen lds
    s_add_u32 m0, s39, 83968
    s_mov_b32 s32, 896
    buffer_load_dwordx4 v14, s[12:15], s32 offen lds
    s_add_u32 m0, s31, 73728
    s_mov_b32 s32, 1843200
    buffer_load_dwordx4 v16, s[16:19], s32 offen lds
    s_add_u32 m0, s39, 84992
    s_mov_b32 s32, 896
    buffer_load_dwordx4 v15, s[12:15], s32 offen lds
    s_add_u32 m0, s31, 74752
    s_mov_b32 s32, 1858560
    buffer_load_dwordx4 v16, s[16:19], s32 offen lds
    s_waitcnt vmcnt(16)
    s_barrier
    s_add_u32 m0, s39, 16384
    s_mov_b32 s32, 1024
    buffer_load_dwordx4 v12, s[12:15], s32 offen lds
    s_add_u32 m0, s31, 0
    s_mov_b32 s32, 1966080
    buffer_load_dwordx4 v16, s[16:19], s32 offen lds
    s_add_u32 m0, s39, 17408
    s_mov_b32 s32, 1024
    buffer_load_dwordx4 v13, s[12:15], s32 offen lds
    s_add_u32 m0, s31, 1024
    s_mov_b32 s32, 1981440
    buffer_load_dwordx4 v16, s[16:19], s32 offen lds
    s_add_u32 m0, s39, 18432
    s_mov_b32 s32, 1024
    buffer_load_dwordx4 v14, s[12:15], s32 offen lds
    s_add_u32 m0, s31, 8192
    s_mov_b32 s32, 2088960
    buffer_load_dwordx4 v16, s[16:19], s32 offen lds
    s_add_u32 m0, s39, 19456
    s_mov_b32 s32, 1024
    buffer_load_dwordx4 v15, s[12:15], s32 offen lds
    s_add_u32 m0, s31, 9216
    s_mov_b32 s32, 2104320
    buffer_load_dwordx4 v16, s[16:19], s32 offen lds
    s_waitcnt vmcnt(16)
    s_barrier
    s_add_u32 m0, s39, 49152
    s_mov_b32 s32, 1152
    buffer_load_dwordx4 v12, s[12:15], s32 offen lds
    s_add_u32 m0, s31, 32768
    s_mov_b32 s32, 2211840
    buffer_load_dwordx4 v16, s[16:19], s32 offen lds
    s_add_u32 m0, s39, 50176
    s_mov_b32 s32, 1152
    buffer_load_dwordx4 v13, s[12:15], s32 offen lds
    s_add_u32 m0, s31, 33792
    s_mov_b32 s32, 2227200
    buffer_load_dwordx4 v16, s[16:19], s32 offen lds
    s_add_u32 m0, s39, 51200
    s_mov_b32 s32, 1152
    buffer_load_dwordx4 v14, s[12:15], s32 offen lds
    s_add_u32 m0, s31, 40960
    s_mov_b32 s32, 2334720
    buffer_load_dwordx4 v16, s[16:19], s32 offen lds
    s_add_u32 m0, s39, 52224
    s_mov_b32 s32, 1152
    buffer_load_dwordx4 v15, s[12:15], s32 offen lds
    s_add_u32 m0, s31, 41984
    s_mov_b32 s32, 2350080
    buffer_load_dwordx4 v16, s[16:19], s32 offen lds
    s_mov_b32 s60, s8
    s_mov_b32 s61, s9
    s_mov_b32 s62, 256
    s_mov_b32 s63, 0x20000
    v_lshlrev_b32 v6, 2, v3
    buffer_load_dword v7, v6, s[60:63], 0 offen offset:64 sc1
    s_waitcnt vmcnt(17)
    s_barrier
    s_waitcnt vmcnt(1)
    s_barrier
    v_lshlrev_b32 v4, 2, v1
    v_add_u32 v4, 162304, v4
    v_mov_b32 v5, 0
    ds_write_b32 v4, v5
    s_mov_b32 s43, 400000
    s_branch L_p1_z1l
L_p1_z0l:
    buffer_load_dword v7, v6, s[60:63], 0 offen offset:64 sc1
L_p1_z1l:
    s_sub_u32 s43, s43, 1
    s_waitcnt vmcnt(0) lgkmcnt(0)
    v_cmp_eq_u32 vcc, 0, v7
    s_cmp_eq_u32 s43, 0
    s_cbranch_scc1 L_p1_z2l
    s_cbranch_vccnz L_p1_z0l
L_p1_z2l:
    s_barrier
    s_branch L_m_entry
L_p1_cmp:
    s_cmp_ge_u32 s2, 32
    s_cbranch_scc1 L_p1_nocpf
    s_getpc_b64 s[52:53]
L_p1_pc0:
    s_mov_b32 s54, L_m_entry-L_p1_pc0
    s_mov_b32 s55, 0x20000
    s_lshr_b32 s27, s2, 3
    s_lshl_b32 s27, s27, 2
    s_add_u32 s27, s27, s40
    s_lshl_b32 s27, s27, 10
    v_lshlrev_b32 v4, 4, v1
    buffer_load_dwordx4 v[204:207], v4, s[52:55], s27 offen
    s_add_u32 s27, s27, 16384
    buffer_load_dwordx4 v[208:211], v4, s[52:55], s27 offen
L_p1_nocpf:
    s_waitcnt lgkmcnt(0)
    s_mov_b32 s12, s4
    s_mov_b32 s13, s5
    s_add_u32 s56, s10, 33050624
    s_addc_u32 s57, s11, 0
    s_mov_b32 s58, 20480
    s_mov_b32 s59, 0x20000
    s_mov_b32 s60, s8
    s_mov_b32 s61, s9
    s_mov_b32 s62, 256
    s_mov_b32 s63, 0x20000
    s_lshl_b32 s66, s24, 4
    s_add_u32 s66, s66, s25
    s_lshl_b32 s66, s66, 2
    s_add_u32 s66, s66, s40
    s_mul_i32 s27, s66, 2560
    v_lshrrev_b32 v4, 5, v1
    v_lshlrev_b32 v229, 2, v4
    v_mul_u32_u24 v4, 1280, v4
    v_and_b32 v5, 31, v1
    v_lshl_add_u32 v4, v5, 4, v4
    v_and_b32 v5, 16, v1
    v_lshl_add_u32 v5, v5, 26, v4
    buffer_load_dwordx4 v[212:215], v4, s[12:15], s27 offen
    buffer_load_dwordx4 v[216:219], v4, s[12:15], s27 offen offset:512
    buffer_load_dwordx4 v[220:223], v5, s[12:15], s27 offen offset:1024
    s_mov_b32 s16, s6
    s_mov_b32 s17, s7
    s_lshl_b32 s27, s2, 2
    s_add_u32 s27, s27, s40
    s_lshl_b32 s27, s27, 10
    s_add_u32 s27, s27, 245760
    v_lshlrev_b32 v4, 4, v1
    buffer_load_dwordx4 v[236:239], v4, s[16:19], s27 offen
    s_add_u32 s27, s27, 983040
    buffer_load_dwordx4 v[240:243], v4, s[16:19], s27 offen
    s_add_u32 s27, s27, 983040
    buffer_load_dwordx4 v[244:247], v4, s[16:19], s27 offen
    s_add_u32 s27, s27, 983040
    v_mov_b32 v12, 0x3f803f80
    v_mov_b32 v13, 0x3f803f80
    v_mov_b32 v14, 0x3f803f80
    v_mov_b32 v15, 0x3f803f80
    v_lshrrev_b32 v6, 2, v3
    v_and_b32 v7, 1, v2
    v_lshl_or_b32 v7, v7, 2, v6
    s_lshl_b32 s41, s40, 1
    v_xor_b32 v7, s41, v7
    v_lshlrev_b32 v7, 5, v7
    v_lshl_add_u32 v6, v2, 3, v6
    v_lshl_add_u32 v7, v6, 8, v7
    v_and_b32 v6, 3, v3
    v_lshl_add_u32 v16, v6, 3, v7
    v_xor_b32 v17, 32, v16
    v_xor_b32 v18, 64, v16
    v_xor_b32 v19, 96, v16
    v_xor_b32 v20, 128, v16
    v_xor_b32 v21, 160, v16
    v_xor_b32 v22, 192, v16
    v_xor_b32 v23, 224, v16
    v_add_u32 v24, 65536, v16
    v_add_u32 v25, 65536, v17
    v_add_u32 v26, 65536, v18
    v_add_u32 v27, 65536, v19
    v_add_u32 v28, 65536, v20
    v_add_u32 v29, 65536, v21
    v_add_u32 v30, 65536, v22
    v_add_u32 v31, 65536, v23
    v_add_u32 v32, 131072, v16
    v_add_u32 v33, 131072, v17
    v_add_u32 v34, 131072, v18
    v_add_u32 v35, 131072, v19
    v_add_u32 v36, 131072, v20
    v_add_u32 v37, 131072, v21
    v_add_u32 v38, 131072, v22
    v_add_u32 v39, 131072, v23
    s_lshl_b32 s39, s40, 12
    v_lshrrev_b32 v6, 1, v3
    v_xor_b32 v6, v6, v2
    v_lshlrev_b32 v6, 4, v6
    v_lshl_add_u32 v6, v3, 7, v6
    v_add_u32 v40, s39, v6
    v_xor_b32 v41, 64, v40
    v_add_u32 v42, 2048, v40
    v_add_u32 v43, 2048, v41
    v_add_u32 v44, 65536, v40
    v_add_u32 v45, 65536, v41
    v_add_u32 v46, 67584, v40
    v_add_u32 v47, 67584, v41
    v_add_u32 v48, 131072, v40
    v_add_u32 v49, 131072, v41
    v_add_u32 v50, 133120, v40
    v_add_u32 v51, 133120, v41
    s_waitcnt lgkmcnt(0)
    s_mov_b32 s20, s10
    s_mov_b32 s21, s11
    s_mov_b32 s22, 7864320
    s_mov_b32 s23, 0x20000
    s_mul_i32 s33, s25, 52
    s_lshr_b32 s33, s33, 8
    s_mul_i32 s34, s33, 5
    s_sub_u32 s34, s25, s34
    s_cmp_eq_u32 s33, 2
    s_cbranch_scc1 L_p1_vpath
    s_mov_b32 s37, 245760
    s_mov_b32 s36, 5120
    s_mov_b32 s38, 0
    s_cmp_eq_u32 s33, 1
    s_cselect_b32 s36, 10240, s36
    s_cselect_b32 s38, 81920, s38
    s_mul_i32 s35, s24, s36
    s_add_u32 s35, s35, s38
    s_lshl_b32 s27, s40, 8
    s_add_u32 s35, s35, s27
    v_lshl_add_u32 v8, v3, 4, s35
    s_lshl_b32 s27, s34, 5
    s_xor_b32 s29, s41, 0
    s_lshl_b32 s29, s29, 2
    s_add_u32 s29, s29, s27
    v_add_u32 v6, s29, v2
    v_mul_u32_u24 v7, 205, v6
    v_lshrrev_b32 v7, 10, v7
    v_mul_u32_u24 v9, 5, v7
    v_sub_u32 v6, v6, v9
    v_mul_lo_u32 v7, v7, s37
    v_lshl_add_u32 v6, v6, 10, v8
    v_add_u32 v52, v6, v7
    s_xor_b32 s29, s41, 1
    s_lshl_b32 s29, s29, 2
    s_add_u32 s29, s29, s27
    v_add_u32 v6, s29, v2
    v_mul_u32_u24 v7, 205, v6
    v_lshrrev_b32 v7, 10, v7
    v_mul_u32_u24 v9, 5, v7
    v_sub_u32 v6, v6, v9
    v_mul_lo_u32 v7, v7, s37
    v_lshl_add_u32 v6, v6, 10, v8
    v_add_u32 v53, v6, v7
    s_xor_b32 s29, s41, 2
    s_lshl_b32 s29, s29, 2
    s_add_u32 s29, s29, s27
    v_add_u32 v6, s29, v2
    v_mul_u32_u24 v7, 205, v6
    v_lshrrev_b32 v7, 10, v7
    v_mul_u32_u24 v9, 5, v7
    v_sub_u32 v6, v6, v9
    v_mul_lo_u32 v7, v7, s37
    v_lshl_add_u32 v6, v6, 10, v8
    v_add_u32 v54, v6, v7
    s_xor_b32 s29, s41, 3
    s_lshl_b32 s29, s29, 2
    s_add_u32 s29, s29, s27
    v_add_u32 v6, s29, v2
    v_mul_u32_u24 v7, 205, v6
    v_lshrrev_b32 v7, 10, v7
    v_mul_u32_u24 v9, 5, v7
    v_sub_u32 v6, v6, v9
    v_mul_lo_u32 v7, v7, s37
    v_lshl_add_u32 v6, v6, 10, v8
    v_add_u32 v55, v6, v7
    s_xor_b32 s29, s41, 4
    s_lshl_b32 s29, s29, 2
    s_add_u32 s29, s29, s27
    v_add_u32 v6, s29, v2
    v_mul_u32_u24 v7, 205, v6
    v_lshrrev_b32 v7, 10, v7
    v_mul_u32_u24 v9, 5, v7
    v_sub_u32 v6, v6, v9
    v_mul_lo_u32 v7, v7, s37
    v_lshl_add_u32 v6, v6, 10, v8
    v_add_u32 v56, v6, v7
    s_xor_b32 s29, s41, 5
    s_lshl_b32 s29, s29, 2
    s_add_u32 s29, s29, s27
    v_add_u32 v6, s29, v2
    v_mul_u32_u24 v7, 205, v6
    v_lshrrev_b32 v7, 10, v7
    v_mul_u32_u24 v9, 5, v7
    v_sub_u32 v6, v6, v9
    v_mul_lo_u32 v7, v7, s37
    v_lshl_add_u32 v6, v6, 10, v8
    v_add_u32 v57, v6, v7
    s_xor_b32 s29, s41, 6
    s_lshl_b32 s29, s29, 2
    s_add_u32 s29, s29, s27
    v_add_u32 v6, s29, v2
    v_mul_u32_u24 v7, 205, v6
    v_lshrrev_b32 v7, 10, v7
    v_mul_u32_u24 v9, 5, v7
    v_sub_u32 v6, v6, v9
    v_mul_lo_u32 v7, v7, s37
    v_lshl_add_u32 v6, v6, 10, v8
    v_add_u32 v58, v6, v7
    s_xor_b32 s29, s41, 7
    s_lshl_b32 s29, s29, 2
    s_add_u32 s29, s29, s27
    v_add_u32 v6, s29, v2
    v_mul_u32_u24 v7, 205, v6
    v_lshrrev_b32 v7, 10, v7
    v_mul_u32_u24 v9, 5, v7
    v_sub_u32 v6, v6, v9
    v_mul_lo_u32 v7, v7, s37
    v_lshl_add_u32 v6, v6, 10, v8
    v_add_u32 v59, v6, v7
    s_mov_b32 s28, 0x3ea52b5c
    s_cmp_eq_u32 s33, 0
    s_cselect_b32 s28, s28, 1.0
    s_barrier
    ds_read_b128 v[164:167], v48 offset:16384
    ds_read_b128 v[168:171], v50 offset:16384
    ds_read_b64_tr_b16 v[132:133], v32 offset:0
    ds_read_b64_tr_b16 v[134:135], v32 offset:1024
    ds_read_b64_tr_b16 v[136:137], v33 offset:0
    ds_read_b64_tr_b16 v[138:139], v33 offset:1024
    ds_read_b64_tr_b16 v[140:141], v34 offset:0
    ds_read_b64_tr_b16 v[142:143], v34 offset:1024
    ds_read_b64_tr_b16 v[144:145], v35 offset:0
    ds_read_b64_tr_b16 v[146:147], v35 offset:1024
    ds_read_b64_tr_b16 v[148:149], v36 offset:0
    ds_read_b64_tr_b16 v[150:151], v36 offset:1024
    ds_read_b64_tr_b16 v[152:153], v37 offset:0
    ds_read_b64_tr_b16 v[154:155], v37 offset:1024
    s_waitcnt lgkmcnt(8)
    v_mfma_f32_16x16x32_bf16 v[68:71], v[132:135], v[164:167], 0
    ds_read_b64_tr_b16 v[156:157], v38 offset:0
    v_mfma_f32_16x16x32_bf16 v[72:75], v[132:135], v[168:171], 0
    ds_read_b64_tr_b16 v[158:159], v38 offset:1024
    v_mfma_f32_16x16x32_bf16 v[76:79], v[136:139], v[164:167], 0
    ds_read_b64_tr_b16 v[160:161], v39 offset:0
    v_mfma_f32_16x16x32_bf16 v[80:83], v[136:139], v[168:171], 0
    ds_read_b64_tr_b16 v[162:163], v39 offset:1024
    s_waitcnt lgkmcnt(8)
    v_mfma_f32_16x16x32_bf16 v[84:87], v[140:143], v[164:167], 0
    ds_read_b128 v[172:175], v49 offset:16384
    v_mfma_f32_16x16x32_bf16 v[88:91], v[140:143], v[168:171], 0
    ds_read_b128 v[176:179], v51 offset:16384
    v_mfma_f32_16x16x32_bf16 v[92:95], v[144:147], v[164:167], 0
    ds_read_b64_tr_b16 v[132:133], v32 offset:8192
    v_mfma_f32_16x16x32_bf16 v[96:99], v[144:147], v[168:171], 0
    ds_read_b64_tr_b16 v[134:135], v32 offset:9216
    v_mfma_f32_16x16x32_bf16 v[60:63], v[144:147], v[12:15], 0
    ds_read_b64_tr_b16 v[136:137], v33 offset:8192
    s_waitcnt lgkmcnt(9)
    v_mfma_f32_16x16x32_bf16 v[100:103], v[148:151], v[164:167], 0
    ds_read_b64_tr_b16 v[138:139], v33 offset:9216
    v_mfma_f32_16x16x32_bf16 v[104:107], v[148:151], v[168:171], 0
    ds_read_b64_tr_b16 v[140:141], v34 offset:8192
    v_mfma_f32_16x16x32_bf16 v[64:67], v[148:151], v[12:15], 0
    ds_read_b64_tr_b16 v[142:143], v34 offset:9216
    v_mfma_f32_16x16x32_bf16 v[108:111], v[152:155], v[164:167], 0
    ds_read_b64_tr_b16 v[144:145], v35 offset:8192
    v_mfma_f32_16x16x32_bf16 v[112:115], v[152:155], v[168:171], 0
    ds_read_b64_tr_b16 v[146:147], v35 offset:9216
    s_waitcnt lgkmcnt(10)
    v_mfma_f32_16x16x32_bf16 v[116:119], v[156:159], v[164:167], 0
    ds_read_b64_tr_b16 v[148:149], v36 offset:8192
    v_mfma_f32_16x16x32_bf16 v[120:123], v[156:159], v[168:171], 0
    ds_read_b64_tr_b16 v[150:151], v36 offset:9216
    v_mfma_f32_16x16x32_bf16 v[124:127], v[160:163], v[164:167], 0
    ds_read_b64_tr_b16 v[152:153], v37 offset:8192
    v_mfma_f32_16x16x32_bf16 v[128:131], v[160:163], v[168:171], 0
    ds_read_b64_tr_b16 v[154:155], v37 offset:9216
    s_waitcnt lgkmcnt(8)
    v_mfma_f32_16x16x32_bf16 v[68:71], v[132:135], v[172:175], v[68:71]
    ds_read_b64_tr_b16 v[156:157], v38 offset:8192
    v_mfma_f32_16x16x32_bf16 v[72:75], v[132:135], v[176:179], v[72:75]
    ds_read_b64_tr_b16 v[158:159], v38 offset:9216
    v_mov_b32 v228, 0x3f803f80
    s_waitcnt vmcnt(3)
    v_dot2_f32_bf16 v224, v212, v228, 0
    v_dot2_f32_bf16 v225, v212, v212, 0
    v_dot2_f32_bf16 v224, v213, v228, v224
    v_dot2_f32_bf16 v225, v213, v213, v225
    v_dot2_f32_bf16 v224, v214, v228, v224
    v_dot2_f32_bf16 v225, v214, v214, v225
    v_dot2_f32_bf16 v224, v215, v228, v224
    v_dot2_f32_bf16 v225, v215, v215, v225
    v_dot2_f32_bf16 v224, v216, v228, v224
    v_dot2_f32_bf16 v225, v216, v216, v225
    v_dot2_f32_bf16 v224, v217, v228, v224
    v_dot2_f32_bf16 v225, v217, v217, v225
    v_dot2_f32_bf16 v224, v218, v228, v224
    v_dot2_f32_bf16 v225, v218, v218, v225
    v_dot2_f32_bf16 v224, v219, v228, v224
    v_dot2_f32_bf16 v225, v219, v219, v225
    v_dot2_f32_bf16 v224, v220, v228, v224
    v_dot2_f32_bf16 v225, v220, v220, v225
    v_dot2_f32_bf16 v224, v221, v228, v224
    v_dot2_f32_bf16 v225, v221, v221, v225
    v_dot2_f32_bf16 v224, v222, v228, v224
    v_dot2_f32_bf16 v225, v222, v222, v225
    v_dot2_f32_bf16 v224, v223, v228, v224
    v_dot2_f32_bf16 v225, v223, v223, v225
    s_lshl_b32 s27, s24, 2
    buffer_load_dword v228, off, s[60:63], s27 sc1
    s_nop 0
    v_add_f32_dpp v224, v224, v224 row_ror:8 row_mask:0xf bank_mask:0xf
    v_add_f32_dpp v225, v225, v225 row_ror:8 row_mask:0xf bank_mask:0xf
    s_nop 0
    v_add_f32_dpp v224, v224, v224 row_ror:4 row_mask:0xf bank_mask:0xf
    v_add_f32_dpp v225, v225, v225 row_ror:4 row_mask:0xf bank_mask:0xf
    s_nop 0
    v_add_f32_dpp v224, v224, v224 row_ror:2 row_mask:0xf bank_mask:0xf
    v_add_f32_dpp v225, v225, v225 row_ror:2 row_mask:0xf bank_mask:0xf
    s_nop 0
    v_add_f32_dpp v224, v224, v224 row_ror:1 row_mask:0xf bank_mask:0xf
    v_add_f32_dpp v225, v225, v225 row_ror:1 row_mask:0xf bank_mask:0xf
    s_nop 0
    v_mov_b32 v226, v224
    v_mov_b32 v227, v225
    s_nop 1
    v_permlane16_swap_b32 v224, v226
    v_permlane16_swap_b32 v225, v227
    v_add_f32 v224, v224, v226
    v_add_f32 v225, v225, v227
    v_mul_f32 v224, 0xbacccccd, v224
    v_mul_f32 v225, 0x3acccccd, v225
    v_fma_f32 v225, -v224, v224, v225
    v_max_f32 v225, 0, v225
    v_add_f32 v225, 0x3727c5ac, v225
    v_rsq_f32 v225, v225
    s_lshl_b32 s27, s66, 3
    s_add_u32 s67, s27, 8192
    s_mov_b32 exec_lo, 1
    s_mov_b32 exec_hi, 1
    buffer_store_dword v224, v229, s[56:59], s27 offen sc1
    buffer_store_dword v225, v229, s[56:59], s67 offen sc1
    s_mov_b64 exec, -1
    v_mfma_f32_16x16x32_bf16 v[76:79], v[136:139], v[172:175], v[76:79]
    ds_read_b64_tr_b16 v[160:161], v39 offset:8192
    v_mfma_f32_16x16x32_bf16 v[80:83], v[136:139], v[176:179], v[80:83]
    ds_read_b64_tr_b16 v[162:163], v39 offset:9216
    s_waitcnt lgkmcnt(8)
    v_mfma_f32_16x16x32_bf16 v[84:87], v[140:143], v[172:175], v[84:87]
    s_barrier
    ds_read_b128 v[164:167], v44 offset:49152
    v_mfma_f32_16x16x32_bf16 v[88:91], v[140:143], v[176:179], v[88:91]
    ds_read_b128 v[168:171], v46 offset:49152
    v_mfma_f32_16x16x32_bf16 v[92:95], v[144:147], v[172:175], v[92:95]
    ds_read_b64_tr_b16 v[132:133], v24 offset:32768
    v_mfma_f32_16x16x32_bf16 v[96:99], v[144:147], v[176:179], v[96:99]
    ds_read_b64_tr_b16 v[134:135], v24 offset:33792
    v_mfma_f32_16x16x32_bf16 v[60:63], v[144:147], v[12:15], v[60:63]
    ds_read_b64_tr_b16 v[136:137], v25 offset:32768
    s_waitcnt lgkmcnt(9)
    v_mfma_f32_16x16x32_bf16 v[100:103], v[148:151], v[172:175], v[100:103]
    ds_read_b64_tr_b16 v[138:139], v25 offset:33792
    v_mfma_f32_16x16x32_bf16 v[104:107], v[148:151], v[176:179], v[104:107]
    ds_read_b64_tr_b16 v[140:141], v26 offset:32768
    v_mfma_f32_16x16x32_bf16 v[64:67], v[148:151], v[12:15], v[64:67]
    ds_read_b64_tr_b16 v[142:143], v26 offset:33792
    v_mfma_f32_16x16x32_bf16 v[108:111], v[152:155], v[172:175], v[108:111]
    ds_read_b64_tr_b16 v[144:145], v27 offset:32768
    v_mfma_f32_16x16x32_bf16 v[112:115], v[152:155], v[176:179], v[112:115]
    ds_read_b64_tr_b16 v[146:147], v27 offset:33792
    s_waitcnt lgkmcnt(10)
    v_mfma_f32_16x16x32_bf16 v[116:119], v[156:159], v[172:175], v[116:119]
    ds_read_b64_tr_b16 v[148:149], v28 offset:32768
    v_mfma_f32_16x16x32_bf16 v[120:123], v[156:159], v[176:179], v[120:123]
    ds_read_b64_tr_b16 v[150:151], v28 offset:33792
    v_mfma_f32_16x16x32_bf16 v[124:127], v[160:163], v[172:175], v[124:127]
    ds_read_b64_tr_b16 v[152:153], v29 offset:32768
    v_mfma_f32_16x16x32_bf16 v[128:131], v[160:163], v[176:179], v[128:131]
    ds_read_b64_tr_b16 v[154:155], v29 offset:33792
    s_waitcnt lgkmcnt(8)
    v_mfma_f32_16x16x32_bf16 v[68:71], v[132:135], v[164:167], v[68:71]
    ds_read_b64_tr_b16 v[156:157], v30 offset:32768
    v_mfma_f32_16x16x32_bf16 v[72:75], v[132:135], v[168:171], v[72:75]
    ds_read_b64_tr_b16 v[158:159], v30 offset:33792
    v_mfma_f32_16x16x32_bf16 v[76:79], v[136:139], v[164:167], v[76:79]
    ds_read_b64_tr_b16 v[160:161], v31 offset:32768
    v_mfma_f32_16x16x32_bf16 v[80:83], v[136:139], v[168:171], v[80:83]
    ds_read_b64_tr_b16 v[162:163], v31 offset:33792
    s_waitcnt lgkmcnt(8)
    v_mfma_f32_16x16x32_bf16 v[84:87], v[140:143], v[164:167], v[84:87]
    ds_read_b128 v[172:175], v45 offset:49152
    v_mfma_f32_16x16x32_bf16 v[88:91], v[140:143], v[168:171], v[88:91]
    ds_read_b128 v[176:179], v47 offset:49152
    v_mfma_f32_16x16x32_bf16 v[92:95], v[144:147], v[164:167], v[92:95]
    ds_read_b64_tr_b16 v[132:133], v24 offset:40960
    v_mfma_f32_16x16x32_bf16 v[96:99], v[144:147], v[168:171], v[96:99]
    ds_read_b64_tr_b16 v[134:135], v24 offset:41984
    v_mfma_f32_16x16x32_bf16 v[60:63], v[144:147], v[12:15], v[60:63]
    ds_read_b64_tr_b16 v[136:137], v25 offset:40960
    s_waitcnt lgkmcnt(9)
    v_mfma_f32_16x16x32_bf16 v[100:103], v[148:151], v[164:167], v[100:103]
    ds_read_b64_tr_b16 v[138:139], v25 offset:41984
    v_mfma_f32_16x16x32_bf16 v[104:107], v[148:151], v[168:171], v[104:107]
    ds_read_b64_tr_b16 v[140:141], v26 offset:40960
    v_mfma_f32_16x16x32_bf16 v[64:67], v[148:151], v[12:15], v[64:67]
    ds_read_b64_tr_b16 v[142:143], v26 offset:41984
    v_mfma_f32_16x16x32_bf16 v[108:111], v[152:155], v[164:167], v[108:111]
    ds_read_b64_tr_b16 v[144:145], v27 offset:40960
    v_mfma_f32_16x16x32_bf16 v[112:115], v[152:155], v[168:171], v[112:115]
    ds_read_b64_tr_b16 v[146:147], v27 offset:41984
    s_waitcnt lgkmcnt(10)
    v_mfma_f32_16x16x32_bf16 v[116:119], v[156:159], v[164:167], v[116:119]
    ds_read_b64_tr_b16 v[148:149], v28 offset:40960
    v_mfma_f32_16x16x32_bf16 v[120:123], v[156:159], v[168:171], v[120:123]
    ds_read_b64_tr_b16 v[150:151], v28 offset:41984
    v_mfma_f32_16x16x32_bf16 v[124:127], v[160:163], v[164:167], v[124:127]
    ds_read_b64_tr_b16 v[152:153], v29 offset:40960
    v_mfma_f32_16x16x32_bf16 v[128:131], v[160:163], v[168:171], v[128:131]
    ds_read_b64_tr_b16 v[154:155], v29 offset:41984
    s_waitcnt lgkmcnt(8)
    v_mfma_f32_16x16x32_bf16 v[68:71], v[132:135], v[172:175], v[68:71]
    ds_read_b64_tr_b16 v[156:157], v30 offset:40960
    v_mfma_f32_16x16x32_bf16 v[72:75], v[132:135], v[176:179], v[72:75]
    ds_read_b64_tr_b16 v[158:159], v30 offset:41984
    v_mfma_f32_16x16x32_bf16 v[76:79], v[136:139], v[172:175], v[76:79]
    ds_read_b64_tr_b16 v[160:161], v31 offset:40960
    v_mfma_f32_16x16x32_bf16 v[80:83], v[136:139], v[176:179], v[80:83]
    ds_read_b64_tr_b16 v[162:163], v31 offset:41984
    s_waitcnt lgkmcnt(8)
    v_mfma_f32_16x16x32_bf16 v[84:87], v[140:143], v[172:175], v[84:87]
    s_barrier
    ds_read_b128 v[164:167], v44 offset:16384
    v_mfma_f32_16x16x32_bf16 v[88:91], v[140:143], v[176:179], v[88:91]
    ds_read_b128 v[168:171], v46 offset:16384
    v_mfma_f32_16x16x32_bf16 v[92:95], v[144:147], v[172:175], v[92:95]
    ds_read_b64_tr_b16 v[132:133], v24 offset:0
    v_mfma_f32_16x16x32_bf16 v[96:99], v[144:147], v[176:179], v[96:99]
    ds_read_b64_tr_b16 v[134:135], v24 offset:1024
    v_mfma_f32_16x16x32_bf16 v[60:63], v[144:147], v[12:15], v[60:63]
    ds_read_b64_tr_b16 v[136:137], v25 offset:0
    s_waitcnt lgkmcnt(9)
    v_mfma_f32_16x16x32_bf16 v[100:103], v[148:151], v[172:175], v[100:103]
    ds_read_b64_tr_b16 v[138:139], v25 offset:1024
    v_mfma_f32_16x16x32_bf16 v[104:107], v[148:151], v[176:179], v[104:107]
    ds_read_b64_tr_b16 v[140:141], v26 offset:0
    v_mfma_f32_16x16x32_bf16 v[64:67], v[148:151], v[12:15], v[64:67]
    ds_read_b64_tr_b16 v[142:143], v26 offset:1024
    v_mfma_f32_16x16x32_bf16 v[108:111], v[152:155], v[172:175], v[108:111]
    ds_read_b64_tr_b16 v[144:145], v27 offset:0
    v_mfma_f32_16x16x32_bf16 v[112:115], v[152:155], v[176:179], v[112:115]
    ds_read_b64_tr_b16 v[146:147], v27 offset:1024
    s_waitcnt lgkmcnt(10)
    v_mfma_f32_16x16x32_bf16 v[116:119], v[156:159], v[172:175], v[116:119]
    ds_read_b64_tr_b16 v[148:149], v28 offset:0
    v_mfma_f32_16x16x32_bf16 v[120:123], v[156:159], v[176:179], v[120:123]
    ds_read_b64_tr_b16 v[150:151], v28 offset:1024
    v_mfma_f32_16x16x32_bf16 v[124:127], v[160:163], v[172:175], v[124:127]
    ds_read_b64_tr_b16 v[152:153], v29 offset:0
    v_mfma_f32_16x16x32_bf16 v[128:131], v[160:163], v[176:179], v[128:131]
    ds_read_b64_tr_b16 v[154:155], v29 offset:1024
    s_waitcnt lgkmcnt(8)
    v_mfma_f32_16x16x32_bf16 v[68:71], v[132:135], v[164:167], v[68:71]
    ds_read_b64_tr_b16 v[156:157], v30 offset:0
    v_mfma_f32_16x16x32_bf16 v[72:75], v[132:135], v[168:171], v[72:75]
    ds_read_b64_tr_b16 v[158:159], v30 offset:1024
    v_mfma_f32_16x16x32_bf16 v[76:79], v[136:139], v[164:167], v[76:79]
    ds_read_b64_tr_b16 v[160:161], v31 offset:0
    v_mfma_f32_16x16x32_bf16 v[80:83], v[136:139], v[168:171], v[80:83]
    ds_read_b64_tr_b16 v[162:163], v31 offset:1024
    s_waitcnt lgkmcnt(8)
    v_mfma_f32_16x16x32_bf16 v[84:87], v[140:143], v[164:167], v[84:87]
    ds_read_b128 v[172:175], v45 offset:16384
    v_mfma_f32_16x16x32_bf16 v[88:91], v[140:143], v[168:171], v[88:91]
    ds_read_b128 v[176:179], v47 offset:16384
    v_mfma_f32_16x16x32_bf16 v[92:95], v[144:147], v[164:167], v[92:95]
    ds_read_b64_tr_b16 v[132:133], v24 offset:8192
    v_mfma_f32_16x16x32_bf16 v[96:99], v[144:147], v[168:171], v[96:99]
    ds_read_b64_tr_b16 v[134:135], v24 offset:9216
    v_mfma_f32_16x16x32_bf16 v[60:63], v[144:147], v[12:15], v[60:63]
    ds_read_b64_tr_b16 v[136:137], v25 offset:8192
    s_waitcnt lgkmcnt(9)
    v_mfma_f32_16x16x32_bf16 v[100:103], v[148:151], v[164:167], v[100:103]
    ds_read_b64_tr_b16 v[138:139], v25 offset:9216
    v_mfma_f32_16x16x32_bf16 v[104:107], v[148:151], v[168:171], v[104:107]
    ds_read_b64_tr_b16 v[140:141], v26 offset:8192
    v_mfma_f32_16x16x32_bf16 v[64:67], v[148:151], v[12:15], v[64:67]
    ds_read_b64_tr_b16 v[142:143], v26 offset:9216
    v_mfma_f32_16x16x32_bf16 v[108:111], v[152:155], v[164:167], v[108:111]
    ds_read_b64_tr_b16 v[144:145], v27 offset:8192
    v_mfma_f32_16x16x32_bf16 v[112:115], v[152:155], v[168:171], v[112:115]
    ds_read_b64_tr_b16 v[146:147], v27 offset:9216
    s_waitcnt lgkmcnt(10)
    v_mfma_f32_16x16x32_bf16 v[116:119], v[156:159], v[164:167], v[116:119]
    ds_read_b64_tr_b16 v[148:149], v28 offset:8192
    v_mfma_f32_16x16x32_bf16 v[120:123], v[156:159], v[168:171], v[120:123]
    ds_read_b64_tr_b16 v[150:151], v28 offset:9216
    v_mfma_f32_16x16x32_bf16 v[124:127], v[160:163], v[164:167], v[124:127]
    ds_read_b64_tr_b16 v[152:153], v29 offset:8192
    v_mfma_f32_16x16x32_bf16 v[128:131], v[160:163], v[168:171], v[128:131]
    ds_read_b64_tr_b16 v[154:155], v29 offset:9216
    s_waitcnt lgkmcnt(8)
    v_mfma_f32_16x16x32_bf16 v[68:71], v[132:135], v[172:175], v[68:71]
    ds_read_b64_tr_b16 v[156:157], v30 offset:8192
    v_mfma_f32_16x16x32_bf16 v[72:75], v[132:135], v[176:179], v[72:75]
    ds_read_b64_tr_b16 v[158:159], v30 offset:9216
    v_mfma_f32_16x16x32_bf16 v[76:79], v[136:139], v[172:175], v[76:79]
    ds_read_b64_tr_b16 v[160:161], v31 offset:8192
    v_mfma_f32_16x16x32_bf16 v[80:83], v[136:139], v[176:179], v[80:83]
    ds_read_b64_tr_b16 v[162:163], v31 offset:9216
    s_waitcnt lgkmcnt(8)
    v_mfma_f32_16x16x32_bf16 v[84:87], v[140:143], v[172:175], v[84:87]
    s_barrier
    ds_read_b128 v[164:167], v40 offset:16384
    v_mfma_f32_16x16x32_bf16 v[88:91], v[140:143], v[176:179], v[88:91]
    ds_read_b128 v[168:171], v42 offset:16384
    v_mfma_f32_16x16x32_bf16 v[92:95], v[144:147], v[172:175], v[92:95]
    ds_read_b64_tr_b16 v[132:133], v16 offset:0
    v_mfma_f32_16x16x32_bf16 v[96:99], v[144:147], v[176:179], v[96:99]
    ds_read_b64_tr_b16 v[134:135], v16 offset:1024
    v_mfma_f32_16x16x32_bf16 v[60:63], v[144:147], v[12:15], v[60:63]
    ds_read_b64_tr_b16 v[136:137], v17 offset:0
    s_waitcnt lgkmcnt(9)
    v_mfma_f32_16x16x32_bf16 v[100:103], v[148:151], v[172:175], v[100:103]
    ds_read_b64_tr_b16 v[138:139], v17 offset:1024
    v_mfma_f32_16x16x32_bf16 v[104:107], v[148:151], v[176:179], v[104:107]
    ds_read_b64_tr_b16 v[140:141], v18 offset:0
    v_mfma_f32_16x16x32_bf16 v[64:67], v[148:151], v[12:15], v[64:67]
    ds_read_b64_tr_b16 v[142:143], v18 offset:1024
    v_mfma_f32_16x16x32_bf16 v[108:111], v[152:155], v[172:175], v[108:111]
    ds_read_b64_tr_b16 v[144:145], v19 offset:0
    v_mfma_f32_16x16x32_bf16 v[112:115], v[152:155], v[176:179], v[112:115]
    ds_read_b64_tr_b16 v[146:147], v19 offset:1024
    s_waitcnt lgkmcnt(10)
    v_mfma_f32_16x16x32_bf16 v[116:119], v[156:159], v[172:175], v[116:119]
    ds_read_b64_tr_b16 v[148:149], v20 offset:0
    v_mfma_f32_16x16x32_bf16 v[120:123], v[156:159], v[176:179], v[120:123]
    ds_read_b64_tr_b16 v[150:151], v20 offset:1024
    v_mfma_f32_16x16x32_bf16 v[124:127], v[160:163], v[172:175], v[124:127]
    ds_read_b64_tr_b16 v[152:153], v21 offset:0
    v_mfma_f32_16x16x32_bf16 v[128:131], v[160:163], v[176:179], v[128:131]
    ds_read_b64_tr_b16 v[154:155], v21 offset:1024
    s_waitcnt lgkmcnt(8)
    v_mfma_f32_16x16x32_bf16 v[68:71], v[132:135], v[164:167], v[68:71]
    ds_read_b64_tr_b16 v[156:157], v22 offset:0
    v_mfma_f32_16x16x32_bf16 v[72:75], v[132:135], v[168:171], v[72:75]
    ds_read_b64_tr_b16 v[158:159], v22 offset:1024
    s_mov_b32 s43, 400000
L_p1_rfq:
    s_waitcnt vmcnt(0)
    v_readfirstlane_b32 s67, v228
    s_cmp_eq_u32 s67, 0
    s_cbranch_scc1 L_p1_rfwq
    s_lshl_b32 s67, s66, 2
    s_add_u32 s67, s67, 16384
    s_mov_b64 exec, 1
    buffer_store_dword v228, off, s[56:59], s67 sc1
    s_mov_b64 exec, -1
L_p1_rfxq:
    v_mfma_f32_16x16x32_bf16 v[76:79], v[136:139], v[164:167], v[76:79]
    ds_read_b64_tr_b16 v[160:161], v23 offset:0
    v_mfma_f32_16x16x32_bf16 v[80:83], v[136:139], v[168:171], v[80:83]
    ds_read_b64_tr_b16 v[162:163], v23 offset:1024
    s_waitcnt lgkmcnt(8)
    v_mfma_f32_16x16x32_bf16 v[84:87], v[140:143], v[164:167], v[84:87]
    ds_read_b128 v[172:175], v41 offset:16384
    v_mfma_f32_16x16x32_bf16 v[88:91], v[140:143], v[168:171], v[88:91]
    ds_read_b128 v[176:179], v43 offset:16384
    v_mfma_f32_16x16x32_bf16 v[92:95], v[144:147], v[164:167], v[92:95]
    ds_read_b64_tr_b16 v[132:133], v16 offset:8192
    v_mfma_f32_16x16x32_bf16 v[96:99], v[144:147], v[168:171], v[96:99]
    ds_read_b64_tr_b16 v[134:135], v16 offset:9216
    v_mfma_f32_16x16x32_bf16 v[60:63], v[144:147], v[12:15], v[60:63]
    ds_read_b64_tr_b16 v[136:137], v17 offset:8192
    s_waitcnt lgkmcnt(9)
    v_mfma_f32_16x16x32_bf16 v[100:103], v[148:151], v[164:167], v[100:103]
    ds_read_b64_tr_b16 v[138:139], v17 offset:9216
    v_mfma_f32_16x16x32_bf16 v[104:107], v[148:151], v[168:171], v[104:107]
    ds_read_b64_tr_b16 v[140:141], v18 offset:8192
    v_mfma_f32_16x16x32_bf16 v[64:67], v[148:151], v[12:15], v[64:67]
    ds_read_b64_tr_b16 v[142:143], v18 offset:9216
    v_mfma_f32_16x16x32_bf16 v[108:111], v[152:155], v[164:167], v[108:111]
    ds_read_b64_tr_b16 v[144:145], v19 offset:8192
    v_mfma_f32_16x16x32_bf16 v[112:115], v[152:155], v[168:171], v[112:115]
    ds_read_b64_tr_b16 v[146:147], v19 offset:9216
    s_waitcnt lgkmcnt(10)
    v_mfma_f32_16x16x32_bf16 v[116:119], v[156:159], v[164:167], v[116:119]
    ds_read_b64_tr_b16 v[148:149], v20 offset:8192
    v_mfma_f32_16x16x32_bf16 v[120:123], v[156:159], v[168:171], v[120:123]
    ds_read_b64_tr_b16 v[150:151], v20 offset:9216
    v_mfma_f32_16x16x32_bf16 v[124:127], v[160:163], v[164:167], v[124:127]
    ds_read_b64_tr_b16 v[152:153], v21 offset:8192
    v_mfma_f32_16x16x32_bf16 v[128:131], v[160:163], v[168:171], v[128:131]
    ds_read_b64_tr_b16 v[154:155], v21 offset:9216
    s_waitcnt lgkmcnt(8)
    v_mfma_f32_16x16x32_bf16 v[68:71], v[132:135], v[172:175], v[68:71]
    ds_read_b64_tr_b16 v[156:157], v22 offset:8192
    v_mfma_f32_16x16x32_bf16 v[72:75], v[132:135], v[176:179], v[72:75]
    ds_read_b64_tr_b16 v[158:159], v22 offset:9216
    v_mfma_f32_16x16x32_bf16 v[76:79], v[136:139], v[172:175], v[76:79]
    ds_read_b64_tr_b16 v[160:161], v23 offset:8192
    v_mfma_f32_16x16x32_bf16 v[80:83], v[136:139], v[176:179], v[80:83]
    ds_read_b64_tr_b16 v[162:163], v23 offset:9216
    s_waitcnt lgkmcnt(8)
    v_mfma_f32_16x16x32_bf16 v[84:87], v[140:143], v[172:175], v[84:87]
    s_barrier
    ds_read_b128 v[164:167], v40 offset:49152
    v_mfma_f32_16x16x32_bf16 v[88:91], v[140:143], v[176:179], v[88:91]
    ds_read_b128 v[168:171], v42 offset:49152
    v_mfma_f32_16x16x32_bf16 v[92:95], v[144:147], v[172:175], v[92:95]
    ds_read_b64_tr_b16 v[132:133], v16 offset:32768
    v_mfma_f32_16x16x32_bf16 v[96:99], v[144:147], v[176:179], v[96:99]
    ds_read_b64_tr_b16 v[134:135], v16 offset:33792
    v_mfma_f32_16x16x32_bf16 v[60:63], v[144:147], v[12:15], v[60:63]
    ds_read_b64_tr_b16 v[136:137], v17 offset:32768
    s_waitcnt lgkmcnt(9)
    v_mfma_f32_16x16x32_bf16 v[100:103], v[148:151], v[172:175], v[100:103]
    ds_read_b64_tr_b16 v[138:139], v17 offset:33792
    v_mfma_f32_16x16x32_bf16 v[104:107], v[148:151], v[176:179], v[104:107]
    ds_read_b64_tr_b16 v[140:141], v18 offset:32768
    v_mfma_f32_16x16x32_bf16 v[64:67], v[148:151], v[12:15], v[64:67]
    ds_read_b64_tr_b16 v[142:143], v18 offset:33792
    v_mfma_f32_16x16x32_bf16 v[108:111], v[152:155], v[172:175], v[108:111]
    ds_read_b64_tr_b16 v[144:145], v19 offset:32768
    v_mfma_f32_16x16x32_bf16 v[112:115], v[152:155], v[176:179], v[112:115]
    ds_read_b64_tr_b16 v[146:147], v19 offset:33792
    s_waitcnt lgkmcnt(10)
    v_mfma_f32_16x16x32_bf16 v[116:119], v[156:159], v[172:175], v[116:119]
    ds_read_b64_tr_b16 v[148:149], v20 offset:32768
    v_mfma_f32_16x16x32_bf16 v[120:123], v[156:159], v[176:179], v[120:123]
    ds_read_b64_tr_b16 v[150:151], v20 offset:33792
    v_mfma_f32_16x16x32_bf16 v[124:127], v[160:163], v[172:175], v[124:127]
    ds_read_b64_tr_b16 v[152:153], v21 offset:32768
    v_mfma_f32_16x16x32_bf16 v[128:131], v[160:163], v[176:179], v[128:131]
    ds_read_b64_tr_b16 v[154:155], v21 offset:33792
    s_waitcnt lgkmcnt(8)
    v_mfma_f32_16x16x32_bf16 v[68:71], v[132:135], v[164:167], v[68:71]
    ds_read_b64_tr_b16 v[156:157], v22 offset:32768
    v_mfma_f32_16x16x32_bf16 v[72:75], v[132:135], v[168:171], v[72:75]
    ds_read_b64_tr_b16 v[158:159], v22 offset:33792
    v_mfma_f32_16x16x32_bf16 v[76:79], v[136:139], v[164:167], v[76:79]
    ds_read_b64_tr_b16 v[160:161], v23 offset:32768
    v_mfma_f32_16x16x32_bf16 v[80:83], v[136:139], v[168:171], v[80:83]
    ds_read_b64_tr_b16 v[162:163], v23 offset:33792
    s_waitcnt lgkmcnt(8)
    v_mfma_f32_16x16x32_bf16 v[84:87], v[140:143], v[164:167], v[84:87]
    ds_read_b128 v[172:175], v41 offset:49152
    v_mfma_f32_16x16x32_bf16 v[88:91], v[140:143], v[168:171], v[88:91]
    ds_read_b128 v[176:179], v43 offset:49152
    v_mfma_f32_16x16x32_bf16 v[92:95], v[144:147], v[164:167], v[92:95]
    ds_read_b64_tr_b16 v[132:133], v16 offset:40960
    v_mfma_f32_16x16x32_bf16 v[96:99], v[144:147], v[168:171], v[96:99]
    ds_read_b64_tr_b16 v[134:135], v16 offset:41984
    v_mfma_f32_16x16x32_bf16 v[60:63], v[144:147], v[12:15], v[60:63]
    ds_read_b64_tr_b16 v[136:137], v17 offset:40960
    s_waitcnt lgkmcnt(9)
    v_mfma_f32_16x16x32_bf16 v[100:103], v[148:151], v[164:167], v[100:103]
    ds_read_b64_tr_b16 v[138:139], v17 offset:41984
    v_mfma_f32_16x16x32_bf16 v[104:107], v[148:151], v[168:171], v[104:107]
    ds_read_b64_tr_b16 v[140:141], v18 offset:40960
    v_mfma_f32_16x16x32_bf16 v[64:67], v[148:151], v[12:15], v[64:67]
    ds_read_b64_tr_b16 v[142:143], v18 offset:41984
    v_mfma_f32_16x16x32_bf16 v[108:111], v[152:155], v[164:167], v[108:111]
    ds_read_b64_tr_b16 v[144:145], v19 offset:40960
    v_mfma_f32_16x16x32_bf16 v[112:115], v[152:155], v[168:171], v[112:115]
    ds_read_b64_tr_b16 v[146:147], v19 offset:41984
    s_waitcnt lgkmcnt(10)
    v_mfma_f32_16x16x32_bf16 v[116:119], v[156:159], v[164:167], v[116:119]
    ds_read_b64_tr_b16 v[148:149], v20 offset:40960
    v_mfma_f32_16x16x32_bf16 v[120:123], v[156:159], v[168:171], v[120:123]
    ds_read_b64_tr_b16 v[150:151], v20 offset:41984
    v_mfma_f32_16x16x32_bf16 v[124:127], v[160:163], v[164:167], v[124:127]
    ds_read_b64_tr_b16 v[152:153], v21 offset:40960
    v_mfma_f32_16x16x32_bf16 v[128:131], v[160:163], v[168:171], v[128:131]
    ds_read_b64_tr_b16 v[154:155], v21 offset:41984
    s_waitcnt lgkmcnt(8)
    v_mfma_f32_16x16x32_bf16 v[68:71], v[132:135], v[172:175], v[68:71]
    ds_read_b64_tr_b16 v[156:157], v22 offset:40960
    v_mfma_f32_16x16x32_bf16 v[72:75], v[132:135], v[176:179], v[72:75]
    ds_read_b64_tr_b16 v[158:159], v22 offset:41984
    v_mfma_f32_16x16x32_bf16 v[76:79], v[136:139], v[172:175], v[76:79]
    ds_read_b64_tr_b16 v[160:161], v23 offset:40960
    v_mfma_f32_16x16x32_bf16 v[80:83], v[136:139], v[176:179], v[80:83]
    ds_read_b64_tr_b16 v[162:163], v23 offset:41984
    s_waitcnt lgkmcnt(8)
    v_mfma_f32_16x16x32_bf16 v[84:87], v[140:143], v[172:175], v[84:87]
    s_barrier
    ds_read_b128 v[164:167], v48 offset:16384
    v_mfma_f32_16x16x32_bf16 v[88:91], v[140:143], v[176:179], v[88:91]
    ds_read_b128 v[168:171], v50 offset:16384
    v_mfma_f32_16x16x32_bf16 v[92:95], v[144:147], v[172:175], v[92:95]
    ds_read_b64_tr_b16 v[132:133], v32 offset:0
    v_mfma_f32_16x16x32_bf16 v[96:99], v[144:147], v[176:179], v[96:99]
    ds_read_b64_tr_b16 v[134:135], v32 offset:1024
    v_mfma_f32_16x16x32_bf16 v[60:63], v[144:147], v[12:15], v[60:63]
    ds_read_b64_tr_b16 v[136:137], v33 offset:0
    s_waitcnt lgkmcnt(9)
    v_mfma_f32_16x16x32_bf16 v[100:103], v[148:151], v[172:175], v[100:103]
    ds_read_b64_tr_b16 v[138:139], v33 offset:1024
    v_mfma_f32_16x16x32_bf16 v[104:107], v[148:151], v[176:179], v[104:107]
    ds_read_b64_tr_b16 v[140:141], v34 offset:0
    v_mfma_f32_16x16x32_bf16 v[64:67], v[148:151], v[12:15], v[64:67]
    ds_read_b64_tr_b16 v[142:143], v34 offset:1024
    v_mfma_f32_16x16x32_bf16 v[108:111], v[152:155], v[172:175], v[108:111]
    ds_read_b64_tr_b16 v[144:145], v35 offset:0
    v_mfma_f32_16x16x32_bf16 v[112:115], v[152:155], v[176:179], v[112:115]
    ds_read_b64_tr_b16 v[146:147], v35 offset:1024
    s_waitcnt lgkmcnt(10)
    v_mfma_f32_16x16x32_bf16 v[116:119], v[156:159], v[172:175], v[116:119]
    ds_read_b64_tr_b16 v[148:149], v36 offset:0
    v_mfma_f32_16x16x32_bf16 v[120:123], v[156:159], v[176:179], v[120:123]
    ds_read_b64_tr_b16 v[150:151], v36 offset:1024
    v_mfma_f32_16x16x32_bf16 v[124:127], v[160:163], v[172:175], v[124:127]
    ds_read_b64_tr_b16 v[152:153], v37 offset:0
    v_mfma_f32_16x16x32_bf16 v[128:131], v[160:163], v[176:179], v[128:131]
    ds_read_b64_tr_b16 v[154:155], v37 offset:1024
    s_waitcnt lgkmcnt(8)
    v_mfma_f32_16x16x32_bf16 v[68:71], v[132:135], v[164:167], v[68:71]
    ds_read_b64_tr_b16 v[156:157], v38 offset:0
    v_mfma_f32_16x16x32_bf16 v[72:75], v[132:135], v[168:171], v[72:75]
    ds_read_b64_tr_b16 v[158:159], v38 offset:1024
    v_mfma_f32_16x16x32_bf16 v[76:79], v[136:139], v[164:167], v[76:79]
    ds_read_b64_tr_b16 v[160:161], v39 offset:0
    v_mfma_f32_16x16x32_bf16 v[80:83], v[136:139], v[168:171], v[80:83]
    ds_read_b64_tr_b16 v[162:163], v39 offset:1024
    s_waitcnt lgkmcnt(8)
    v_mfma_f32_16x16x32_bf16 v[84:87], v[140:143], v[164:167], v[84:87]
    ds_read_b128 v[172:175], v49 offset:16384
    v_mfma_f32_16x16x32_bf16 v[88:91], v[140:143], v[168:171], v[88:91]
    ds_read_b128 v[176:179], v51 offset:16384
    v_mfma_f32_16x16x32_bf16 v[92:95], v[144:147], v[164:167], v[92:95]
    ds_read_b64_tr_b16 v[132:133], v32 offset:8192
    v_mfma_f32_16x16x32_bf16 v[96:99], v[144:147], v[168:171], v[96:99]
    ds_read_b64_tr_b16 v[134:135], v32 offset:9216
    v_mfma_f32_16x16x32_bf16 v[60:63], v[144:147], v[12:15], v[60:63]
    ds_read_b64_tr_b16 v[136:137], v33 offset:8192
    s_waitcnt lgkmcnt(9)
    v_mfma_f32_16x16x32_bf16 v[100:103], v[148:151], v[164:167], v[100:103]
    ds_read_b64_tr_b16 v[138:139], v33 offset:9216
    v_mfma_f32_16x16x32_bf16 v[104:107], v[148:151], v[168:171], v[104:107]
    ds_read_b64_tr_b16 v[140:141], v34 offset:8192
    v_mfma_f32_16x16x32_bf16 v[64:67], v[148:151], v[12:15], v[64:67]
    ds_read_b64_tr_b16 v[142:143], v34 offset:9216
    v_mfma_f32_16x16x32_bf16 v[108:111], v[152:155], v[164:167], v[108:111]
    ds_read_b64_tr_b16 v[144:145], v35 offset:8192
    v_mfma_f32_16x16x32_bf16 v[112:115], v[152:155], v[168:171], v[112:115]
    ds_read_b64_tr_b16 v[146:147], v35 offset:9216
    s_waitcnt lgkmcnt(10)
    v_mfma_f32_16x16x32_bf16 v[116:119], v[156:159], v[164:167], v[116:119]
    ds_read_b64_tr_b16 v[148:149], v36 offset:8192
    v_mfma_f32_16x16x32_bf16 v[120:123], v[156:159], v[168:171], v[120:123]
    ds_read_b64_tr_b16 v[150:151], v36 offset:9216
    v_mfma_f32_16x16x32_bf16 v[124:127], v[160:163], v[164:167], v[124:127]
    ds_read_b64_tr_b16 v[152:153], v37 offset:8192
    v_mfma_f32_16x16x32_bf16 v[128:131], v[160:163], v[168:171], v[128:131]
    ds_read_b64_tr_b16 v[154:155], v37 offset:9216
    s_waitcnt lgkmcnt(8)
    v_mfma_f32_16x16x32_bf16 v[68:71], v[132:135], v[172:175], v[68:71]
    ds_read_b64_tr_b16 v[156:157], v38 offset:8192
    v_mfma_f32_16x16x32_bf16 v[72:75], v[132:135], v[176:179], v[72:75]
    ds_read_b64_tr_b16 v[158:159], v38 offset:9216
    s_lshl_b32 s42, s24, 8
    s_lshl_b32 s27, s40, 6
    s_add_u32 s42, s42, s27
    s_add_u32 s42, s42, 16384
    v_lshlrev_b32 v241, 2, v3
    buffer_load_dword v240, v241, s[56:59], s42 offen sc1
    v_mfma_f32_16x16x32_bf16 v[76:79], v[136:139], v[172:175], v[76:79]
    ds_read_b64_tr_b16 v[160:161], v39 offset:8192
    v_mfma_f32_16x16x32_bf16 v[80:83], v[136:139], v[176:179], v[80:83]
    ds_read_b64_tr_b16 v[162:163], v39 offset:9216
    s_waitcnt lgkmcnt(8)
    v_mfma_f32_16x16x32_bf16 v[84:87], v[140:143], v[172:175], v[84:87]
    s_barrier
    ds_read_b128 v[164:167], v44 offset:49152
    v_mfma_f32_16x16x32_bf16 v[88:91], v[140:143], v[176:179], v[88:91]
    ds_read_b128 v[168:171], v46 offset:49152
    v_mfma_f32_16x16x32_bf16 v[92:95], v[144:147], v[172:175], v[92:95]
    ds_read_b64_tr_b16 v[132:133], v24 offset:32768
    v_mfma_f32_16x16x32_bf16 v[96:99], v[144:147], v[176:179], v[96:99]
    ds_read_b64_tr_b16 v[134:135], v24 offset:33792
    v_mfma_f32_16x16x32_bf16 v[60:63], v[144:147], v[12:15], v[60:63]
    ds_read_b64_tr_b16 v[136:137], v25 offset:32768
    s_waitcnt lgkmcnt(9)
    v_mfma_f32_16x16x32_bf16 v[100:103], v[148:151], v[172:175], v[100:103]
    ds_read_b64_tr_b16 v[138:139], v25 offset:33792
    v_mfma_f32_16x16x32_bf16 v[104:107], v[148:151], v[176:179], v[104:107]
    ds_read_b64_tr_b16 v[140:141], v26 offset:32768
    v_mfma_f32_16x16x32_bf16 v[64:67], v[148:151], v[12:15], v[64:67]
    ds_read_b64_tr_b16 v[142:143], v26 offset:33792
    v_mfma_f32_16x16x32_bf16 v[108:111], v[152:155], v[172:175], v[108:111]
    ds_read_b64_tr_b16 v[144:145], v27 offset:32768
    v_mfma_f32_16x16x32_bf16 v[112:115], v[152:155], v[176:179], v[112:115]
    ds_read_b64_tr_b16 v[146:147], v27 offset:33792
    s_waitcnt lgkmcnt(10)
    v_mfma_f32_16x16x32_bf16 v[116:119], v[156:159], v[172:175], v[116:119]
    ds_read_b64_tr_b16 v[148:149], v28 offset:32768
    v_mfma_f32_16x16x32_bf16 v[120:123], v[156:159], v[176:179], v[120:123]
    ds_read_b64_tr_b16 v[150:151], v28 offset:33792
    v_mfma_f32_16x16x32_bf16 v[124:127], v[160:163], v[172:175], v[124:127]
    ds_read_b64_tr_b16 v[152:153], v29 offset:32768
    v_mfma_f32_16x16x32_bf16 v[128:131], v[160:163], v[176:179], v[128:131]
    ds_read_b64_tr_b16 v[154:155], v29 offset:33792
    s_waitcnt lgkmcnt(8)
    v_mfma_f32_16x16x32_bf16 v[68:71], v[132:135], v[164:167], v[68:71]
    ds_read_b64_tr_b16 v[156:157], v30 offset:32768
    v_mfma_f32_16x16x32_bf16 v[72:75], v[132:135], v[168:171], v[72:75]
    ds_read_b64_tr_b16 v[158:159], v30 offset:33792
    v_mfma_f32_16x16x32_bf16 v[76:79], v[136:139], v[164:167], v[76:79]
    ds_read_b64_tr_b16 v[160:161], v31 offset:32768
    v_mfma_f32_16x16x32_bf16 v[80:83], v[136:139], v[168:171], v[80:83]
    ds_read_b64_tr_b16 v[162:163], v31 offset:33792
    s_waitcnt lgkmcnt(8)
    v_mfma_f32_16x16x32_bf16 v[84:87], v[140:143], v[164:167], v[84:87]
    ds_read_b128 v[172:175], v45 offset:49152
    v_mfma_f32_16x16x32_bf16 v[88:91], v[140:143], v[168:171], v[88:91]
    ds_read_b128 v[176:179], v47 offset:49152
    v_mfma_f32_16x16x32_bf16 v[92:95], v[144:147], v[164:167], v[92:95]
    ds_read_b64_tr_b16 v[132:133], v24 offset:40960
    v_mfma_f32_16x16x32_bf16 v[96:99], v[144:147], v[168:171], v[96:99]
    ds_read_b64_tr_b16 v[134:135], v24 offset:41984
    v_mfma_f32_16x16x32_bf16 v[60:63], v[144:147], v[12:15], v[60:63]
    ds_read_b64_tr_b16 v[136:137], v25 offset:40960
    s_waitcnt lgkmcnt(9)
    v_mfma_f32_16x16x32_bf16 v[100:103], v[148:151], v[164:167], v[100:103]
    ds_read_b64_tr_b16 v[138:139], v25 offset:41984
    v_mfma_f32_16x16x32_bf16 v[104:107], v[148:151], v[168:171], v[104:107]
    ds_read_b64_tr_b16 v[140:141], v26 offset:40960
    v_mfma_f32_16x16x32_bf16 v[64:67], v[148:151], v[12:15], v[64:67]
    ds_read_b64_tr_b16 v[142:143], v26 offset:41984
    v_mfma_f32_16x16x32_bf16 v[108:111], v[152:155], v[164:167], v[108:111]
    ds_read_b64_tr_b16 v[144:145], v27 offset:40960
    v_mfma_f32_16x16x32_bf16 v[112:115], v[152:155], v[168:171], v[112:115]
    ds_read_b64_tr_b16 v[146:147], v27 offset:41984
    s_waitcnt lgkmcnt(10)
    v_mfma_f32_16x16x32_bf16 v[116:119], v[156:159], v[164:167], v[116:119]
    ds_read_b64_tr_b16 v[148:149], v28 offset:40960
    v_mfma_f32_16x16x32_bf16 v[120:123], v[156:159], v[168:171], v[120:123]
    ds_read_b64_tr_b16 v[150:151], v28 offset:41984
    v_mfma_f32_16x16x32_bf16 v[124:127], v[160:163], v[164:167], v[124:127]
    ds_read_b64_tr_b16 v[152:153], v29 offset:40960
    v_mfma_f32_16x16x32_bf16 v[128:131], v[160:163], v[168:171], v[128:131]
    ds_read_b64_tr_b16 v[154:155], v29 offset:41984
    s_waitcnt lgkmcnt(8)
    v_mfma_f32_16x16x32_bf16 v[68:71], v[132:135], v[172:175], v[68:71]
    ds_read_b64_tr_b16 v[156:157], v30 offset:40960
    v_mfma_f32_16x16x32_bf16 v[72:75], v[132:135], v[176:179], v[72:75]
    ds_read_b64_tr_b16 v[158:159], v30 offset:41984
    v_mfma_f32_16x16x32_bf16 v[76:79], v[136:139], v[172:175], v[76:79]
    ds_read_b64_tr_b16 v[160:161], v31 offset:40960
    v_mfma_f32_16x16x32_bf16 v[80:83], v[136:139], v[176:179], v[80:83]
    ds_read_b64_tr_b16 v[162:163], v31 offset:41984
    s_waitcnt lgkmcnt(8)
    v_mfma_f32_16x16x32_bf16 v[84:87], v[140:143], v[172:175], v[84:87]
    s_barrier
    ds_read_b128 v[164:167], v44 offset:16384
    v_mfma_f32_16x16x32_bf16 v[88:91], v[140:143], v[176:179], v[88:91]
    ds_read_b128 v[168:171], v46 offset:16384
    v_mfma_f32_16x16x32_bf16 v[92:95], v[144:147], v[172:175], v[92:95]
    ds_read_b64_tr_b16 v[132:133], v24 offset:0
    v_mfma_f32_16x16x32_bf16 v[96:99], v[144:147], v[176:179], v[96:99]
    ds_read_b64_tr_b16 v[134:135], v24 offset:1024
    v_mfma_f32_16x16x32_bf16 v[60:63], v[144:147], v[12:15], v[60:63]
    ds_read_b64_tr_b16 v[136:137], v25 offset:0
    s_waitcnt lgkmcnt(9)
    v_mfma_f32_16x16x32_bf16 v[100:103], v[148:151], v[172:175], v[100:103]
    ds_read_b64_tr_b16 v[138:139], v25 offset:1024
    v_mfma_f32_16x16x32_bf16 v[104:107], v[148:151], v[176:179], v[104:107]
    ds_read_b64_tr_b16 v[140:141], v26 offset:0
    v_mfma_f32_16x16x32_bf16 v[64:67], v[148:151], v[12:15], v[64:67]
    ds_read_b64_tr_b16 v[142:143], v26 offset:1024
    v_mfma_f32_16x16x32_bf16 v[108:111], v[152:155], v[172:175], v[108:111]
    ds_read_b64_tr_b16 v[144:145], v27 offset:0
    v_mfma_f32_16x16x32_bf16 v[112:115], v[152:155], v[176:179], v[112:115]
    ds_read_b64_tr_b16 v[146:147], v27 offset:1024
    s_waitcnt lgkmcnt(10)
    v_mfma_f32_16x16x32_bf16 v[116:119], v[156:159], v[172:175], v[116:119]
    ds_read_b64_tr_b16 v[148:149], v28 offset:0
    v_mfma_f32_16x16x32_bf16 v[120:123], v[156:159], v[176:179], v[120:123]
    ds_read_b64_tr_b16 v[150:151], v28 offset:1024
    v_mfma_f32_16x16x32_bf16 v[124:127], v[160:163], v[172:175], v[124:127]
    ds_read_b64_tr_b16 v[152:153], v29 offset:0
    v_mfma_f32_16x16x32_bf16 v[128:131], v[160:163], v[176:179], v[128:131]
    ds_read_b64_tr_b16 v[154:155], v29 offset:1024
    s_waitcnt lgkmcnt(8)
    v_mfma_f32_16x16x32_bf16 v[68:71], v[132:135], v[164:167], v[68:71]
    ds_read_b64_tr_b16 v[156:157], v30 offset:0
    v_mfma_f32_16x16x32_bf16 v[72:75], v[132:135], v[168:171], v[72:75]
    ds_read_b64_tr_b16 v[158:159], v30 offset:1024
    s_mov_b32 s43, 400000
L_p1_spq:
    s_waitcnt vmcnt(0)
    v_cmp_eq_u32 vcc, 0, v240
    s_cbranch_vccnz L_p1_spwq
L_p1_spxq:
    s_lshl_b32 s42, s24, 9
    s_lshl_b32 s27, s40, 7
    s_add_u32 s42, s42, s27
    s_add_u32 s43, s42, 8192
    v_lshlrev_b32 v241, 3, v3
    buffer_load_dwordx2 v[236:237], v241, s[56:59], s42 offen sc1
    buffer_load_dwordx2 v[238:239], v241, s[56:59], s43 offen sc1
    v_mfma_f32_16x16x32_bf16 v[76:79], v[136:139], v[164:167], v[76:79]
    ds_read_b64_tr_b16 v[160:161], v31 offset:0
    v_mfma_f32_16x16x32_bf16 v[80:83], v[136:139], v[168:171], v[80:83]
    ds_read_b64_tr_b16 v[162:163], v31 offset:1024
    s_waitcnt lgkmcnt(8)
    v_mfma_f32_16x16x32_bf16 v[84:87], v[140:143], v[164:167], v[84:87]
    ds_read_b128 v[172:175], v45 offset:16384
    v_mfma_f32_16x16x32_bf16 v[88:91], v[140:143], v[168:171], v[88:91]
    ds_read_b128 v[176:179], v47 offset:16384
    v_mfma_f32_16x16x32_bf16 v[92:95], v[144:147], v[164:167], v[92:95]
    ds_read_b64_tr_b16 v[132:133], v24 offset:8192
    v_mfma_f32_16x16x32_bf16 v[96:99], v[144:147], v[168:171], v[96:99]
    ds_read_b64_tr_b16 v[134:135], v24 offset:9216
    v_mfma_f32_16x16x32_bf16 v[60:63], v[144:147], v[12:15], v[60:63]
    ds_read_b64_tr_b16 v[136:137], v25 offset:8192
    s_waitcnt lgkmcnt(9)
    v_mfma_f32_16x16x32_bf16 v[100:103], v[148:151], v[164:167], v[100:103]
    ds_read_b64_tr_b16 v[138:139], v25 offset:9216
    v_mfma_f32_16x16x32_bf16 v[104:107], v[148:151], v[168:171], v[104:107]
    ds_read_b64_tr_b16 v[140:141], v26 offset:8192
    v_mfma_f32_16x16x32_bf16 v[64:67], v[148:151], v[12:15], v[64:67]
    ds_read_b64_tr_b16 v[142:143], v26 offset:9216
    v_mfma_f32_16x16x32_bf16 v[108:111], v[152:155], v[164:167], v[108:111]
    ds_read_b64_tr_b16 v[144:145], v27 offset:8192
    v_mfma_f32_16x16x32_bf16 v[112:115], v[152:155], v[168:171], v[112:115]
    ds_read_b64_tr_b16 v[146:147], v27 offset:9216
    s_waitcnt lgkmcnt(10)
    v_mfma_f32_16x16x32_bf16 v[116:119], v[156:159], v[164:167], v[116:119]
    ds_read_b64_tr_b16 v[148:149], v28 offset:8192
    v_mfma_f32_16x16x32_bf16 v[120:123], v[156:159], v[168:171], v[120:123]
    ds_read_b64_tr_b16 v[150:151], v28 offset:9216
    v_mfma_f32_16x16x32_bf16 v[124:127], v[160:163], v[164:167], v[124:127]
    ds_read_b64_tr_b16 v[152:153], v29 offset:8192
    v_mfma_f32_16x16x32_bf16 v[128:131], v[160:163], v[168:171], v[128:131]
    ds_read_b64_tr_b16 v[154:155], v29 offset:9216
    s_waitcnt lgkmcnt(8)
    v_mfma_f32_16x16x32_bf16 v[68:71], v[132:135], v[172:175], v[68:71]
    ds_read_b64_tr_b16 v[156:157], v30 offset:8192
    v_mfma_f32_16x16x32_bf16 v[72:75], v[132:135], v[176:179], v[72:75]
    ds_read_b64_tr_b16 v[158:159], v30 offset:9216
    v_mfma_f32_16x16x32_bf16 v[76:79], v[136:139], v[172:175], v[76:79]
    ds_read_b64_tr_b16 v[160:161], v31 offset:8192
    v_mfma_f32_16x16x32_bf16 v[80:83], v[136:139], v[176:179], v[80:83]
    ds_read_b64_tr_b16 v[162:163], v31 offset:9216
    s_waitcnt lgkmcnt(8)
    v_mfma_f32_16x16x32_bf16 v[84:87], v[140:143], v[172:175], v[84:87]
    s_barrier
    ds_read_b128 v[164:167], v40 offset:16384
    v_mfma_f32_16x16x32_bf16 v[88:91], v[140:143], v[176:179], v[88:91]
    ds_read_b128 v[168:171], v42 offset:16384
    v_mfma_f32_16x16x32_bf16 v[92:95], v[144:147], v[172:175], v[92:95]
    ds_read_b64_tr_b16 v[132:133], v19 offset:0
    ds_read_b64_tr_b16 v[134:135], v19 offset:1024
    ds_read_b128 v[180:183], v41 offset:16384
    v_mfma_f32_16x16x32_bf16 v[96:99], v[144:147], v[176:179], v[96:99]
    ds_read_b128 v[184:187], v43 offset:16384
    v_mfma_f32_16x16x32_bf16 v[60:63], v[144:147], v[12:15], v[60:63]
    ds_read_b64_tr_b16 v[136:137], v19 offset:8192
    s_waitcnt lgkmcnt(11)
    v_mfma_f32_16x16x32_bf16 v[100:103], v[148:151], v[172:175], v[100:103]
    ds_read_b64_tr_b16 v[138:139], v19 offset:9216
    ds_read_b128 v[188:191], v40 offset:49152
    v_mfma_f32_16x16x32_bf16 v[104:107], v[148:151], v[176:179], v[104:107]
    ds_read_b128 v[192:195], v42 offset:49152
    v_mfma_f32_16x16x32_bf16 v[64:67], v[148:151], v[12:15], v[64:67]
    ds_read_b64_tr_b16 v[140:141], v19 offset:32768
    v_mfma_f32_16x16x32_bf16 v[108:111], v[152:155], v[172:175], v[108:111]
    ds_read_b64_tr_b16 v[142:143], v19 offset:33792
    ds_read_b128 v[196:199], v41 offset:49152
    v_mfma_f32_16x16x32_bf16 v[112:115], v[152:155], v[176:179], v[112:115]
    ds_read_b128 v[200:203], v43 offset:49152
    s_waitcnt lgkmcnt(14)
    v_mfma_f32_16x16x32_bf16 v[116:119], v[156:159], v[172:175], v[116:119]
    ds_read_b64_tr_b16 v[144:145], v19 offset:40960
    v_mfma_f32_16x16x32_bf16 v[120:123], v[156:159], v[176:179], v[120:123]
    ds_read_b64_tr_b16 v[146:147], v19 offset:41984
    v_mfma_f32_16x16x32_bf16 v[124:127], v[160:163], v[172:175], v[124:127]
    ds_read_b64_tr_b16 v[148:149], v20 offset:0
    v_mfma_f32_16x16x32_bf16 v[128:131], v[160:163], v[176:179], v[128:131]
    ds_read_b64_tr_b16 v[150:151], v20 offset:1024
    s_waitcnt lgkmcnt(10)
    v_mfma_f32_16x16x32_bf16 v[92:95], v[132:135], v[164:167], v[92:95]
    ds_read_b64_tr_b16 v[152:153], v20 offset:8192
    v_mfma_f32_16x16x32_bf16 v[96:99], v[132:135], v[168:171], v[96:99]
    ds_read_b64_tr_b16 v[154:155], v20 offset:9216
    v_mfma_f32_16x16x32_bf16 v[60:63], v[132:135], v[12:15], v[60:63]
    ds_read_b64_tr_b16 v[156:157], v20 offset:32768
    v_mfma_f32_16x16x32_bf16 v[92:95], v[136:139], v[180:183], v[92:95]
    ds_read_b64_tr_b16 v[158:159], v20 offset:33792
    v_mfma_f32_16x16x32_bf16 v[96:99], v[136:139], v[184:187], v[96:99]
    ds_read_b64_tr_b16 v[160:161], v20 offset:40960
    v_mfma_f32_16x16x32_bf16 v[60:63], v[136:139], v[12:15], v[60:63]
    ds_read_b64_tr_b16 v[162:163], v20 offset:41984
    s_waitcnt lgkmcnt(8)
    v_mfma_f32_16x16x32_bf16 v[92:95], v[140:143], v[188:191], v[92:95]
    ds_read_b64_tr_b16 v[132:133], v16 offset:0
    v_mfma_f32_16x16x32_bf16 v[96:99], v[140:143], v[192:195], v[96:99]
    ds_read_b64_tr_b16 v[134:135], v16 offset:1024
    v_mfma_f32_16x16x32_bf16 v[60:63], v[140:143], v[12:15], v[60:63]
    v_mfma_f32_16x16x32_bf16 v[92:95], v[144:147], v[196:199], v[92:95]
    ds_read_b64_tr_b16 v[136:137], v16 offset:8192
    v_mfma_f32_16x16x32_bf16 v[96:99], v[144:147], v[200:203], v[96:99]
    ds_read_b64_tr_b16 v[138:139], v16 offset:9216
    v_mfma_f32_16x16x32_bf16 v[60:63], v[144:147], v[12:15], v[60:63]
    s_waitcnt lgkmcnt(8)
    v_mfma_f32_16x16x32_bf16 v[100:103], v[148:151], v[164:167], v[100:103]
    ds_read_b64_tr_b16 v[140:141], v16 offset:32768
    v_mfma_f32_16x16x32_bf16 v[104:107], v[148:151], v[168:171], v[104:107]
    ds_read_b64_tr_b16 v[142:143], v16 offset:33792
    v_mfma_f32_16x16x32_bf16 v[64:67], v[148:151], v[12:15], v[64:67]
    v_mfma_f32_16x16x32_bf16 v[100:103], v[152:155], v[180:183], v[100:103]
    ds_read_b64_tr_b16 v[144:145], v16 offset:40960
    v_mfma_f32_16x16x32_bf16 v[104:107], v[152:155], v[184:187], v[104:107]
    ds_read_b64_tr_b16 v[146:147], v16 offset:41984
    v_mfma_f32_16x16x32_bf16 v[64:67], v[152:155], v[12:15], v[64:67]
    s_waitcnt lgkmcnt(8)
    v_mfma_f32_16x16x32_bf16 v[100:103], v[156:159], v[188:191], v[100:103]
    ds_read_b64_tr_b16 v[148:149], v17 offset:0
    v_mfma_f32_16x16x32_bf16 v[104:107], v[156:159], v[192:195], v[104:107]
    ds_read_b64_tr_b16 v[150:151], v17 offset:1024
    v_mfma_f32_16x16x32_bf16 v[64:67], v[156:159], v[12:15], v[64:67]
    v_mfma_f32_16x16x32_bf16 v[100:103], v[160:163], v[196:199], v[100:103]
    ds_read_b64_tr_b16 v[152:153], v17 offset:8192
    v_mfma_f32_16x16x32_bf16 v[104:107], v[160:163], v[200:203], v[104:107]
    ds_read_b64_tr_b16 v[154:155], v17 offset:9216
    v_mfma_f32_16x16x32_bf16 v[64:67], v[160:163], v[12:15], v[64:67]
    s_waitcnt lgkmcnt(8)
    v_mfma_f32_16x16x32_bf16 v[68:71], v[132:135], v[164:167], v[68:71]
    ds_read_b64_tr_b16 v[156:157], v17 offset:32768
    v_mfma_f32_16x16x32_bf16 v[72:75], v[132:135], v[168:171], v[72:75]
    ds_read_b64_tr_b16 v[158:159], v17 offset:33792
    v_mfma_f32_16x16x32_bf16 v[68:71], v[136:139], v[180:183], v[68:71]
    ds_read_b64_tr_b16 v[160:161], v17 offset:40960
    v_mfma_f32_16x16x32_bf16 v[72:75], v[136:139], v[184:187], v[72:75]
    ds_read_b64_tr_b16 v[162:163], v17 offset:41984
    s_waitcnt lgkmcnt(8)
    v_mfma_f32_16x16x32_bf16 v[68:71], v[140:143], v[188:191], v[68:71]
    ds_read_b64_tr_b16 v[132:133], v18 offset:0
    v_mfma_f32_16x16x32_bf16 v[72:75], v[140:143], v[192:195], v[72:75]
    ds_read_b64_tr_b16 v[134:135], v18 offset:1024
    s_lshl_b32 s27, s40, 7
    s_add_u32 s27, s27, 139264
    v_lshl_add_u32 v4, v2, 4, s27
    v_xor_b32 v5, 192, v4
    ds_write_b128 v5, v[60:63] offset:0
    v_xor_b32 v5, 256, v4
    ds_write_b128 v5, v[64:67] offset:0
    s_waitcnt vmcnt(0) lgkmcnt(0)
    s_barrier
    v_xor_b32 v5, 192, v4
    ds_read_b128 v[216:219], v5 offset:0
    v_xor_b32 v5, 256, v4
    ds_read_b128 v[220:223], v5 offset:0
    v_xor_b32 v5, 0, v4
    ds_read_b128 v[204:207], v5 offset:0
    v_xor_b32 v5, 64, v4
    ds_read_b128 v[208:211], v5 offset:0
    v_xor_b32 v5, 128, v4
    ds_read_b128 v[212:215], v5 offset:0
    v_xor_b32 v5, 320, v4
    ds_read_b128 v[224:227], v5 offset:0
    v_xor_b32 v5, 384, v4
    ds_read_b128 v[228:231], v5 offset:0
    v_xor_b32 v5, 448, v4
    ds_read_b128 v[232:235], v5 offset:0
    v_mul_f32 v238, s28, v238
    v_mul_f32 v239, s28, v239
    v_mfma_f32_16x16x32_bf16 v[68:71], v[144:147], v[196:199], v[68:71]
    ds_read_b64_tr_b16 v[136:137], v18 offset:8192
    v_mfma_f32_16x16x32_bf16 v[72:75], v[144:147], v[200:203], v[72:75]
    ds_read_b64_tr_b16 v[138:139], v18 offset:9216
    s_waitcnt lgkmcnt(15)
    v_mfma_f32_16x16x32_bf16 v[76:79], v[148:151], v[164:167], v[76:79]
    ds_read_b64_tr_b16 v[140:141], v18 offset:32768
    v_mfma_f32_16x16x32_bf16 v[80:83], v[148:151], v[168:171], v[80:83]
    ds_read_b64_tr_b16 v[142:143], v18 offset:33792
    v_mfma_f32_16x16x32_bf16 v[76:79], v[152:155], v[180:183], v[76:79]
    ds_read_b64_tr_b16 v[144:145], v18 offset:40960
    v_mfma_f32_16x16x32_bf16 v[80:83], v[152:155], v[184:187], v[80:83]
    ds_read_b64_tr_b16 v[146:147], v18 offset:41984
    s_waitcnt lgkmcnt(6)
    v_pk_fma_f32 v[92:93], v[216:217], v[236:237], v[92:93] op_sel:[0,0,0] op_sel_hi:[1,0,1]
    v_pk_fma_f32 v[94:95], v[218:219], v[236:237], v[94:95] op_sel:[0,0,0] op_sel_hi:[1,0,1]
    v_pk_fma_f32 v[96:97], v[216:217], v[236:237], v[96:97] op_sel:[0,1,0] op_sel_hi:[1,1,1]
    v_pk_fma_f32 v[98:99], v[218:219], v[236:237], v[98:99] op_sel:[0,1,0] op_sel_hi:[1,1,1]
    v_pk_mul_f32 v[92:93], v[92:93], v[238:239] op_sel:[0,0] op_sel_hi:[1,0]
    v_pk_mul_f32 v[94:95], v[94:95], v[238:239] op_sel:[0,0] op_sel_hi:[1,0]
    v_pk_mul_f32 v[96:97], v[96:97], v[238:239] op_sel:[0,1] op_sel_hi:[1,1]
    v_pk_mul_f32 v[98:99], v[98:99], v[238:239] op_sel:[0,1] op_sel_hi:[1,1]
    v_cvt_pk_bf16_f32 v92, v92, v93
    v_cvt_pk_bf16_f32 v93, v94, v95
    v_cvt_pk_bf16_f32 v94, v96, v97
    v_cvt_pk_bf16_f32 v95, v98, v99
    buffer_store_dwordx4 v[92:95], v55, s[20:23], 0 offen sc1
    s_waitcnt lgkmcnt(15)
    v_mfma_f32_16x16x32_bf16 v[76:79], v[156:159], v[188:191], v[76:79]
    ds_read_b64_tr_b16 v[148:149], v21 offset:0
    v_mfma_f32_16x16x32_bf16 v[80:83], v[156:159], v[192:195], v[80:83]
    ds_read_b64_tr_b16 v[150:151], v21 offset:1024
    v_mfma_f32_16x16x32_bf16 v[76:79], v[160:163], v[196:199], v[76:79]
    ds_read_b64_tr_b16 v[152:153], v21 offset:8192
    v_mfma_f32_16x16x32_bf16 v[80:83], v[160:163], v[200:203], v[80:83]
    ds_read_b64_tr_b16 v[154:155], v21 offset:9216
    s_waitcnt lgkmcnt(8)
    v_mfma_f32_16x16x32_bf16 v[84:87], v[132:135], v[164:167], v[84:87]
    ds_read_b64_tr_b16 v[156:157], v21 offset:32768
    v_mfma_f32_16x16x32_bf16 v[88:91], v[132:135], v[168:171], v[88:91]
    ds_read_b64_tr_b16 v[158:159], v21 offset:33792
    v_pk_fma_f32 v[100:101], v[220:221], v[236:237], v[100:101] op_sel:[0,0,0] op_sel_hi:[1,0,1]
    v_pk_fma_f32 v[102:103], v[222:223], v[236:237], v[102:103] op_sel:[0,0,0] op_sel_hi:[1,0,1]
    v_pk_fma_f32 v[104:105], v[220:221], v[236:237], v[104:105] op_sel:[0,1,0] op_sel_hi:[1,1,1]
    v_pk_fma_f32 v[106:107], v[222:223], v[236:237], v[106:107] op_sel:[0,1,0] op_sel_hi:[1,1,1]
    v_pk_mul_f32 v[100:101], v[100:101], v[238:239] op_sel:[0,0] op_sel_hi:[1,0]
    v_pk_mul_f32 v[102:103], v[102:103], v[238:239] op_sel:[0,0] op_sel_hi:[1,0]
    v_pk_mul_f32 v[104:105], v[104:105], v[238:239] op_sel:[0,1] op_sel_hi:[1,1]
    v_pk_mul_f32 v[106:107], v[106:107], v[238:239] op_sel:[0,1] op_sel_hi:[1,1]
    v_cvt_pk_bf16_f32 v100, v100, v101
    v_cvt_pk_bf16_f32 v101, v102, v103
    v_cvt_pk_bf16_f32 v102, v104, v105
    v_cvt_pk_bf16_f32 v103, v106, v107
    buffer_store_dwordx4 v[100:103], v56, s[20:23], 0 offen sc1
    v_mfma_f32_16x16x32_bf16 v[84:87], v[136:139], v[180:183], v[84:87]
    ds_read_b64_tr_b16 v[160:161], v21 offset:40960
    v_mfma_f32_16x16x32_bf16 v[88:91], v[136:139], v[184:187], v[88:91]
    ds_read_b64_tr_b16 v[162:163], v21 offset:41984
    s_waitcnt lgkmcnt(8)
    v_mfma_f32_16x16x32_bf16 v[84:87], v[140:143], v[188:191], v[84:87]
    ds_read_b64_tr_b16 v[132:133], v22 offset:0
    v_mfma_f32_16x16x32_bf16 v[88:91], v[140:143], v[192:195], v[88:91]
    ds_read_b64_tr_b16 v[134:135], v22 offset:1024
    v_mfma_f32_16x16x32_bf16 v[84:87], v[144:147], v[196:199], v[84:87]
    ds_read_b64_tr_b16 v[136:137], v22 offset:8192
    v_mfma_f32_16x16x32_bf16 v[88:91], v[144:147], v[200:203], v[88:91]
    ds_read_b64_tr_b16 v[138:139], v22 offset:9216
    v_pk_fma_f32 v[68:69], v[204:205], v[236:237], v[68:69] op_sel:[0,0,0] op_sel_hi:[1,0,1]
    v_pk_fma_f32 v[70:71], v[206:207], v[236:237], v[70:71] op_sel:[0,0,0] op_sel_hi:[1,0,1]
    v_pk_fma_f32 v[72:73], v[204:205], v[236:237], v[72:73] op_sel:[0,1,0] op_sel_hi:[1,1,1]
    v_pk_fma_f32 v[74:75], v[206:207], v[236:237], v[74:75] op_sel:[0,1,0] op_sel_hi:[1,1,1]
    v_pk_mul_f32 v[68:69], v[68:69], v[238:239] op_sel:[0,0] op_sel_hi:[1,0]
    v_pk_mul_f32 v[70:71], v[70:71], v[238:239] op_sel:[0,0] op_sel_hi:[1,0]
    v_pk_mul_f32 v[72:73], v[72:73], v[238:239] op_sel:[0,1] op_sel_hi:[1,1]
    v_pk_mul_f32 v[74:75], v[74:75], v[238:239] op_sel:[0,1] op_sel_hi:[1,1]
    v_cvt_pk_bf16_f32 v68, v68, v69
    v_cvt_pk_bf16_f32 v69, v70, v71
    v_cvt_pk_bf16_f32 v70, v72, v73
    v_cvt_pk_bf16_f32 v71, v74, v75
    buffer_store_dwordx4 v[68:71], v52, s[20:23], 0 offen sc1
    s_waitcnt lgkmcnt(8)
    v_mfma_f32_16x16x32_bf16 v[108:111], v[148:151], v[164:167], v[108:111]
    ds_read_b64_tr_b16 v[140:141], v22 offset:32768
    v_mfma_f32_16x16x32_bf16 v[112:115], v[148:151], v[168:171], v[112:115]
    ds_read_b64_tr_b16 v[142:143], v22 offset:33792
    v_mfma_f32_16x16x32_bf16 v[108:111], v[152:155], v[180:183], v[108:111]
    ds_read_b64_tr_b16 v[144:145], v22 offset:40960
    v_mfma_f32_16x16x32_bf16 v[112:115], v[152:155], v[184:187], v[112:115]
    ds_read_b64_tr_b16 v[146:147], v22 offset:41984
    s_waitcnt lgkmcnt(8)
    v_mfma_f32_16x16x32_bf16 v[108:111], v[156:159], v[188:191], v[108:111]
    ds_read_b64_tr_b16 v[148:149], v23 offset:0
    v_mfma_f32_16x16x32_bf16 v[112:115], v[156:159], v[192:195], v[112:115]
    ds_read_b64_tr_b16 v[150:151], v23 offset:1024
    v_pk_fma_f32 v[76:77], v[208:209], v[236:237], v[76:77] op_sel:[0,0,0] op_sel_hi:[1,0,1]
    v_pk_fma_f32 v[78:79], v[210:211], v[236:237], v[78:79] op_sel:[0,0,0] op_sel_hi:[1,0,1]
    v_pk_fma_f32 v[80:81], v[208:209], v[236:237], v[80:81] op_sel:[0,1,0] op_sel_hi:[1,1,1]
    v_pk_fma_f32 v[82:83], v[210:211], v[236:237], v[82:83] op_sel:[0,1,0] op_sel_hi:[1,1,1]
    v_pk_mul_f32 v[76:77], v[76:77], v[238:239] op_sel:[0,0] op_sel_hi:[1,0]
    v_pk_mul_f32 v[78:79], v[78:79], v[238:239] op_sel:[0,0] op_sel_hi:[1,0]
    v_pk_mul_f32 v[80:81], v[80:81], v[238:239] op_sel:[0,1] op_sel_hi:[1,1]
    v_pk_mul_f32 v[82:83], v[82:83], v[238:239] op_sel:[0,1] op_sel_hi:[1,1]
    v_cvt_pk_bf16_f32 v76, v76, v77
    v_cvt_pk_bf16_f32 v77, v78, v79
    v_cvt_pk_bf16_f32 v78, v80, v81
    v_cvt_pk_bf16_f32 v79, v82, v83
    buffer_store_dwordx4 v[76:79], v53, s[20:23], 0 offen sc1
    v_mfma_f32_16x16x32_bf16 v[108:111], v[160:163], v[196:199], v[108:111]
    ds_read_b64_tr_b16 v[152:153], v23 offset:8192
    v_mfma_f32_16x16x32_bf16 v[112:115], v[160:163], v[200:203], v[112:115]
    ds_read_b64_tr_b16 v[154:155], v23 offset:9216
    s_waitcnt lgkmcnt(8)
    v_mfma_f32_16x16x32_bf16 v[116:119], v[132:135], v[164:167], v[116:119]
    ds_read_b64_tr_b16 v[156:157], v23 offset:32768
    v_mfma_f32_16x16x32_bf16 v[120:123], v[132:135], v[168:171], v[120:123]
    ds_read_b64_tr_b16 v[158:159], v23 offset:33792
    v_mfma_f32_16x16x32_bf16 v[116:119], v[136:139], v[180:183], v[116:119]
    ds_read_b64_tr_b16 v[160:161], v23 offset:40960
    v_mfma_f32_16x16x32_bf16 v[120:123], v[136:139], v[184:187], v[120:123]
    ds_read_b64_tr_b16 v[162:163], v23 offset:41984
    v_pk_fma_f32 v[84:85], v[212:213], v[236:237], v[84:85] op_sel:[0,0,0] op_sel_hi:[1,0,1]
    v_pk_fma_f32 v[86:87], v[214:215], v[236:237], v[86:87] op_sel:[0,0,0] op_sel_hi:[1,0,1]
    v_pk_fma_f32 v[88:89], v[212:213], v[236:237], v[88:89] op_sel:[0,1,0] op_sel_hi:[1,1,1]
    v_pk_fma_f32 v[90:91], v[214:215], v[236:237], v[90:91] op_sel:[0,1,0] op_sel_hi:[1,1,1]
    v_pk_mul_f32 v[84:85], v[84:85], v[238:239] op_sel:[0,0] op_sel_hi:[1,0]
    v_pk_mul_f32 v[86:87], v[86:87], v[238:239] op_sel:[0,0] op_sel_hi:[1,0]
    v_pk_mul_f32 v[88:89], v[88:89], v[238:239] op_sel:[0,1] op_sel_hi:[1,1]
    v_pk_mul_f32 v[90:91], v[90:91], v[238:239] op_sel:[0,1] op_sel_hi:[1,1]
    v_cvt_pk_bf16_f32 v84, v84, v85
    v_cvt_pk_bf16_f32 v85, v86, v87
    v_cvt_pk_bf16_f32 v86, v88, v89
    v_cvt_pk_bf16_f32 v87, v90, v91
    buffer_store_dwordx4 v[84:87], v54, s[20:23], 0 offen sc1
    s_waitcnt lgkmcnt(8)
    v_mfma_f32_16x16x32_bf16 v[116:119], v[140:143], v[188:191], v[116:119]
    v_mfma_f32_16x16x32_bf16 v[120:123], v[140:143], v[192:195], v[120:123]
    v_mfma_f32_16x16x32_bf16 v[116:119], v[144:147], v[196:199], v[116:119]
    v_mfma_f32_16x16x32_bf16 v[120:123], v[144:147], v[200:203], v[120:123]
    s_waitcnt lgkmcnt(4)
    v_mfma_f32_16x16x32_bf16 v[124:127], v[148:151], v[164:167], v[124:127]
    v_mfma_f32_16x16x32_bf16 v[128:131], v[148:151], v[168:171], v[128:131]
    v_pk_fma_f32 v[108:109], v[224:225], v[236:237], v[108:109] op_sel:[0,0,0] op_sel_hi:[1,0,1]
    v_pk_fma_f32 v[110:111], v[226:227], v[236:237], v[110:111] op_sel:[0,0,0] op_sel_hi:[1,0,1]
    v_pk_fma_f32 v[112:113], v[224:225], v[236:237], v[112:113] op_sel:[0,1,0] op_sel_hi:[1,1,1]
    v_pk_fma_f32 v[114:115], v[226:227], v[236:237], v[114:115] op_sel:[0,1,0] op_sel_hi:[1,1,1]
    v_pk_mul_f32 v[108:109], v[108:109], v[238:239] op_sel:[0,0] op_sel_hi:[1,0]
    v_pk_mul_f32 v[110:111], v[110:111], v[238:239] op_sel:[0,0] op_sel_hi:[1,0]
    v_pk_mul_f32 v[112:113], v[112:113], v[238:239] op_sel:[0,1] op_sel_hi:[1,1]
    v_pk_mul_f32 v[114:115], v[114:115], v[238:239] op_sel:[0,1] op_sel_hi:[1,1]
    v_cvt_pk_bf16_f32 v108, v108, v109
    v_cvt_pk_bf16_f32 v109, v110, v111
    v_cvt_pk_bf16_f32 v110, v112, v113
    v_cvt_pk_bf16_f32 v111, v114, v115
    buffer_store_dwordx4 v[108:111], v57, s[20:23], 0 offen sc1
    v_mfma_f32_16x16x32_bf16 v[124:127], v[152:155], v[180:183], v[124:127]
    v_mfma_f32_16x16x32_bf16 v[128:131], v[152:155], v[184:187], v[128:131]
    s_waitcnt lgkmcnt(0)
    v_mfma_f32_16x16x32_bf16 v[124:127], v[156:159], v[188:191], v[124:127]
    v_mfma_f32_16x16x32_bf16 v[128:131], v[156:159], v[192:195], v[128:131]
    v_mfma_f32_16x16x32_bf16 v[124:127], v[160:163], v[196:199], v[124:127]
    v_mfma_f32_16x16x32_bf16 v[128:131], v[160:163], v[200:203], v[128:131]
    v_pk_fma_f32 v[116:117], v[228:229], v[236:237], v[116:117] op_sel:[0,0,0] op_sel_hi:[1,0,1]
    v_pk_fma_f32 v[118:119], v[230:231], v[236:237], v[118:119] op_sel:[0,0,0] op_sel_hi:[1,0,1]
    v_pk_fma_f32 v[120:121], v[228:229], v[236:237], v[120:121] op_sel:[0,1,0] op_sel_hi:[1,1,1]
    v_pk_fma_f32 v[122:123], v[230:231], v[236:237], v[122:123] op_sel:[0,1,0] op_sel_hi:[1,1,1]
    v_pk_mul_f32 v[116:117], v[116:117], v[238:239] op_sel:[0,0] op_sel_hi:[1,0]
    v_pk_mul_f32 v[118:119], v[118:119], v[238:239] op_sel:[0,0] op_sel_hi:[1,0]
    v_pk_mul_f32 v[120:121], v[120:121], v[238:239] op_sel:[0,1] op_sel_hi:[1,1]
    v_pk_mul_f32 v[122:123], v[122:123], v[238:239] op_sel:[0,1] op_sel_hi:[1,1]
    v_cvt_pk_bf16_f32 v116, v116, v117
    v_cvt_pk_bf16_f32 v117, v118, v119
    v_cvt_pk_bf16_f32 v118, v120, v121
    v_cvt_pk_bf16_f32 v119, v122, v123
    buffer_store_dwordx4 v[116:119], v58, s[20:23], 0 offen sc1
    s_nop 7
    v_pk_fma_f32 v[124:125], v[232:233], v[236:237], v[124:125] op_sel:[0,0,0] op_sel_hi:[1,0,1]
    v_pk_fma_f32 v[126:127], v[234:235], v[236:237], v[126:127] op_sel:[0,0,0] op_sel_hi:[1,0,1]
    v_pk_fma_f32 v[128:129], v[232:233], v[236:237], v[128:129] op_sel:[0,1,0] op_sel_hi:[1,1,1]
    v_pk_fma_f32 v[130:131], v[234:235], v[236:237], v[130:131] op_sel:[0,1,0] op_sel_hi:[1,1,1]
    v_pk_mul_f32 v[124:125], v[124:125], v[238:239] op_sel:[0,0] op_sel_hi:[1,0]
    v_pk_mul_f32 v[126:127], v[126:127], v[238:239] op_sel:[0,0] op_sel_hi:[1,0]
    v_pk_mul_f32 v[128:129], v[128:129], v[238:239] op_sel:[0,1] op_sel_hi:[1,1]
    v_pk_mul_f32 v[130:131], v[130:131], v[238:239] op_sel:[0,1] op_sel_hi:[1,1]
    v_cvt_pk_bf16_f32 v124, v124, v125
    v_cvt_pk_bf16_f32 v125, v126, v127
    v_cvt_pk_bf16_f32 v126, v128, v129
    v_cvt_pk_bf16_f32 v127, v130, v131
    buffer_store_dwordx4 v[124:127], v59, s[20:23], 0 offen sc1
    s_lshl_b32 s68, s25, 4
    s_add_u32 s68, s68, s24
    s_lshl_b32 s68, s68, 7
    s_add_u32 s68, s68, 32611456
    s_branch L_m_entry
    s_endpgm
L_p1_vpath:
    s_mul_i32 s35, s24, 10240
    s_mul_i32 s27, s40, 1280
    s_add_u32 s35, s35, s27
    s_add_u32 s35, s35, 87040
    v_mul_u32_u24 v8, 320, v2
    v_add_u32 v8, s35, v8
    s_mov_b32 s37, 245760
    s_lshl_b32 s27, s34, 7
    s_xor_b32 s29, s41, 0
    s_lshl_b32 s29, s29, 4
    s_add_u32 s29, s29, s27
    v_add_u32 v6, s29, v3
    v_mul_u32_u24 v7, 3277, v6
    v_lshrrev_b32 v7, 16, v7
    v_mul_u32_u24 v9, 20, v7
    v_sub_u32 v6, v6, v9
    v_mul_lo_u32 v7, v7, s37
    v_lshl_add_u32 v6, v6, 4, v8
    v_add_u32 v52, v6, v7
    s_xor_b32 s29, s41, 1
    s_lshl_b32 s29, s29, 4
    s_add_u32 s29, s29, s27
    v_add_u32 v6, s29, v3
    v_mul_u32_u24 v7, 3277, v6
    v_lshrrev_b32 v7, 16, v7
    v_mul_u32_u24 v9, 20, v7
    v_sub_u32 v6, v6, v9
    v_mul_lo_u32 v7, v7, s37
    v_lshl_add_u32 v6, v6, 4, v8
    v_add_u32 v53, v6, v7
    s_xor_b32 s29, s41, 2
    s_lshl_b32 s29, s29, 4
    s_add_u32 s29, s29, s27
    v_add_u32 v6, s29, v3
    v_mul_u32_u24 v7, 3277, v6
    v_lshrrev_b32 v7, 16, v7
    v_mul_u32_u24 v9, 20, v7
    v_sub_u32 v6, v6, v9
    v_mul_lo_u32 v7, v7, s37
    v_lshl_add_u32 v6, v6, 4, v8
    v_add_u32 v54, v6, v7
    s_xor_b32 s29, s41, 3
    s_lshl_b32 s29, s29, 4
    s_add_u32 s29, s29, s27
    v_add_u32 v6, s29, v3
    v_mul_u32_u24 v7, 3277, v6
    v_lshrrev_b32 v7, 16, v7
    v_mul_u32_u24 v9, 20, v7
    v_sub_u32 v6, v6, v9
    v_mul_lo_u32 v7, v7, s37
    v_lshl_add_u32 v6, v6, 4, v8
    v_add_u32 v55, v6, v7
    s_xor_b32 s29, s41, 4
    s_lshl_b32 s29, s29, 4
    s_add_u32 s29, s29, s27
    v_add_u32 v6, s29, v3
    v_mul_u32_u24 v7, 3277, v6
    v_lshrrev_b32 v7, 16, v7
    v_mul_u32_u24 v9, 20, v7
    v_sub_u32 v6, v6, v9
    v_mul_lo_u32 v7, v7, s37
    v_lshl_add_u32 v6, v6, 4, v8
    v_add_u32 v56, v6, v7
    s_xor_b32 s29, s41, 5
    s_lshl_b32 s29, s29, 4
    s_add_u32 s29, s29, s27
    v_add_u32 v6, s29, v3
    v_mul_u32_u24 v7, 3277, v6
    v_lshrrev_b32 v7, 16, v7
    v_mul_u32_u24 v9, 20, v7
    v_sub_u32 v6, v6, v9
    v_mul_lo_u32 v7, v7, s37
    v_lshl_add_u32 v6, v6, 4, v8
    v_add_u32 v57, v6, v7
    s_xor_b32 s29, s41, 6
    s_lshl_b32 s29, s29, 4
    s_add_u32 s29, s29, s27
    v_add_u32 v6, s29, v3
    v_mul_u32_u24 v7, 3277, v6
    v_lshrrev_b32 v7, 16, v7
    v_mul_u32_u24 v9, 20, v7
    v_sub_u32 v6, v6, v9
    v_mul_lo_u32 v7, v7, s37
    v_lshl_add_u32 v6, v6, 4, v8
    v_add_u32 v58, v6, v7
    s_xor_b32 s29, s41, 7
    s_lshl_b32 s29, s29, 4
    s_add_u32 s29, s29, s27
    v_add_u32 v6, s29, v3
    v_mul_u32_u24 v7, 3277, v6
    v_lshrrev_b32 v7, 16, v7
    v_mul_u32_u24 v9, 20, v7
    v_sub_u32 v6, v6, v9
    v_mul_lo_u32 v7, v7, s37
    v_lshl_add_u32 v6, v6, 4, v8
    v_add_u32 v59, v6, v7
    s_barrier
    ds_read_b128 v[164:167], v48 offset:16384
    ds_read_b128 v[168:171], v50 offset:16384
    ds_read_b64_tr_b16 v[132:133], v32 offset:0
    ds_read_b64_tr_b16 v[134:135], v32 offset:1024
    ds_read_b64_tr_b16 v[136:137], v33 offset:0
    ds_read_b64_tr_b16 v[138:139], v33 offset:1024
    ds_read_b64_tr_b16 v[140:141], v34 offset:0
    ds_read_b64_tr_b16 v[142:143], v34 offset:1024
    ds_read_b64_tr_b16 v[144:145], v35 offset:0
    ds_read_b64_tr_b16 v[146:147], v35 offset:1024
    ds_read_b64_tr_b16 v[148:149], v36 offset:0
    ds_read_b64_tr_b16 v[150:151], v36 offset:1024
    ds_read_b64_tr_b16 v[152:153], v37 offset:0
    ds_read_b64_tr_b16 v[154:155], v37 offset:1024
    s_waitcnt lgkmcnt(8)
    v_mfma_f32_16x16x32_bf16 v[68:71], v[164:167], v[132:135], 0
    ds_read_b64_tr_b16 v[156:157], v38 offset:0
    v_mfma_f32_16x16x32_bf16 v[72:75], v[168:171], v[132:135], 0
    ds_read_b64_tr_b16 v[158:159], v38 offset:1024
    v_mfma_f32_16x16x32_bf16 v[76:79], v[164:167], v[136:139], 0
    ds_read_b64_tr_b16 v[160:161], v39 offset:0
    v_mfma_f32_16x16x32_bf16 v[80:83], v[168:171], v[136:139], 0
    ds_read_b64_tr_b16 v[162:163], v39 offset:1024
    s_waitcnt lgkmcnt(8)
    v_mfma_f32_16x16x32_bf16 v[84:87], v[164:167], v[140:143], 0
    ds_read_b128 v[172:175], v49 offset:16384
    v_mfma_f32_16x16x32_bf16 v[88:91], v[168:171], v[140:143], 0
    ds_read_b128 v[176:179], v51 offset:16384
    v_mfma_f32_16x16x32_bf16 v[92:95], v[164:167], v[144:147], 0
    ds_read_b64_tr_b16 v[132:133], v32 offset:8192
    v_mfma_f32_16x16x32_bf16 v[96:99], v[168:171], v[144:147], 0
    ds_read_b64_tr_b16 v[134:135], v32 offset:9216
    v_mfma_f32_16x16x32_bf16 v[60:63], v[144:147], v[12:15], 0
    ds_read_b64_tr_b16 v[136:137], v33 offset:8192
    s_waitcnt lgkmcnt(9)
    v_mfma_f32_16x16x32_bf16 v[100:103], v[164:167], v[148:151], 0
    ds_read_b64_tr_b16 v[138:139], v33 offset:9216
    v_mfma_f32_16x16x32_bf16 v[104:107], v[168:171], v[148:151], 0
    ds_read_b64_tr_b16 v[140:141], v34 offset:8192
    v_mfma_f32_16x16x32_bf16 v[64:67], v[148:151], v[12:15], 0
    ds_read_b64_tr_b16 v[142:143], v34 offset:9216
    v_mfma_f32_16x16x32_bf16 v[108:111], v[164:167], v[152:155], 0
    ds_read_b64_tr_b16 v[144:145], v35 offset:8192
    v_mfma_f32_16x16x32_bf16 v[112:115], v[168:171], v[152:155], 0
    ds_read_b64_tr_b16 v[146:147], v35 offset:9216
    s_waitcnt lgkmcnt(10)
    v_mfma_f32_16x16x32_bf16 v[116:119], v[164:167], v[156:159], 0
    ds_read_b64_tr_b16 v[148:149], v36 offset:8192
    v_mfma_f32_16x16x32_bf16 v[120:123], v[168:171], v[156:159], 0
    ds_read_b64_tr_b16 v[150:151], v36 offset:9216
    v_mfma_f32_16x16x32_bf16 v[124:127], v[164:167], v[160:163], 0
    ds_read_b64_tr_b16 v[152:153], v37 offset:8192
    v_mfma_f32_16x16x32_bf16 v[128:131], v[168:171], v[160:163], 0
    ds_read_b64_tr_b16 v[154:155], v37 offset:9216
    s_waitcnt lgkmcnt(8)
    v_mfma_f32_16x16x32_bf16 v[68:71], v[172:175], v[132:135], v[68:71]
    ds_read_b64_tr_b16 v[156:157], v38 offset:8192
    v_mfma_f32_16x16x32_bf16 v[72:75], v[176:179], v[132:135], v[72:75]
    ds_read_b64_tr_b16 v[158:159], v38 offset:9216
    v_mov_b32 v228, 0x3f803f80
    s_waitcnt vmcnt(3)
    v_dot2_f32_bf16 v224, v212, v228, 0
    v_dot2_f32_bf16 v225, v212, v212, 0
    v_dot2_f32_bf16 v224, v213, v228, v224
    v_dot2_f32_bf16 v225, v213, v213, v225
    v_dot2_f32_bf16 v224, v214, v228, v224
    v_dot2_f32_bf16 v225, v214, v214, v225
    v_dot2_f32_bf16 v224, v215, v228, v224
    v_dot2_f32_bf16 v225, v215, v215, v225
    v_dot2_f32_bf16 v224, v216, v228, v224
    v_dot2_f32_bf16 v225, v216, v216, v225
    v_dot2_f32_bf16 v224, v217, v228, v224
    v_dot2_f32_bf16 v225, v217, v217, v225
    v_dot2_f32_bf16 v224, v218, v228, v224
    v_dot2_f32_bf16 v225, v218, v218, v225
    v_dot2_f32_bf16 v224, v219, v228, v224
    v_dot2_f32_bf16 v225, v219, v219, v225
    v_dot2_f32_bf16 v224, v220, v228, v224
    v_dot2_f32_bf16 v225, v220, v220, v225
    v_dot2_f32_bf16 v224, v221, v228, v224
    v_dot2_f32_bf16 v225, v221, v221, v225
    v_dot2_f32_bf16 v224, v222, v228, v224
    v_dot2_f32_bf16 v225, v222, v222, v225
    v_dot2_f32_bf16 v224, v223, v228, v224
    v_dot2_f32_bf16 v225, v223, v223, v225
    s_lshl_b32 s27, s24, 2
    buffer_load_dword v228, off, s[60:63], s27 sc1
    s_nop 0
    v_add_f32_dpp v224, v224, v224 row_ror:8 row_mask:0xf bank_mask:0xf
    v_add_f32_dpp v225, v225, v225 row_ror:8 row_mask:0xf bank_mask:0xf
    s_nop 0
    v_add_f32_dpp v224, v224, v224 row_ror:4 row_mask:0xf bank_mask:0xf
    v_add_f32_dpp v225, v225, v225 row_ror:4 row_mask:0xf bank_mask:0xf
    s_nop 0
    v_add_f32_dpp v224, v224, v224 row_ror:2 row_mask:0xf bank_mask:0xf
    v_add_f32_dpp v225, v225, v225 row_ror:2 row_mask:0xf bank_mask:0xf
    s_nop 0
    v_add_f32_dpp v224, v224, v224 row_ror:1 row_mask:0xf bank_mask:0xf
    v_add_f32_dpp v225, v225, v225 row_ror:1 row_mask:0xf bank_mask:0xf
    s_nop 0
    v_mov_b32 v226, v224
    v_mov_b32 v227, v225
    s_nop 1
    v_permlane16_swap_b32 v224, v226
    v_permlane16_swap_b32 v225, v227
    v_add_f32 v224, v224, v226
    v_add_f32 v225, v225, v227
    v_mul_f32 v224, 0xbacccccd, v224
    v_mul_f32 v225, 0x3acccccd, v225
    v_fma_f32 v225, -v224, v224, v225
    v_max_f32 v225, 0, v225
    v_add_f32 v225, 0x3727c5ac, v225
    v_rsq_f32 v225, v225
    s_lshl_b32 s27, s66, 3
    s_add_u32 s67, s27, 8192
    s_mov_b32 exec_lo, 1
    s_mov_b32 exec_hi, 1
    buffer_store_dword v224, v229, s[56:59], s27 offen sc1
    buffer_store_dword v225, v229, s[56:59], s67 offen sc1
    s_mov_b64 exec, -1
    v_mfma_f32_16x16x32_bf16 v[76:79], v[172:175], v[136:139], v[76:79]
    ds_read_b64_tr_b16 v[160:161], v39 offset:8192
    v_mfma_f32_16x16x32_bf16 v[80:83], v[176:179], v[136:139], v[80:83]
    ds_read_b64_tr_b16 v[162:163], v39 offset:9216
    s_waitcnt lgkmcnt(8)
    v_mfma_f32_16x16x32_bf16 v[84:87], v[172:175], v[140:143], v[84:87]
    s_barrier
    ds_read_b128 v[164:167], v44 offset:49152
    v_mfma_f32_16x16x32_bf16 v[88:91], v[176:179], v[140:143], v[88:91]
    ds_read_b128 v[168:171], v46 offset:49152
    v_mfma_f32_16x16x32_bf16 v[92:95], v[172:175], v[144:147], v[92:95]
    ds_read_b64_tr_b16 v[132:133], v24 offset:32768
    v_mfma_f32_16x16x32_bf16 v[96:99], v[176:179], v[144:147], v[96:99]
    ds_read_b64_tr_b16 v[134:135], v24 offset:33792
    v_mfma_f32_16x16x32_bf16 v[60:63], v[144:147], v[12:15], v[60:63]
    ds_read_b64_tr_b16 v[136:137], v25 offset:32768
    s_waitcnt lgkmcnt(9)
    v_mfma_f32_16x16x32_bf16 v[100:103], v[172:175], v[148:151], v[100:103]
    ds_read_b64_tr_b16 v[138:139], v25 offset:33792
    v_mfma_f32_16x16x32_bf16 v[104:107], v[176:179], v[148:151], v[104:107]
    ds_read_b64_tr_b16 v[140:141], v26 offset:32768
    v_mfma_f32_16x16x32_bf16 v[64:67], v[148:151], v[12:15], v[64:67]
    ds_read_b64_tr_b16 v[142:143], v26 offset:33792
    v_mfma_f32_16x16x32_bf16 v[108:111], v[172:175], v[152:155], v[108:111]
    ds_read_b64_tr_b16 v[144:145], v27 offset:32768
    v_mfma_f32_16x16x32_bf16 v[112:115], v[176:179], v[152:155], v[112:115]
    ds_read_b64_tr_b16 v[146:147], v27 offset:33792
    s_waitcnt lgkmcnt(10)
    v_mfma_f32_16x16x32_bf16 v[116:119], v[172:175], v[156:159], v[116:119]
    ds_read_b64_tr_b16 v[148:149], v28 offset:32768
    v_mfma_f32_16x16x32_bf16 v[120:123], v[176:179], v[156:159], v[120:123]
    ds_read_b64_tr_b16 v[150:151], v28 offset:33792
    v_mfma_f32_16x16x32_bf16 v[124:127], v[172:175], v[160:163], v[124:127]
    ds_read_b64_tr_b16 v[152:153], v29 offset:32768
    v_mfma_f32_16x16x32_bf16 v[128:131], v[176:179], v[160:163], v[128:131]
    ds_read_b64_tr_b16 v[154:155], v29 offset:33792
    s_waitcnt lgkmcnt(8)
    v_mfma_f32_16x16x32_bf16 v[68:71], v[164:167], v[132:135], v[68:71]
    ds_read_b64_tr_b16 v[156:157], v30 offset:32768
    v_mfma_f32_16x16x32_bf16 v[72:75], v[168:171], v[132:135], v[72:75]
    ds_read_b64_tr_b16 v[158:159], v30 offset:33792
    v_mfma_f32_16x16x32_bf16 v[76:79], v[164:167], v[136:139], v[76:79]
    ds_read_b64_tr_b16 v[160:161], v31 offset:32768
    v_mfma_f32_16x16x32_bf16 v[80:83], v[168:171], v[136:139], v[80:83]
    ds_read_b64_tr_b16 v[162:163], v31 offset:33792
    s_waitcnt lgkmcnt(8)
    v_mfma_f32_16x16x32_bf16 v[84:87], v[164:167], v[140:143], v[84:87]
    ds_read_b128 v[172:175], v45 offset:49152
    v_mfma_f32_16x16x32_bf16 v[88:91], v[168:171], v[140:143], v[88:91]
    ds_read_b128 v[176:179], v47 offset:49152
    v_mfma_f32_16x16x32_bf16 v[92:95], v[164:167], v[144:147], v[92:95]
    ds_read_b64_tr_b16 v[132:133], v24 offset:40960
    v_mfma_f32_16x16x32_bf16 v[96:99], v[168:171], v[144:147], v[96:99]
    ds_read_b64_tr_b16 v[134:135], v24 offset:41984
    v_mfma_f32_16x16x32_bf16 v[60:63], v[144:147], v[12:15], v[60:63]
    ds_read_b64_tr_b16 v[136:137], v25 offset:40960
    s_waitcnt lgkmcnt(9)
    v_mfma_f32_16x16x32_bf16 v[100:103], v[164:167], v[148:151], v[100:103]
    ds_read_b64_tr_b16 v[138:139], v25 offset:41984
    v_mfma_f32_16x16x32_bf16 v[104:107], v[168:171], v[148:151], v[104:107]
    ds_read_b64_tr_b16 v[140:141], v26 offset:40960
    v_mfma_f32_16x16x32_bf16 v[64:67], v[148:151], v[12:15], v[64:67]
    ds_read_b64_tr_b16 v[142:143], v26 offset:41984
    v_mfma_f32_16x16x32_bf16 v[108:111], v[164:167], v[152:155], v[108:111]
    ds_read_b64_tr_b16 v[144:145], v27 offset:40960
    v_mfma_f32_16x16x32_bf16 v[112:115], v[168:171], v[152:155], v[112:115]
    ds_read_b64_tr_b16 v[146:147], v27 offset:41984
    s_waitcnt lgkmcnt(10)
    v_mfma_f32_16x16x32_bf16 v[116:119], v[164:167], v[156:159], v[116:119]
    ds_read_b64_tr_b16 v[148:149], v28 offset:40960
    v_mfma_f32_16x16x32_bf16 v[120:123], v[168:171], v[156:159], v[120:123]
    ds_read_b64_tr_b16 v[150:151], v28 offset:41984
    v_mfma_f32_16x16x32_bf16 v[124:127], v[164:167], v[160:163], v[124:127]
    ds_read_b64_tr_b16 v[152:153], v29 offset:40960
    v_mfma_f32_16x16x32_bf16 v[128:131], v[168:171], v[160:163], v[128:131]
    ds_read_b64_tr_b16 v[154:155], v29 offset:41984
    s_waitcnt lgkmcnt(8)
    v_mfma_f32_16x16x32_bf16 v[68:71], v[172:175], v[132:135], v[68:71]
    ds_read_b64_tr_b16 v[156:157], v30 offset:40960
    v_mfma_f32_16x16x32_bf16 v[72:75], v[176:179], v[132:135], v[72:75]
    ds_read_b64_tr_b16 v[158:159], v30 offset:41984
    v_mfma_f32_16x16x32_bf16 v[76:79], v[172:175], v[136:139], v[76:79]
    ds_read_b64_tr_b16 v[160:161], v31 offset:40960
    v_mfma_f32_16x16x32_bf16 v[80:83], v[176:179], v[136:139], v[80:83]
    ds_read_b64_tr_b16 v[162:163], v31 offset:41984
    s_waitcnt lgkmcnt(8)
    v_mfma_f32_16x16x32_bf16 v[84:87], v[172:175], v[140:143], v[84:87]
    s_barrier
    ds_read_b128 v[164:167], v44 offset:16384
    v_mfma_f32_16x16x32_bf16 v[88:91], v[176:179], v[140:143], v[88:91]
    ds_read_b128 v[168:171], v46 offset:16384
    v_mfma_f32_16x16x32_bf16 v[92:95], v[172:175], v[144:147], v[92:95]
    ds_read_b64_tr_b16 v[132:133], v24 offset:0
    v_mfma_f32_16x16x32_bf16 v[96:99], v[176:179], v[144:147], v[96:99]
    ds_read_b64_tr_b16 v[134:135], v24 offset:1024
    v_mfma_f32_16x16x32_bf16 v[60:63], v[144:147], v[12:15], v[60:63]
    ds_read_b64_tr_b16 v[136:137], v25 offset:0
    s_waitcnt lgkmcnt(9)
    v_mfma_f32_16x16x32_bf16 v[100:103], v[172:175], v[148:151], v[100:103]
    ds_read_b64_tr_b16 v[138:139], v25 offset:1024
    v_mfma_f32_16x16x32_bf16 v[104:107], v[176:179], v[148:151], v[104:107]
    ds_read_b64_tr_b16 v[140:141], v26 offset:0
    v_mfma_f32_16x16x32_bf16 v[64:67], v[148:151], v[12:15], v[64:67]
    ds_read_b64_tr_b16 v[142:143], v26 offset:1024
    v_mfma_f32_16x16x32_bf16 v[108:111], v[172:175], v[152:155], v[108:111]
    ds_read_b64_tr_b16 v[144:145], v27 offset:0
    v_mfma_f32_16x16x32_bf16 v[112:115], v[176:179], v[152:155], v[112:115]
    ds_read_b64_tr_b16 v[146:147], v27 offset:1024
    s_waitcnt lgkmcnt(10)
    v_mfma_f32_16x16x32_bf16 v[116:119], v[172:175], v[156:159], v[116:119]
    ds_read_b64_tr_b16 v[148:149], v28 offset:0
    v_mfma_f32_16x16x32_bf16 v[120:123], v[176:179], v[156:159], v[120:123]
    ds_read_b64_tr_b16 v[150:151], v28 offset:1024
    v_mfma_f32_16x16x32_bf16 v[124:127], v[172:175], v[160:163], v[124:127]
    ds_read_b64_tr_b16 v[152:153], v29 offset:0
    v_mfma_f32_16x16x32_bf16 v[128:131], v[176:179], v[160:163], v[128:131]
    ds_read_b64_tr_b16 v[154:155], v29 offset:1024
    s_waitcnt lgkmcnt(8)
    v_mfma_f32_16x16x32_bf16 v[68:71], v[164:167], v[132:135], v[68:71]
    ds_read_b64_tr_b16 v[156:157], v30 offset:0
    v_mfma_f32_16x16x32_bf16 v[72:75], v[168:171], v[132:135], v[72:75]
    ds_read_b64_tr_b16 v[158:159], v30 offset:1024
    v_mfma_f32_16x16x32_bf16 v[76:79], v[164:167], v[136:139], v[76:79]
    ds_read_b64_tr_b16 v[160:161], v31 offset:0
    v_mfma_f32_16x16x32_bf16 v[80:83], v[168:171], v[136:139], v[80:83]
    ds_read_b64_tr_b16 v[162:163], v31 offset:1024
    s_waitcnt lgkmcnt(8)
    v_mfma_f32_16x16x32_bf16 v[84:87], v[164:167], v[140:143], v[84:87]
    ds_read_b128 v[172:175], v45 offset:16384
    v_mfma_f32_16x16x32_bf16 v[88:91], v[168:171], v[140:143], v[88:91]
    ds_read_b128 v[176:179], v47 offset:16384
    v_mfma_f32_16x16x32_bf16 v[92:95], v[164:167], v[144:147], v[92:95]
    ds_read_b64_tr_b16 v[132:133], v24 offset:8192
    v_mfma_f32_16x16x32_bf16 v[96:99], v[168:171], v[144:147], v[96:99]
    ds_read_b64_tr_b16 v[134:135], v24 offset:9216
    v_mfma_f32_16x16x32_bf16 v[60:63], v[144:147], v[12:15], v[60:63]
    ds_read_b64_tr_b16 v[136:137], v25 offset:8192
    s_waitcnt lgkmcnt(9)
    v_mfma_f32_16x16x32_bf16 v[100:103], v[164:167], v[148:151], v[100:103]
    ds_read_b64_tr_b16 v[138:139], v25 offset:9216
    v_mfma_f32_16x16x32_bf16 v[104:107], v[168:171], v[148:151], v[104:107]
    ds_read_b64_tr_b16 v[140:141], v26 offset:8192
    v_mfma_f32_16x16x32_bf16 v[64:67], v[148:151], v[12:15], v[64:67]
    ds_read_b64_tr_b16 v[142:143], v26 offset:9216
    v_mfma_f32_16x16x32_bf16 v[108:111], v[164:167], v[152:155], v[108:111]
    ds_read_b64_tr_b16 v[144:145], v27 offset:8192
    v_mfma_f32_16x16x32_bf16 v[112:115], v[168:171], v[152:155], v[112:115]
    ds_read_b64_tr_b16 v[146:147], v27 offset:9216
    s_waitcnt lgkmcnt(10)
    v_mfma_f32_16x16x32_bf16 v[116:119], v[164:167], v[156:159], v[116:119]
    ds_read_b64_tr_b16 v[148:149], v28 offset:8192
    v_mfma_f32_16x16x32_bf16 v[120:123], v[168:171], v[156:159], v[120:123]
    ds_read_b64_tr_b16 v[150:151], v28 offset:9216
    v_mfma_f32_16x16x32_bf16 v[124:127], v[164:167], v[160:163], v[124:127]
    ds_read_b64_tr_b16 v[152:153], v29 offset:8192
    v_mfma_f32_16x16x32_bf16 v[128:131], v[168:171], v[160:163], v[128:131]
    ds_read_b64_tr_b16 v[154:155], v29 offset:9216
    s_waitcnt lgkmcnt(8)
    v_mfma_f32_16x16x32_bf16 v[68:71], v[172:175], v[132:135], v[68:71]
    ds_read_b64_tr_b16 v[156:157], v30 offset:8192
    v_mfma_f32_16x16x32_bf16 v[72:75], v[176:179], v[132:135], v[72:75]
    ds_read_b64_tr_b16 v[158:159], v30 offset:9216
    v_mfma_f32_16x16x32_bf16 v[76:79], v[172:175], v[136:139], v[76:79]
    ds_read_b64_tr_b16 v[160:161], v31 offset:8192
    v_mfma_f32_16x16x32_bf16 v[80:83], v[176:179], v[136:139], v[80:83]
    ds_read_b64_tr_b16 v[162:163], v31 offset:9216
    s_waitcnt lgkmcnt(8)
    v_mfma_f32_16x16x32_bf16 v[84:87], v[172:175], v[140:143], v[84:87]
    s_barrier
    ds_read_b128 v[164:167], v40 offset:16384
    v_mfma_f32_16x16x32_bf16 v[88:91], v[176:179], v[140:143], v[88:91]
    ds_read_b128 v[168:171], v42 offset:16384
    v_mfma_f32_16x16x32_bf16 v[92:95], v[172:175], v[144:147], v[92:95]
    ds_read_b64_tr_b16 v[132:133], v16 offset:0
    v_mfma_f32_16x16x32_bf16 v[96:99], v[176:179], v[144:147], v[96:99]
    ds_read_b64_tr_b16 v[134:135], v16 offset:1024
    v_mfma_f32_16x16x32_bf16 v[60:63], v[144:147], v[12:15], v[60:63]
    ds_read_b64_tr_b16 v[136:137], v17 offset:0
    s_waitcnt lgkmcnt(9)
    v_mfma_f32_16x16x32_bf16 v[100:103], v[172:175], v[148:151], v[100:103]
    ds_read_b64_tr_b16 v[138:139], v17 offset:1024
    v_mfma_f32_16x16x32_bf16 v[104:107], v[176:179], v[148:151], v[104:107]
    ds_read_b64_tr_b16 v[140:141], v18 offset:0
    v_mfma_f32_16x16x32_bf16 v[64:67], v[148:151], v[12:15], v[64:67]
    ds_read_b64_tr_b16 v[142:143], v18 offset:1024
    v_mfma_f32_16x16x32_bf16 v[108:111], v[172:175], v[152:155], v[108:111]
    ds_read_b64_tr_b16 v[144:145], v19 offset:0
    v_mfma_f32_16x16x32_bf16 v[112:115], v[176:179], v[152:155], v[112:115]
    ds_read_b64_tr_b16 v[146:147], v19 offset:1024
    s_waitcnt lgkmcnt(10)
    v_mfma_f32_16x16x32_bf16 v[116:119], v[172:175], v[156:159], v[116:119]
    ds_read_b64_tr_b16 v[148:149], v20 offset:0
    v_mfma_f32_16x16x32_bf16 v[120:123], v[176:179], v[156:159], v[120:123]
    ds_read_b64_tr_b16 v[150:151], v20 offset:1024
    v_mfma_f32_16x16x32_bf16 v[124:127], v[172:175], v[160:163], v[124:127]
    ds_read_b64_tr_b16 v[152:153], v21 offset:0
    v_mfma_f32_16x16x32_bf16 v[128:131], v[176:179], v[160:163], v[128:131]
    ds_read_b64_tr_b16 v[154:155], v21 offset:1024
    s_waitcnt lgkmcnt(8)
    v_mfma_f32_16x16x32_bf16 v[68:71], v[164:167], v[132:135], v[68:71]
    ds_read_b64_tr_b16 v[156:157], v22 offset:0
    v_mfma_f32_16x16x32_bf16 v[72:75], v[168:171], v[132:135], v[72:75]
    ds_read_b64_tr_b16 v[158:159], v22 offset:1024
    s_mov_b32 s43, 400000
L_p1_rfv:
    s_waitcnt vmcnt(0)
    v_readfirstlane_b32 s67, v228
    s_cmp_eq_u32 s67, 0
    s_cbranch_scc1 L_p1_rfwv
    s_lshl_b32 s67, s66, 2
    s_add_u32 s67, s67, 16384
    s_mov_b64 exec, 1
    buffer_store_dword v228, off, s[56:59], s67 sc1
    s_mov_b64 exec, -1
L_p1_rfxv:
    v_mfma_f32_16x16x32_bf16 v[76:79], v[164:167], v[136:139], v[76:79]
    ds_read_b64_tr_b16 v[160:161], v23 offset:0
    v_mfma_f32_16x16x32_bf16 v[80:83], v[168:171], v[136:139], v[80:83]
    ds_read_b64_tr_b16 v[162:163], v23 offset:1024
    s_waitcnt lgkmcnt(8)
    v_mfma_f32_16x16x32_bf16 v[84:87], v[164:167], v[140:143], v[84:87]
    ds_read_b128 v[172:175], v41 offset:16384
    v_mfma_f32_16x16x32_bf16 v[88:91], v[168:171], v[140:143], v[88:91]
    ds_read_b128 v[176:179], v43 offset:16384
    v_mfma_f32_16x16x32_bf16 v[92:95], v[164:167], v[144:147], v[92:95]
    ds_read_b64_tr_b16 v[132:133], v16 offset:8192
    v_mfma_f32_16x16x32_bf16 v[96:99], v[168:171], v[144:147], v[96:99]
    ds_read_b64_tr_b16 v[134:135], v16 offset:9216
    v_mfma_f32_16x16x32_bf16 v[60:63], v[144:147], v[12:15], v[60:63]
    ds_read_b64_tr_b16 v[136:137], v17 offset:8192
    s_waitcnt lgkmcnt(9)
    v_mfma_f32_16x16x32_bf16 v[100:103], v[164:167], v[148:151], v[100:103]
    ds_read_b64_tr_b16 v[138:139], v17 offset:9216
    v_mfma_f32_16x16x32_bf16 v[104:107], v[168:171], v[148:151], v[104:107]
    ds_read_b64_tr_b16 v[140:141], v18 offset:8192
    v_mfma_f32_16x16x32_bf16 v[64:67], v[148:151], v[12:15], v[64:67]
    ds_read_b64_tr_b16 v[142:143], v18 offset:9216
    v_mfma_f32_16x16x32_bf16 v[108:111], v[164:167], v[152:155], v[108:111]
    ds_read_b64_tr_b16 v[144:145], v19 offset:8192
    v_mfma_f32_16x16x32_bf16 v[112:115], v[168:171], v[152:155], v[112:115]
    ds_read_b64_tr_b16 v[146:147], v19 offset:9216
    s_waitcnt lgkmcnt(10)
    v_mfma_f32_16x16x32_bf16 v[116:119], v[164:167], v[156:159], v[116:119]
    ds_read_b64_tr_b16 v[148:149], v20 offset:8192
    v_mfma_f32_16x16x32_bf16 v[120:123], v[168:171], v[156:159], v[120:123]
    ds_read_b64_tr_b16 v[150:151], v20 offset:9216
    v_mfma_f32_16x16x32_bf16 v[124:127], v[164:167], v[160:163], v[124:127]
    ds_read_b64_tr_b16 v[152:153], v21 offset:8192
    v_mfma_f32_16x16x32_bf16 v[128:131], v[168:171], v[160:163], v[128:131]
    ds_read_b64_tr_b16 v[154:155], v21 offset:9216
    s_waitcnt lgkmcnt(8)
    v_mfma_f32_16x16x32_bf16 v[68:71], v[172:175], v[132:135], v[68:71]
    ds_read_b64_tr_b16 v[156:157], v22 offset:8192
    v_mfma_f32_16x16x32_bf16 v[72:75], v[176:179], v[132:135], v[72:75]
    ds_read_b64_tr_b16 v[158:159], v22 offset:9216
    v_mfma_f32_16x16x32_bf16 v[76:79], v[172:175], v[136:139], v[76:79]
    ds_read_b64_tr_b16 v[160:161], v23 offset:8192
    v_mfma_f32_16x16x32_bf16 v[80:83], v[176:179], v[136:139], v[80:83]
    ds_read_b64_tr_b16 v[162:163], v23 offset:9216
    s_waitcnt lgkmcnt(8)
    v_mfma_f32_16x16x32_bf16 v[84:87], v[172:175], v[140:143], v[84:87]
    s_barrier
    ds_read_b128 v[164:167], v40 offset:49152
    v_mfma_f32_16x16x32_bf16 v[88:91], v[176:179], v[140:143], v[88:91]
    ds_read_b128 v[168:171], v42 offset:49152
    v_mfma_f32_16x16x32_bf16 v[92:95], v[172:175], v[144:147], v[92:95]
    ds_read_b64_tr_b16 v[132:133], v16 offset:32768
    v_mfma_f32_16x16x32_bf16 v[96:99], v[176:179], v[144:147], v[96:99]
    ds_read_b64_tr_b16 v[134:135], v16 offset:33792
    v_mfma_f32_16x16x32_bf16 v[60:63], v[144:147], v[12:15], v[60:63]
    ds_read_b64_tr_b16 v[136:137], v17 offset:32768
    s_waitcnt lgkmcnt(9)
    v_mfma_f32_16x16x32_bf16 v[100:103], v[172:175], v[148:151], v[100:103]
    ds_read_b64_tr_b16 v[138:139], v17 offset:33792
    v_mfma_f32_16x16x32_bf16 v[104:107], v[176:179], v[148:151], v[104:107]
    ds_read_b64_tr_b16 v[140:141], v18 offset:32768
    v_mfma_f32_16x16x32_bf16 v[64:67], v[148:151], v[12:15], v[64:67]
    ds_read_b64_tr_b16 v[142:143], v18 offset:33792
    v_mfma_f32_16x16x32_bf16 v[108:111], v[172:175], v[152:155], v[108:111]
    ds_read_b64_tr_b16 v[144:145], v19 offset:32768
    v_mfma_f32_16x16x32_bf16 v[112:115], v[176:179], v[152:155], v[112:115]
    ds_read_b64_tr_b16 v[146:147], v19 offset:33792
    s_waitcnt lgkmcnt(10)
    v_mfma_f32_16x16x32_bf16 v[116:119], v[172:175], v[156:159], v[116:119]
    ds_read_b64_tr_b16 v[148:149], v20 offset:32768
    v_mfma_f32_16x16x32_bf16 v[120:123], v[176:179], v[156:159], v[120:123]
    ds_read_b64_tr_b16 v[150:151], v20 offset:33792
    v_mfma_f32_16x16x32_bf16 v[124:127], v[172:175], v[160:163], v[124:127]
    ds_read_b64_tr_b16 v[152:153], v21 offset:32768
    v_mfma_f32_16x16x32_bf16 v[128:131], v[176:179], v[160:163], v[128:131]
    ds_read_b64_tr_b16 v[154:155], v21 offset:33792
    s_waitcnt lgkmcnt(8)
    v_mfma_f32_16x16x32_bf16 v[68:71], v[164:167], v[132:135], v[68:71]
    ds_read_b64_tr_b16 v[156:157], v22 offset:32768
    v_mfma_f32_16x16x32_bf16 v[72:75], v[168:171], v[132:135], v[72:75]
    ds_read_b64_tr_b16 v[158:159], v22 offset:33792
    v_mfma_f32_16x16x32_bf16 v[76:79], v[164:167], v[136:139], v[76:79]
    ds_read_b64_tr_b16 v[160:161], v23 offset:32768
    v_mfma_f32_16x16x32_bf16 v[80:83], v[168:171], v[136:139], v[80:83]
    ds_read_b64_tr_b16 v[162:163], v23 offset:33792
    s_waitcnt lgkmcnt(8)
    v_mfma_f32_16x16x32_bf16 v[84:87], v[164:167], v[140:143], v[84:87]
    ds_read_b128 v[172:175], v41 offset:49152
    v_mfma_f32_16x16x32_bf16 v[88:91], v[168:171], v[140:143], v[88:91]
    ds_read_b128 v[176:179], v43 offset:49152
    v_mfma_f32_16x16x32_bf16 v[92:95], v[164:167], v[144:147], v[92:95]
    ds_read_b64_tr_b16 v[132:133], v16 offset:40960
    v_mfma_f32_16x16x32_bf16 v[96:99], v[168:171], v[144:147], v[96:99]
    ds_read_b64_tr_b16 v[134:135], v16 offset:41984
    v_mfma_f32_16x16x32_bf16 v[60:63], v[144:147], v[12:15], v[60:63]
    ds_read_b64_tr_b16 v[136:137], v17 offset:40960
    s_waitcnt lgkmcnt(9)
    v_mfma_f32_16x16x32_bf16 v[100:103], v[164:167], v[148:151], v[100:103]
    ds_read_b64_tr_b16 v[138:139], v17 offset:41984
    v_mfma_f32_16x16x32_bf16 v[104:107], v[168:171], v[148:151], v[104:107]
    ds_read_b64_tr_b16 v[140:141], v18 offset:40960
    v_mfma_f32_16x16x32_bf16 v[64:67], v[148:151], v[12:15], v[64:67]
    ds_read_b64_tr_b16 v[142:143], v18 offset:41984
    v_mfma_f32_16x16x32_bf16 v[108:111], v[164:167], v[152:155], v[108:111]
    ds_read_b64_tr_b16 v[144:145], v19 offset:40960
    v_mfma_f32_16x16x32_bf16 v[112:115], v[168:171], v[152:155], v[112:115]
    ds_read_b64_tr_b16 v[146:147], v19 offset:41984
    s_waitcnt lgkmcnt(10)
    v_mfma_f32_16x16x32_bf16 v[116:119], v[164:167], v[156:159], v[116:119]
    ds_read_b64_tr_b16 v[148:149], v20 offset:40960
    v_mfma_f32_16x16x32_bf16 v[120:123], v[168:171], v[156:159], v[120:123]
    ds_read_b64_tr_b16 v[150:151], v20 offset:41984
    v_mfma_f32_16x16x32_bf16 v[124:127], v[164:167], v[160:163], v[124:127]
    ds_read_b64_tr_b16 v[152:153], v21 offset:40960
    v_mfma_f32_16x16x32_bf16 v[128:131], v[168:171], v[160:163], v[128:131]
    ds_read_b64_tr_b16 v[154:155], v21 offset:41984
    s_waitcnt lgkmcnt(8)
    v_mfma_f32_16x16x32_bf16 v[68:71], v[172:175], v[132:135], v[68:71]
    ds_read_b64_tr_b16 v[156:157], v22 offset:40960
    v_mfma_f32_16x16x32_bf16 v[72:75], v[176:179], v[132:135], v[72:75]
    ds_read_b64_tr_b16 v[158:159], v22 offset:41984
    v_mfma_f32_16x16x32_bf16 v[76:79], v[172:175], v[136:139], v[76:79]
    ds_read_b64_tr_b16 v[160:161], v23 offset:40960
    v_mfma_f32_16x16x32_bf16 v[80:83], v[176:179], v[136:139], v[80:83]
    ds_read_b64_tr_b16 v[162:163], v23 offset:41984
    s_waitcnt lgkmcnt(8)
    v_mfma_f32_16x16x32_bf16 v[84:87], v[172:175], v[140:143], v[84:87]
    s_barrier
    ds_read_b128 v[164:167], v48 offset:16384
    v_mfma_f32_16x16x32_bf16 v[88:91], v[176:179], v[140:143], v[88:91]
    ds_read_b128 v[168:171], v50 offset:16384
    v_mfma_f32_16x16x32_bf16 v[92:95], v[172:175], v[144:147], v[92:95]
    ds_read_b64_tr_b16 v[132:133], v32 offset:0
    v_mfma_f32_16x16x32_bf16 v[96:99], v[176:179], v[144:147], v[96:99]
    ds_read_b64_tr_b16 v[134:135], v32 offset:1024
    v_mfma_f32_16x16x32_bf16 v[60:63], v[144:147], v[12:15], v[60:63]
    ds_read_b64_tr_b16 v[136:137], v33 offset:0
    s_waitcnt lgkmcnt(9)
    v_mfma_f32_16x16x32_bf16 v[100:103], v[172:175], v[148:151], v[100:103]
    ds_read_b64_tr_b16 v[138:139], v33 offset:1024
    v_mfma_f32_16x16x32_bf16 v[104:107], v[176:179], v[148:151], v[104:107]
    ds_read_b64_tr_b16 v[140:141], v34 offset:0
    v_mfma_f32_16x16x32_bf16 v[64:67], v[148:151], v[12:15], v[64:67]
    ds_read_b64_tr_b16 v[142:143], v34 offset:1024
    v_mfma_f32_16x16x32_bf16 v[108:111], v[172:175], v[152:155], v[108:111]
    ds_read_b64_tr_b16 v[144:145], v35 offset:0
    v_mfma_f32_16x16x32_bf16 v[112:115], v[176:179], v[152:155], v[112:115]
    ds_read_b64_tr_b16 v[146:147], v35 offset:1024
    s_waitcnt lgkmcnt(10)
    v_mfma_f32_16x16x32_bf16 v[116:119], v[172:175], v[156:159], v[116:119]
    ds_read_b64_tr_b16 v[148:149], v36 offset:0
    v_mfma_f32_16x16x32_bf16 v[120:123], v[176:179], v[156:159], v[120:123]
    ds_read_b64_tr_b16 v[150:151], v36 offset:1024
    v_mfma_f32_16x16x32_bf16 v[124:127], v[172:175], v[160:163], v[124:127]
    ds_read_b64_tr_b16 v[152:153], v37 offset:0
    v_mfma_f32_16x16x32_bf16 v[128:131], v[176:179], v[160:163], v[128:131]
    ds_read_b64_tr_b16 v[154:155], v37 offset:1024
    s_waitcnt lgkmcnt(8)
    v_mfma_f32_16x16x32_bf16 v[68:71], v[164:167], v[132:135], v[68:71]
    ds_read_b64_tr_b16 v[156:157], v38 offset:0
    v_mfma_f32_16x16x32_bf16 v[72:75], v[168:171], v[132:135], v[72:75]
    ds_read_b64_tr_b16 v[158:159], v38 offset:1024
    v_mfma_f32_16x16x32_bf16 v[76:79], v[164:167], v[136:139], v[76:79]
    ds_read_b64_tr_b16 v[160:161], v39 offset:0
    v_mfma_f32_16x16x32_bf16 v[80:83], v[168:171], v[136:139], v[80:83]
    ds_read_b64_tr_b16 v[162:163], v39 offset:1024
    s_waitcnt lgkmcnt(8)
    v_mfma_f32_16x16x32_bf16 v[84:87], v[164:167], v[140:143], v[84:87]
    ds_read_b128 v[172:175], v49 offset:16384
    v_mfma_f32_16x16x32_bf16 v[88:91], v[168:171], v[140:143], v[88:91]
    ds_read_b128 v[176:179], v51 offset:16384
    v_mfma_f32_16x16x32_bf16 v[92:95], v[164:167], v[144:147], v[92:95]
    ds_read_b64_tr_b16 v[132:133], v32 offset:8192
    v_mfma_f32_16x16x32_bf16 v[96:99], v[168:171], v[144:147], v[96:99]
    ds_read_b64_tr_b16 v[134:135], v32 offset:9216
    v_mfma_f32_16x16x32_bf16 v[60:63], v[144:147], v[12:15], v[60:63]
    ds_read_b64_tr_b16 v[136:137], v33 offset:8192
    s_waitcnt lgkmcnt(9)
    v_mfma_f32_16x16x32_bf16 v[100:103], v[164:167], v[148:151], v[100:103]
    ds_read_b64_tr_b16 v[138:139], v33 offset:9216
    v_mfma_f32_16x16x32_bf16 v[104:107], v[168:171], v[148:151], v[104:107]
    ds_read_b64_tr_b16 v[140:141], v34 offset:8192
    v_mfma_f32_16x16x32_bf16 v[64:67], v[148:151], v[12:15], v[64:67]
    ds_read_b64_tr_b16 v[142:143], v34 offset:9216
    v_mfma_f32_16x16x32_bf16 v[108:111], v[164:167], v[152:155], v[108:111]
    ds_read_b64_tr_b16 v[144:145], v35 offset:8192
    v_mfma_f32_16x16x32_bf16 v[112:115], v[168:171], v[152:155], v[112:115]
    ds_read_b64_tr_b16 v[146:147], v35 offset:9216
    s_waitcnt lgkmcnt(10)
    v_mfma_f32_16x16x32_bf16 v[116:119], v[164:167], v[156:159], v[116:119]
    ds_read_b64_tr_b16 v[148:149], v36 offset:8192
    v_mfma_f32_16x16x32_bf16 v[120:123], v[168:171], v[156:159], v[120:123]
    ds_read_b64_tr_b16 v[150:151], v36 offset:9216
    v_mfma_f32_16x16x32_bf16 v[124:127], v[164:167], v[160:163], v[124:127]
    ds_read_b64_tr_b16 v[152:153], v37 offset:8192
    v_mfma_f32_16x16x32_bf16 v[128:131], v[168:171], v[160:163], v[128:131]
    ds_read_b64_tr_b16 v[154:155], v37 offset:9216
    s_waitcnt lgkmcnt(8)
    v_mfma_f32_16x16x32_bf16 v[68:71], v[172:175], v[132:135], v[68:71]
    ds_read_b64_tr_b16 v[156:157], v38 offset:8192
    v_mfma_f32_16x16x32_bf16 v[72:75], v[176:179], v[132:135], v[72:75]
    ds_read_b64_tr_b16 v[158:159], v38 offset:9216
    s_lshl_b32 s42, s24, 8
    s_lshl_b32 s27, s40, 6
    s_add_u32 s42, s42, s27
    s_add_u32 s42, s42, 16384
    v_lshlrev_b32 v241, 2, v3
    buffer_load_dword v240, v241, s[56:59], s42 offen sc1
    v_mfma_f32_16x16x32_bf16 v[76:79], v[172:175], v[136:139], v[76:79]
    ds_read_b64_tr_b16 v[160:161], v39 offset:8192
    v_mfma_f32_16x16x32_bf16 v[80:83], v[176:179], v[136:139], v[80:83]
    ds_read_b64_tr_b16 v[162:163], v39 offset:9216
    s_waitcnt lgkmcnt(8)
    v_mfma_f32_16x16x32_bf16 v[84:87], v[172:175], v[140:143], v[84:87]
    s_barrier
    ds_read_b128 v[164:167], v44 offset:49152
    v_mfma_f32_16x16x32_bf16 v[88:91], v[176:179], v[140:143], v[88:91]
    ds_read_b128 v[168:171], v46 offset:49152
    v_mfma_f32_16x16x32_bf16 v[92:95], v[172:175], v[144:147], v[92:95]
    ds_read_b64_tr_b16 v[132:133], v24 offset:32768
    v_mfma_f32_16x16x32_bf16 v[96:99], v[176:179], v[144:147], v[96:99]
    ds_read_b64_tr_b16 v[134:135], v24 offset:33792
    v_mfma_f32_16x16x32_bf16 v[60:63], v[144:147], v[12:15], v[60:63]
    ds_read_b64_tr_b16 v[136:137], v25 offset:32768
    s_waitcnt lgkmcnt(9)
    v_mfma_f32_16x16x32_bf16 v[100:103], v[172:175], v[148:151], v[100:103]
    ds_read_b64_tr_b16 v[138:139], v25 offset:33792
    v_mfma_f32_16x16x32_bf16 v[104:107], v[176:179], v[148:151], v[104:107]
    ds_read_b64_tr_b16 v[140:141], v26 offset:32768
    v_mfma_f32_16x16x32_bf16 v[64:67], v[148:151], v[12:15], v[64:67]
    ds_read_b64_tr_b16 v[142:143], v26 offset:33792
    v_mfma_f32_16x16x32_bf16 v[108:111], v[172:175], v[152:155], v[108:111]
    ds_read_b64_tr_b16 v[144:145], v27 offset:32768
    v_mfma_f32_16x16x32_bf16 v[112:115], v[176:179], v[152:155], v[112:115]
    ds_read_b64_tr_b16 v[146:147], v27 offset:33792
    s_waitcnt lgkmcnt(10)
    v_mfma_f32_16x16x32_bf16 v[116:119], v[172:175], v[156:159], v[116:119]
    ds_read_b64_tr_b16 v[148:149], v28 offset:32768
    v_mfma_f32_16x16x32_bf16 v[120:123], v[176:179], v[156:159], v[120:123]
    ds_read_b64_tr_b16 v[150:151], v28 offset:33792
    v_mfma_f32_16x16x32_bf16 v[124:127], v[172:175], v[160:163], v[124:127]
    ds_read_b64_tr_b16 v[152:153], v29 offset:32768
    v_mfma_f32_16x16x32_bf16 v[128:131], v[176:179], v[160:163], v[128:131]
    ds_read_b64_tr_b16 v[154:155], v29 offset:33792
    s_waitcnt lgkmcnt(8)
    v_mfma_f32_16x16x32_bf16 v[68:71], v[164:167], v[132:135], v[68:71]
    ds_read_b64_tr_b16 v[156:157], v30 offset:32768
    v_mfma_f32_16x16x32_bf16 v[72:75], v[168:171], v[132:135], v[72:75]
    ds_read_b64_tr_b16 v[158:159], v30 offset:33792
    v_mfma_f32_16x16x32_bf16 v[76:79], v[164:167], v[136:139], v[76:79]
    ds_read_b64_tr_b16 v[160:161], v31 offset:32768
    v_mfma_f32_16x16x32_bf16 v[80:83], v[168:171], v[136:139], v[80:83]
    ds_read_b64_tr_b16 v[162:163], v31 offset:33792
    s_waitcnt lgkmcnt(8)
    v_mfma_f32_16x16x32_bf16 v[84:87], v[164:167], v[140:143], v[84:87]
    ds_read_b128 v[172:175], v45 offset:49152
    v_mfma_f32_16x16x32_bf16 v[88:91], v[168:171], v[140:143], v[88:91]
    ds_read_b128 v[176:179], v47 offset:49152
    v_mfma_f32_16x16x32_bf16 v[92:95], v[164:167], v[144:147], v[92:95]
    ds_read_b64_tr_b16 v[132:133], v24 offset:40960
    v_mfma_f32_16x16x32_bf16 v[96:99], v[168:171], v[144:147], v[96:99]
    ds_read_b64_tr_b16 v[134:135], v24 offset:41984
    v_mfma_f32_16x16x32_bf16 v[60:63], v[144:147], v[12:15], v[60:63]
    ds_read_b64_tr_b16 v[136:137], v25 offset:40960
    s_waitcnt lgkmcnt(9)
    v_mfma_f32_16x16x32_bf16 v[100:103], v[164:167], v[148:151], v[100:103]
    ds_read_b64_tr_b16 v[138:139], v25 offset:41984
    v_mfma_f32_16x16x32_bf16 v[104:107], v[168:171], v[148:151], v[104:107]
    ds_read_b64_tr_b16 v[140:141], v26 offset:40960
    v_mfma_f32_16x16x32_bf16 v[64:67], v[148:151], v[12:15], v[64:67]
    ds_read_b64_tr_b16 v[142:143], v26 offset:41984
    v_mfma_f32_16x16x32_bf16 v[108:111], v[164:167], v[152:155], v[108:111]
    ds_read_b64_tr_b16 v[144:145], v27 offset:40960
    v_mfma_f32_16x16x32_bf16 v[112:115], v[168:171], v[152:155], v[112:115]
    ds_read_b64_tr_b16 v[146:147], v27 offset:41984
    s_waitcnt lgkmcnt(10)
    v_mfma_f32_16x16x32_bf16 v[116:119], v[164:167], v[156:159], v[116:119]
    ds_read_b64_tr_b16 v[148:149], v28 offset:40960
    v_mfma_f32_16x16x32_bf16 v[120:123], v[168:171], v[156:159], v[120:123]
    ds_read_b64_tr_b16 v[150:151], v28 offset:41984
    v_mfma_f32_16x16x32_bf16 v[124:127], v[164:167], v[160:163], v[124:127]
    ds_read_b64_tr_b16 v[152:153], v29 offset:40960
    v_mfma_f32_16x16x32_bf16 v[128:131], v[168:171], v[160:163], v[128:131]
    ds_read_b64_tr_b16 v[154:155], v29 offset:41984
    s_waitcnt lgkmcnt(8)
    v_mfma_f32_16x16x32_bf16 v[68:71], v[172:175], v[132:135], v[68:71]
    ds_read_b64_tr_b16 v[156:157], v30 offset:40960
    v_mfma_f32_16x16x32_bf16 v[72:75], v[176:179], v[132:135], v[72:75]
    ds_read_b64_tr_b16 v[158:159], v30 offset:41984
    v_mfma_f32_16x16x32_bf16 v[76:79], v[172:175], v[136:139], v[76:79]
    ds_read_b64_tr_b16 v[160:161], v31 offset:40960
    v_mfma_f32_16x16x32_bf16 v[80:83], v[176:179], v[136:139], v[80:83]
    ds_read_b64_tr_b16 v[162:163], v31 offset:41984
    s_waitcnt lgkmcnt(8)
    v_mfma_f32_16x16x32_bf16 v[84:87], v[172:175], v[140:143], v[84:87]
    s_barrier
    ds_read_b128 v[164:167], v44 offset:16384
    v_mfma_f32_16x16x32_bf16 v[88:91], v[176:179], v[140:143], v[88:91]
    ds_read_b128 v[168:171], v46 offset:16384
    v_mfma_f32_16x16x32_bf16 v[92:95], v[172:175], v[144:147], v[92:95]
    ds_read_b64_tr_b16 v[132:133], v24 offset:0
    v_mfma_f32_16x16x32_bf16 v[96:99], v[176:179], v[144:147], v[96:99]
    ds_read_b64_tr_b16 v[134:135], v24 offset:1024
    v_mfma_f32_16x16x32_bf16 v[60:63], v[144:147], v[12:15], v[60:63]
    ds_read_b64_tr_b16 v[136:137], v25 offset:0
    s_waitcnt lgkmcnt(9)
    v_mfma_f32_16x16x32_bf16 v[100:103], v[172:175], v[148:151], v[100:103]
    ds_read_b64_tr_b16 v[138:139], v25 offset:1024
    v_mfma_f32_16x16x32_bf16 v[104:107], v[176:179], v[148:151], v[104:107]
    ds_read_b64_tr_b16 v[140:141], v26 offset:0
    v_mfma_f32_16x16x32_bf16 v[64:67], v[148:151], v[12:15], v[64:67]
    ds_read_b64_tr_b16 v[142:143], v26 offset:1024
    v_mfma_f32_16x16x32_bf16 v[108:111], v[172:175], v[152:155], v[108:111]
    ds_read_b64_tr_b16 v[144:145], v27 offset:0
    v_mfma_f32_16x16x32_bf16 v[112:115], v[176:179], v[152:155], v[112:115]
    ds_read_b64_tr_b16 v[146:147], v27 offset:1024
    s_waitcnt lgkmcnt(10)
    v_mfma_f32_16x16x32_bf16 v[116:119], v[172:175], v[156:159], v[116:119]
    ds_read_b64_tr_b16 v[148:149], v28 offset:0
    v_mfma_f32_16x16x32_bf16 v[120:123], v[176:179], v[156:159], v[120:123]
    ds_read_b64_tr_b16 v[150:151], v28 offset:1024
    v_mfma_f32_16x16x32_bf16 v[124:127], v[172:175], v[160:163], v[124:127]
    ds_read_b64_tr_b16 v[152:153], v29 offset:0
    v_mfma_f32_16x16x32_bf16 v[128:131], v[176:179], v[160:163], v[128:131]
    ds_read_b64_tr_b16 v[154:155], v29 offset:1024
    s_waitcnt lgkmcnt(8)
    v_mfma_f32_16x16x32_bf16 v[68:71], v[164:167], v[132:135], v[68:71]
    ds_read_b64_tr_b16 v[156:157], v30 offset:0
    v_mfma_f32_16x16x32_bf16 v[72:75], v[168:171], v[132:135], v[72:75]
    ds_read_b64_tr_b16 v[158:159], v30 offset:1024
    s_mov_b32 s43, 400000
L_p1_spv:
    s_waitcnt vmcnt(0)
    v_cmp_eq_u32 vcc, 0, v240
    s_cbranch_vccnz L_p1_spwv
L_p1_spxv:
    s_lshl_b32 s42, s24, 9
    s_lshl_b32 s27, s40, 7
    s_add_u32 s42, s42, s27
    s_add_u32 s43, s42, 8192
    v_lshlrev_b32 v241, 5, v2
    buffer_load_dwordx4 v[212:215], v241, s[56:59], s42 offen offset:0 sc1
    buffer_load_dwordx4 v[220:223], v241, s[56:59], s43 offen offset:0 sc1
    buffer_load_dwordx4 v[216:219], v241, s[56:59], s42 offen offset:16 sc1
    buffer_load_dwordx4 v[224:227], v241, s[56:59], s43 offen offset:16 sc1
    v_mfma_f32_16x16x32_bf16 v[76:79], v[164:167], v[136:139], v[76:79]
    ds_read_b64_tr_b16 v[160:161], v31 offset:0
    v_mfma_f32_16x16x32_bf16 v[80:83], v[168:171], v[136:139], v[80:83]
    ds_read_b64_tr_b16 v[162:163], v31 offset:1024
    s_waitcnt lgkmcnt(8)
    v_mfma_f32_16x16x32_bf16 v[84:87], v[164:167], v[140:143], v[84:87]
    ds_read_b128 v[172:175], v45 offset:16384
    v_mfma_f32_16x16x32_bf16 v[88:91], v[168:171], v[140:143], v[88:91]
    ds_read_b128 v[176:179], v47 offset:16384
    v_mfma_f32_16x16x32_bf16 v[92:95], v[164:167], v[144:147], v[92:95]
    ds_read_b64_tr_b16 v[132:133], v24 offset:8192
    v_mfma_f32_16x16x32_bf16 v[96:99], v[168:171], v[144:147], v[96:99]
    ds_read_b64_tr_b16 v[134:135], v24 offset:9216
    v_mfma_f32_16x16x32_bf16 v[60:63], v[144:147], v[12:15], v[60:63]
    ds_read_b64_tr_b16 v[136:137], v25 offset:8192
    s_waitcnt lgkmcnt(9)
    v_mfma_f32_16x16x32_bf16 v[100:103], v[164:167], v[148:151], v[100:103]
    ds_read_b64_tr_b16 v[138:139], v25 offset:9216
    v_mfma_f32_16x16x32_bf16 v[104:107], v[168:171], v[148:151], v[104:107]
    ds_read_b64_tr_b16 v[140:141], v26 offset:8192
    v_mfma_f32_16x16x32_bf16 v[64:67], v[148:151], v[12:15], v[64:67]
    ds_read_b64_tr_b16 v[142:143], v26 offset:9216
    v_mfma_f32_16x16x32_bf16 v[108:111], v[164:167], v[152:155], v[108:111]
    ds_read_b64_tr_b16 v[144:145], v27 offset:8192
    v_mfma_f32_16x16x32_bf16 v[112:115], v[168:171], v[152:155], v[112:115]
    ds_read_b64_tr_b16 v[146:147], v27 offset:9216
    s_waitcnt lgkmcnt(10)
    v_mfma_f32_16x16x32_bf16 v[116:119], v[164:167], v[156:159], v[116:119]
    ds_read_b64_tr_b16 v[148:149], v28 offset:8192
    v_mfma_f32_16x16x32_bf16 v[120:123], v[168:171], v[156:159], v[120:123]
    ds_read_b64_tr_b16 v[150:151], v28 offset:9216
    v_mfma_f32_16x16x32_bf16 v[124:127], v[164:167], v[160:163], v[124:127]
    ds_read_b64_tr_b16 v[152:153], v29 offset:8192
    v_mfma_f32_16x16x32_bf16 v[128:131], v[168:171], v[160:163], v[128:131]
    ds_read_b64_tr_b16 v[154:155], v29 offset:9216
    s_waitcnt lgkmcnt(8)
    v_mfma_f32_16x16x32_bf16 v[68:71], v[172:175], v[132:135], v[68:71]
    ds_read_b64_tr_b16 v[156:157], v30 offset:8192
    v_mfma_f32_16x16x32_bf16 v[72:75], v[176:179], v[132:135], v[72:75]
    ds_read_b64_tr_b16 v[158:159], v30 offset:9216
    v_mfma_f32_16x16x32_bf16 v[76:79], v[172:175], v[136:139], v[76:79]
    ds_read_b64_tr_b16 v[160:161], v31 offset:8192
    v_mfma_f32_16x16x32_bf16 v[80:83], v[176:179], v[136:139], v[80:83]
    ds_read_b64_tr_b16 v[162:163], v31 offset:9216
    s_waitcnt lgkmcnt(8)
    v_mfma_f32_16x16x32_bf16 v[84:87], v[172:175], v[140:143], v[84:87]
    s_barrier
    ds_read_b128 v[164:167], v40 offset:16384
    v_mfma_f32_16x16x32_bf16 v[88:91], v[176:179], v[140:143], v[88:91]
    ds_read_b128 v[168:171], v42 offset:16384
    v_mfma_f32_16x16x32_bf16 v[92:95], v[172:175], v[144:147], v[92:95]
    ds_read_b64_tr_b16 v[132:133], v19 offset:0
    ds_read_b64_tr_b16 v[134:135], v19 offset:1024
    ds_read_b128 v[180:183], v41 offset:16384
    v_mfma_f32_16x16x32_bf16 v[96:99], v[176:179], v[144:147], v[96:99]
    ds_read_b128 v[184:187], v43 offset:16384
    v_mfma_f32_16x16x32_bf16 v[60:63], v[144:147], v[12:15], v[60:63]
    ds_read_b64_tr_b16 v[136:137], v19 offset:8192
    s_waitcnt lgkmcnt(11)
    v_mfma_f32_16x16x32_bf16 v[100:103], v[172:175], v[148:151], v[100:103]
    ds_read_b64_tr_b16 v[138:139], v19 offset:9216
    ds_read_b128 v[188:191], v40 offset:49152
    v_mfma_f32_16x16x32_bf16 v[104:107], v[176:179], v[148:151], v[104:107]
    ds_read_b128 v[192:195], v42 offset:49152
    v_mfma_f32_16x16x32_bf16 v[64:67], v[148:151], v[12:15], v[64:67]
    ds_read_b64_tr_b16 v[140:141], v19 offset:32768
    v_mfma_f32_16x16x32_bf16 v[108:111], v[172:175], v[152:155], v[108:111]
    ds_read_b64_tr_b16 v[142:143], v19 offset:33792
    ds_read_b128 v[196:199], v41 offset:49152
    v_mfma_f32_16x16x32_bf16 v[112:115], v[176:179], v[152:155], v[112:115]
    ds_read_b128 v[200:203], v43 offset:49152
    s_waitcnt lgkmcnt(14)
    v_mfma_f32_16x16x32_bf16 v[116:119], v[172:175], v[156:159], v[116:119]
    ds_read_b64_tr_b16 v[144:145], v19 offset:40960
    v_mfma_f32_16x16x32_bf16 v[120:123], v[176:179], v[156:159], v[120:123]
    ds_read_b64_tr_b16 v[146:147], v19 offset:41984
    v_mfma_f32_16x16x32_bf16 v[124:127], v[172:175], v[160:163], v[124:127]
    ds_read_b64_tr_b16 v[148:149], v20 offset:0
    v_mfma_f32_16x16x32_bf16 v[128:131], v[176:179], v[160:163], v[128:131]
    ds_read_b64_tr_b16 v[150:151], v20 offset:1024
    s_waitcnt lgkmcnt(10)
    v_mfma_f32_16x16x32_bf16 v[92:95], v[164:167], v[132:135], v[92:95]
    ds_read_b64_tr_b16 v[152:153], v20 offset:8192
    v_mfma_f32_16x16x32_bf16 v[96:99], v[168:171], v[132:135], v[96:99]
    ds_read_b64_tr_b16 v[154:155], v20 offset:9216
    v_mfma_f32_16x16x32_bf16 v[60:63], v[132:135], v[12:15], v[60:63]
    ds_read_b64_tr_b16 v[156:157], v20 offset:32768
    v_mfma_f32_16x16x32_bf16 v[92:95], v[180:183], v[136:139], v[92:95]
    ds_read_b64_tr_b16 v[158:159], v20 offset:33792
    v_mfma_f32_16x16x32_bf16 v[96:99], v[184:187], v[136:139], v[96:99]
    ds_read_b64_tr_b16 v[160:161], v20 offset:40960
    v_mfma_f32_16x16x32_bf16 v[60:63], v[136:139], v[12:15], v[60:63]
    ds_read_b64_tr_b16 v[162:163], v20 offset:41984
    s_waitcnt lgkmcnt(8)
    v_mfma_f32_16x16x32_bf16 v[92:95], v[188:191], v[140:143], v[92:95]
    ds_read_b64_tr_b16 v[132:133], v16 offset:0
    v_mfma_f32_16x16x32_bf16 v[96:99], v[192:195], v[140:143], v[96:99]
    ds_read_b64_tr_b16 v[134:135], v16 offset:1024
    v_mfma_f32_16x16x32_bf16 v[60:63], v[140:143], v[12:15], v[60:63]
    v_mfma_f32_16x16x32_bf16 v[92:95], v[196:199], v[144:147], v[92:95]
    ds_read_b64_tr_b16 v[136:137], v16 offset:8192
    v_mfma_f32_16x16x32_bf16 v[96:99], v[200:203], v[144:147], v[96:99]
    ds_read_b64_tr_b16 v[138:139], v16 offset:9216
    v_mfma_f32_16x16x32_bf16 v[60:63], v[144:147], v[12:15], v[60:63]
    s_waitcnt lgkmcnt(8)
    v_mfma_f32_16x16x32_bf16 v[100:103], v[164:167], v[148:151], v[100:103]
    ds_read_b64_tr_b16 v[140:141], v16 offset:32768
    v_mfma_f32_16x16x32_bf16 v[104:107], v[168:171], v[148:151], v[104:107]
    ds_read_b64_tr_b16 v[142:143], v16 offset:33792
    v_mfma_f32_16x16x32_bf16 v[64:67], v[148:151], v[12:15], v[64:67]
    v_mfma_f32_16x16x32_bf16 v[100:103], v[180:183], v[152:155], v[100:103]
    ds_read_b64_tr_b16 v[144:145], v16 offset:40960
    v_mfma_f32_16x16x32_bf16 v[104:107], v[184:187], v[152:155], v[104:107]
    ds_read_b64_tr_b16 v[146:147], v16 offset:41984
    v_mfma_f32_16x16x32_bf16 v[64:67], v[152:155], v[12:15], v[64:67]
    s_waitcnt lgkmcnt(8)
    v_mfma_f32_16x16x32_bf16 v[100:103], v[188:191], v[156:159], v[100:103]
    ds_read_b64_tr_b16 v[148:149], v17 offset:0
    v_mfma_f32_16x16x32_bf16 v[104:107], v[192:195], v[156:159], v[104:107]
    ds_read_b64_tr_b16 v[150:151], v17 offset:1024
    v_mfma_f32_16x16x32_bf16 v[64:67], v[156:159], v[12:15], v[64:67]
    v_mfma_f32_16x16x32_bf16 v[100:103], v[196:199], v[160:163], v[100:103]
    ds_read_b64_tr_b16 v[152:153], v17 offset:8192
    v_mfma_f32_16x16x32_bf16 v[104:107], v[200:203], v[160:163], v[104:107]
    ds_read_b64_tr_b16 v[154:155], v17 offset:9216
    v_mfma_f32_16x16x32_bf16 v[64:67], v[160:163], v[12:15], v[64:67]
    s_waitcnt lgkmcnt(8)
    v_mfma_f32_16x16x32_bf16 v[68:71], v[164:167], v[132:135], v[68:71]
    ds_read_b64_tr_b16 v[156:157], v17 offset:32768
    v_mfma_f32_16x16x32_bf16 v[72:75], v[168:171], v[132:135], v[72:75]
    ds_read_b64_tr_b16 v[158:159], v17 offset:33792
    v_mfma_f32_16x16x32_bf16 v[68:71], v[180:183], v[136:139], v[68:71]
    ds_read_b64_tr_b16 v[160:161], v17 offset:40960
    v_mfma_f32_16x16x32_bf16 v[72:75], v[184:187], v[136:139], v[72:75]
    ds_read_b64_tr_b16 v[162:163], v17 offset:41984
    s_waitcnt lgkmcnt(8)
    v_mfma_f32_16x16x32_bf16 v[68:71], v[188:191], v[140:143], v[68:71]
    ds_read_b64_tr_b16 v[132:133], v18 offset:0
    v_mfma_f32_16x16x32_bf16 v[72:75], v[192:195], v[140:143], v[72:75]
    ds_read_b64_tr_b16 v[134:135], v18 offset:1024
    s_lshl_b32 s27, s40, 7
    s_add_u32 s27, s27, 139264
    v_lshl_add_u32 v4, v2, 4, s27
    v_xor_b32 v5, 192, v4
    ds_write_b128 v5, v[60:63] offset:0
    v_xor_b32 v5, 256, v4
    ds_write_b128 v5, v[64:67] offset:0
    v_lshl_add_u32 v4, v3, 2, s27
    s_waitcnt vmcnt(0) lgkmcnt(0)
    s_barrier
    v_xor_b32 v5, 192, v4
    ds_read_b32 v207, v5 offset:0
    v_xor_b32 v5, 256, v4
    ds_read_b32 v208, v5 offset:0
    v_xor_b32 v5, 0, v4
    ds_read_b32 v204, v5 offset:0
    v_xor_b32 v5, 64, v4
    ds_read_b32 v205, v5 offset:0
    v_xor_b32 v5, 128, v4
    ds_read_b32 v206, v5 offset:0
    v_xor_b32 v5, 320, v4
    ds_read_b32 v209, v5 offset:0
    v_xor_b32 v5, 384, v4
    ds_read_b32 v210, v5 offset:0
    v_xor_b32 v5, 448, v4
    ds_read_b32 v211, v5 offset:0
    v_mfma_f32_16x16x32_bf16 v[68:71], v[196:199], v[144:147], v[68:71]
    ds_read_b64_tr_b16 v[136:137], v18 offset:8192
    v_mfma_f32_16x16x32_bf16 v[72:75], v[200:203], v[144:147], v[72:75]
    ds_read_b64_tr_b16 v[138:139], v18 offset:9216
    s_waitcnt lgkmcnt(15)
    v_mfma_f32_16x16x32_bf16 v[76:79], v[164:167], v[148:151], v[76:79]
    ds_read_b64_tr_b16 v[140:141], v18 offset:32768
    v_mfma_f32_16x16x32_bf16 v[80:83], v[168:171], v[148:151], v[80:83]
    ds_read_b64_tr_b16 v[142:143], v18 offset:33792
    v_mfma_f32_16x16x32_bf16 v[76:79], v[180:183], v[152:155], v[76:79]
    ds_read_b64_tr_b16 v[144:145], v18 offset:40960
    v_mfma_f32_16x16x32_bf16 v[80:83], v[184:187], v[152:155], v[80:83]
    ds_read_b64_tr_b16 v[146:147], v18 offset:41984
    s_waitcnt lgkmcnt(6)
    v_pk_fma_f32 v[92:93], v[212:213], v[206:207], v[92:93] op_sel:[0,1,0] op_sel_hi:[1,1,1]
    v_pk_fma_f32 v[94:95], v[214:215], v[206:207], v[94:95] op_sel:[0,1,0] op_sel_hi:[1,1,1]
    v_pk_fma_f32 v[96:97], v[216:217], v[206:207], v[96:97] op_sel:[0,1,0] op_sel_hi:[1,1,1]
    v_pk_fma_f32 v[98:99], v[218:219], v[206:207], v[98:99] op_sel:[0,1,0] op_sel_hi:[1,1,1]
    v_pk_mul_f32 v[92:93], v[92:93], v[220:221]
    v_pk_mul_f32 v[94:95], v[94:95], v[222:223]
    v_pk_mul_f32 v[96:97], v[96:97], v[224:225]
    v_pk_mul_f32 v[98:99], v[98:99], v[226:227]
    v_cvt_pk_bf16_f32 v92, v92, v93
    v_cvt_pk_bf16_f32 v93, v94, v95
    v_cvt_pk_bf16_f32 v94, v96, v97
    v_cvt_pk_bf16_f32 v95, v98, v99
    buffer_store_dwordx4 v[92:95], v55, s[20:23], 0 offen sc1
    s_waitcnt lgkmcnt(15)
    v_mfma_f32_16x16x32_bf16 v[76:79], v[188:191], v[156:159], v[76:79]
    ds_read_b64_tr_b16 v[148:149], v21 offset:0
    v_mfma_f32_16x16x32_bf16 v[80:83], v[192:195], v[156:159], v[80:83]
    ds_read_b64_tr_b16 v[150:151], v21 offset:1024
    v_mfma_f32_16x16x32_bf16 v[76:79], v[196:199], v[160:163], v[76:79]
    ds_read_b64_tr_b16 v[152:153], v21 offset:8192
    v_mfma_f32_16x16x32_bf16 v[80:83], v[200:203], v[160:163], v[80:83]
    ds_read_b64_tr_b16 v[154:155], v21 offset:9216
    s_waitcnt lgkmcnt(8)
    v_mfma_f32_16x16x32_bf16 v[84:87], v[164:167], v[132:135], v[84:87]
    ds_read_b64_tr_b16 v[156:157], v21 offset:32768
    v_mfma_f32_16x16x32_bf16 v[88:91], v[168:171], v[132:135], v[88:91]
    ds_read_b64_tr_b16 v[158:159], v21 offset:33792
    v_pk_fma_f32 v[100:101], v[212:213], v[208:209], v[100:101] op_sel:[0,0,0] op_sel_hi:[1,0,1]
    v_pk_fma_f32 v[102:103], v[214:215], v[208:209], v[102:103] op_sel:[0,0,0] op_sel_hi:[1,0,1]
    v_pk_fma_f32 v[104:105], v[216:217], v[208:209], v[104:105] op_sel:[0,0,0] op_sel_hi:[1,0,1]
    v_pk_fma_f32 v[106:107], v[218:219], v[208:209], v[106:107] op_sel:[0,0,0] op_sel_hi:[1,0,1]
    v_pk_mul_f32 v[100:101], v[100:101], v[220:221]
    v_pk_mul_f32 v[102:103], v[102:103], v[222:223]
    v_pk_mul_f32 v[104:105], v[104:105], v[224:225]
    v_pk_mul_f32 v[106:107], v[106:107], v[226:227]
    v_cvt_pk_bf16_f32 v100, v100, v101
    v_cvt_pk_bf16_f32 v101, v102, v103
    v_cvt_pk_bf16_f32 v102, v104, v105
    v_cvt_pk_bf16_f32 v103, v106, v107
    buffer_store_dwordx4 v[100:103], v56, s[20:23], 0 offen sc1
    v_mfma_f32_16x16x32_bf16 v[84:87], v[180:183], v[136:139], v[84:87]
    ds_read_b64_tr_b16 v[160:161], v21 offset:40960
    v_mfma_f32_16x16x32_bf16 v[88:91], v[184:187], v[136:139], v[88:91]
    ds_read_b64_tr_b16 v[162:163], v21 offset:41984
    s_waitcnt lgkmcnt(8)
    v_mfma_f32_16x16x32_bf16 v[84:87], v[188:191], v[140:143], v[84:87]
    ds_read_b64_tr_b16 v[132:133], v22 offset:0
    v_mfma_f32_16x16x32_bf16 v[88:91], v[192:195], v[140:143], v[88:91]
    ds_read_b64_tr_b16 v[134:135], v22 offset:1024
    v_mfma_f32_16x16x32_bf16 v[84:87], v[196:199], v[144:147], v[84:87]
    ds_read_b64_tr_b16 v[136:137], v22 offset:8192
    v_mfma_f32_16x16x32_bf16 v[88:91], v[200:203], v[144:147], v[88:91]
    ds_read_b64_tr_b16 v[138:139], v22 offset:9216
    v_pk_fma_f32 v[68:69], v[212:213], v[204:205], v[68:69] op_sel:[0,0,0] op_sel_hi:[1,0,1]
    v_pk_fma_f32 v[70:71], v[214:215], v[204:205], v[70:71] op_sel:[0,0,0] op_sel_hi:[1,0,1]
    v_pk_fma_f32 v[72:73], v[216:217], v[204:205], v[72:73] op_sel:[0,0,0] op_sel_hi:[1,0,1]
    v_pk_fma_f32 v[74:75], v[218:219], v[204:205], v[74:75] op_sel:[0,0,0] op_sel_hi:[1,0,1]
    v_pk_mul_f32 v[68:69], v[68:69], v[220:221]
    v_pk_mul_f32 v[70:71], v[70:71], v[222:223]
    v_pk_mul_f32 v[72:73], v[72:73], v[224:225]
    v_pk_mul_f32 v[74:75], v[74:75], v[226:227]
    v_cvt_pk_bf16_f32 v68, v68, v69
    v_cvt_pk_bf16_f32 v69, v70, v71
    v_cvt_pk_bf16_f32 v70, v72, v73
    v_cvt_pk_bf16_f32 v71, v74, v75
    buffer_store_dwordx4 v[68:71], v52, s[20:23], 0 offen sc1
    s_waitcnt lgkmcnt(8)
    v_mfma_f32_16x16x32_bf16 v[108:111], v[164:167], v[148:151], v[108:111]
    ds_read_b64_tr_b16 v[140:141], v22 offset:32768
    v_mfma_f32_16x16x32_bf16 v[112:115], v[168:171], v[148:151], v[112:115]
    ds_read_b64_tr_b16 v[142:143], v22 offset:33792
    v_mfma_f32_16x16x32_bf16 v[108:111], v[180:183], v[152:155], v[108:111]
    ds_read_b64_tr_b16 v[144:145], v22 offset:40960
    v_mfma_f32_16x16x32_bf16 v[112:115], v[184:187], v[152:155], v[112:115]
    ds_read_b64_tr_b16 v[146:147], v22 offset:41984
    s_waitcnt lgkmcnt(8)
    v_mfma_f32_16x16x32_bf16 v[108:111], v[188:191], v[156:159], v[108:111]
    ds_read_b64_tr_b16 v[148:149], v23 offset:0
    v_mfma_f32_16x16x32_bf16 v[112:115], v[192:195], v[156:159], v[112:115]
    ds_read_b64_tr_b16 v[150:151], v23 offset:1024
    v_pk_fma_f32 v[76:77], v[212:213], v[204:205], v[76:77] op_sel:[0,1,0] op_sel_hi:[1,1,1]
    v_pk_fma_f32 v[78:79], v[214:215], v[204:205], v[78:79] op_sel:[0,1,0] op_sel_hi:[1,1,1]
    v_pk_fma_f32 v[80:81], v[216:217], v[204:205], v[80:81] op_sel:[0,1,0] op_sel_hi:[1,1,1]
    v_pk_fma_f32 v[82:83], v[218:219], v[204:205], v[82:83] op_sel:[0,1,0] op_sel_hi:[1,1,1]
    v_pk_mul_f32 v[76:77], v[76:77], v[220:221]
    v_pk_mul_f32 v[78:79], v[78:79], v[222:223]
    v_pk_mul_f32 v[80:81], v[80:81], v[224:225]
    v_pk_mul_f32 v[82:83], v[82:83], v[226:227]
    v_cvt_pk_bf16_f32 v76, v76, v77
    v_cvt_pk_bf16_f32 v77, v78, v79
    v_cvt_pk_bf16_f32 v78, v80, v81
    v_cvt_pk_bf16_f32 v79, v82, v83
    buffer_store_dwordx4 v[76:79], v53, s[20:23], 0 offen sc1
    v_mfma_f32_16x16x32_bf16 v[108:111], v[196:199], v[160:163], v[108:111]
    ds_read_b64_tr_b16 v[152:153], v23 offset:8192
    v_mfma_f32_16x16x32_bf16 v[112:115], v[200:203], v[160:163], v[112:115]
    ds_read_b64_tr_b16 v[154:155], v23 offset:9216
    s_waitcnt lgkmcnt(8)
    v_mfma_f32_16x16x32_bf16 v[116:119], v[164:167], v[132:135], v[116:119]
    ds_read_b64_tr_b16 v[156:157], v23 offset:32768
    v_mfma_f32_16x16x32_bf16 v[120:123], v[168:171], v[132:135], v[120:123]
    ds_read_b64_tr_b16 v[158:159], v23 offset:33792
    v_mfma_f32_16x16x32_bf16 v[116:119], v[180:183], v[136:139], v[116:119]
    ds_read_b64_tr_b16 v[160:161], v23 offset:40960
    v_mfma_f32_16x16x32_bf16 v[120:123], v[184:187], v[136:139], v[120:123]
    ds_read_b64_tr_b16 v[162:163], v23 offset:41984
    v_pk_fma_f32 v[84:85], v[212:213], v[206:207], v[84:85] op_sel:[0,0,0] op_sel_hi:[1,0,1]
    v_pk_fma_f32 v[86:87], v[214:215], v[206:207], v[86:87] op_sel:[0,0,0] op_sel_hi:[1,0,1]
    v_pk_fma_f32 v[88:89], v[216:217], v[206:207], v[88:89] op_sel:[0,0,0] op_sel_hi:[1,0,1]
    v_pk_fma_f32 v[90:91], v[218:219], v[206:207], v[90:91] op_sel:[0,0,0] op_sel_hi:[1,0,1]
    v_pk_mul_f32 v[84:85], v[84:85], v[220:221]
    v_pk_mul_f32 v[86:87], v[86:87], v[222:223]
    v_pk_mul_f32 v[88:89], v[88:89], v[224:225]
    v_pk_mul_f32 v[90:91], v[90:91], v[226:227]
    v_cvt_pk_bf16_f32 v84, v84, v85
    v_cvt_pk_bf16_f32 v85, v86, v87
    v_cvt_pk_bf16_f32 v86, v88, v89
    v_cvt_pk_bf16_f32 v87, v90, v91
    buffer_store_dwordx4 v[84:87], v54, s[20:23], 0 offen sc1
    s_waitcnt lgkmcnt(8)
    v_mfma_f32_16x16x32_bf16 v[116:119], v[188:191], v[140:143], v[116:119]
    v_mfma_f32_16x16x32_bf16 v[120:123], v[192:195], v[140:143], v[120:123]
    v_mfma_f32_16x16x32_bf16 v[116:119], v[196:199], v[144:147], v[116:119]
    v_mfma_f32_16x16x32_bf16 v[120:123], v[200:203], v[144:147], v[120:123]
    s_waitcnt lgkmcnt(4)
    v_mfma_f32_16x16x32_bf16 v[124:127], v[164:167], v[148:151], v[124:127]
    v_mfma_f32_16x16x32_bf16 v[128:131], v[168:171], v[148:151], v[128:131]
    v_pk_fma_f32 v[108:109], v[212:213], v[208:209], v[108:109] op_sel:[0,1,0] op_sel_hi:[1,1,1]
    v_pk_fma_f32 v[110:111], v[214:215], v[208:209], v[110:111] op_sel:[0,1,0] op_sel_hi:[1,1,1]
    v_pk_fma_f32 v[112:113], v[216:217], v[208:209], v[112:113] op_sel:[0,1,0] op_sel_hi:[1,1,1]
    v_pk_fma_f32 v[114:115], v[218:219], v[208:209], v[114:115] op_sel:[0,1,0] op_sel_hi:[1,1,1]
    v_pk_mul_f32 v[108:109], v[108:109], v[220:221]
    v_pk_mul_f32 v[110:111], v[110:111], v[222:223]
    v_pk_mul_f32 v[112:113], v[112:113], v[224:225]
    v_pk_mul_f32 v[114:115], v[114:115], v[226:227]
    v_cvt_pk_bf16_f32 v108, v108, v109
    v_cvt_pk_bf16_f32 v109, v110, v111
    v_cvt_pk_bf16_f32 v110, v112, v113
    v_cvt_pk_bf16_f32 v111, v114, v115
    buffer_store_dwordx4 v[108:111], v57, s[20:23], 0 offen sc1
    v_mfma_f32_16x16x32_bf16 v[124:127], v[180:183], v[152:155], v[124:127]
    v_mfma_f32_16x16x32_bf16 v[128:131], v[184:187], v[152:155], v[128:131]
    s_waitcnt lgkmcnt(0)
    v_mfma_f32_16x16x32_bf16 v[124:127], v[188:191], v[156:159], v[124:127]
    v_mfma_f32_16x16x32_bf16 v[128:131], v[192:195], v[156:159], v[128:131]
    v_mfma_f32_16x16x32_bf16 v[124:127], v[196:199], v[160:163], v[124:127]
    v_mfma_f32_16x16x32_bf16 v[128:131], v[200:203], v[160:163], v[128:131]
    v_pk_fma_f32 v[116:117], v[212:213], v[210:211], v[116:117] op_sel:[0,0,0] op_sel_hi:[1,0,1]
    v_pk_fma_f32 v[118:119], v[214:215], v[210:211], v[118:119] op_sel:[0,0,0] op_sel_hi:[1,0,1]
    v_pk_fma_f32 v[120:121], v[216:217], v[210:211], v[120:121] op_sel:[0,0,0] op_sel_hi:[1,0,1]
    v_pk_fma_f32 v[122:123], v[218:219], v[210:211], v[122:123] op_sel:[0,0,0] op_sel_hi:[1,0,1]
    v_pk_mul_f32 v[116:117], v[116:117], v[220:221]
    v_pk_mul_f32 v[118:119], v[118:119], v[222:223]
    v_pk_mul_f32 v[120:121], v[120:121], v[224:225]
    v_pk_mul_f32 v[122:123], v[122:123], v[226:227]
    v_cvt_pk_bf16_f32 v116, v116, v117
    v_cvt_pk_bf16_f32 v117, v118, v119
    v_cvt_pk_bf16_f32 v118, v120, v121
    v_cvt_pk_bf16_f32 v119, v122, v123
    buffer_store_dwordx4 v[116:119], v58, s[20:23], 0 offen sc1
    s_nop 7
    v_pk_fma_f32 v[124:125], v[212:213], v[210:211], v[124:125] op_sel:[0,1,0] op_sel_hi:[1,1,1]
    v_pk_fma_f32 v[126:127], v[214:215], v[210:211], v[126:127] op_sel:[0,1,0] op_sel_hi:[1,1,1]
    v_pk_fma_f32 v[128:129], v[216:217], v[210:211], v[128:129] op_sel:[0,1,0] op_sel_hi:[1,1,1]
    v_pk_fma_f32 v[130:131], v[218:219], v[210:211], v[130:131] op_sel:[0,1,0] op_sel_hi:[1,1,1]
    v_pk_mul_f32 v[124:125], v[124:125], v[220:221]
    v_pk_mul_f32 v[126:127], v[126:127], v[222:223]
    v_pk_mul_f32 v[128:129], v[128:129], v[224:225]
    v_pk_mul_f32 v[130:131], v[130:131], v[226:227]
    v_cvt_pk_bf16_f32 v124, v124, v125
    v_cvt_pk_bf16_f32 v125, v126, v127
    v_cvt_pk_bf16_f32 v126, v128, v129
    v_cvt_pk_bf16_f32 v127, v130, v131
    buffer_store_dwordx4 v[124:127], v59, s[20:23], 0 offen sc1
    s_lshl_b32 s68, s25, 4
    s_add_u32 s68, s68, s24
    s_lshl_b32 s68, s68, 7
    s_add_u32 s68, s68, 32611456
    s_branch L_m_entry
L_p1_end:
    s_endpgm
L_p1_aux:
    s_cmp_ge_u32 s2, 256
    s_cbranch_scc1 L_p1_end
    s_sub_u32 s24, s2, 240
    s_cmp_ge_u32 s26, 4
    s_cbranch_scc1 L_p1_aux1
    s_mov_b32 s40, s26
    s_waitcnt lgkmcnt(0)
    s_mov_b32 s12, s4
    s_mov_b32 s13, s5
    s_mov_b32 s14, 2621440
    s_mov_b32 s15, 0x20000
    s_cmp_lg_u32 s26, 0
    s_cbranch_scc1 L_p1_aux0
    s_add_u32 s20, s10, 33067008
    s_addc_u32 s21, s11, 0
    s_mov_b32 s22, 4096
    s_mov_b32 s23, 0x20000
    s_mov_b32 s60, s8
    s_mov_b32 s61, s9
    s_mov_b32 s62, 256
    s_mov_b32 s63, 0x20000
    s_lshl_b32 s27, s24, 8
    v_lshlrev_b32 v4, 2, v1
    v_mov_b32 v5, 0
    buffer_store_dword v5, v4, s[20:23], s27 offen sc1
    s_lshl_b32 s27, s24, 2
    v_mov_b32 v5, 1
    s_mov_b64 exec, 1
    s_waitcnt vmcnt(0)
    buffer_store_dword v5, off, s[60:63], s27 sc1
    s_mov_b64 exec, -1
L_p1_aux0:
    s_add_u32 s56, s10, 33050624
    s_addc_u32 s57, s11, 0
    s_mov_b32 s58, 20480
    s_mov_b32 s59, 0x20000
    s_mov_b32 s60, s8
    s_mov_b32 s61, s9
    s_mov_b32 s62, 256
    s_mov_b32 s63, 0x20000
    s_lshl_b32 s66, s24, 4
    s_add_u32 s66, s66, 15
    s_lshl_b32 s66, s66, 2
    s_add_u32 s66, s66, s40
    s_mul_i32 s27, s66, 2560
    v_lshrrev_b32 v4, 5, v1
    v_lshlrev_b32 v229, 2, v4
    v_mul_u32_u24 v4, 1280, v4
    v_and_b32 v5, 31, v1
    v_lshl_add_u32 v4, v5, 4, v4
    v_and_b32 v5, 16, v1
    v_lshl_add_u32 v5, v5, 26, v4
    buffer_load_dwordx4 v[212:215], v4, s[12:15], s27 offen
    buffer_load_dwordx4 v[216:219], v4, s[12:15], s27 offen offset:512
    buffer_load_dwordx4 v[220:223], v5, s[12:15], s27 offen offset:1024
    s_barrier
    v_mov_b32 v228, 0x3f803f80
    s_waitcnt vmcnt(0)
    v_dot2_f32_bf16 v224, v212, v228, 0
    v_dot2_f32_bf16 v225, v212, v212, 0
    v_dot2_f32_bf16 v224, v213, v228, v224
    v_dot2_f32_bf16 v225, v213, v213, v225
    v_dot2_f32_bf16 v224, v214, v228, v224
    v_dot2_f32_bf16 v225, v214, v214, v225
    v_dot2_f32_bf16 v224, v215, v228, v224
    v_dot2_f32_bf16 v225, v215, v215, v225
    v_dot2_f32_bf16 v224, v216, v228, v224
    v_dot2_f32_bf16 v225, v216, v216, v225
    v_dot2_f32_bf16 v224, v217, v228, v224
    v_dot2_f32_bf16 v225, v217, v217, v225
    v_dot2_f32_bf16 v224, v218, v228, v224
    v_dot2_f32_bf16 v225, v218, v218, v225
    v_dot2_f32_bf16 v224, v219, v228, v224
    v_dot2_f32_bf16 v225, v219, v219, v225
    v_dot2_f32_bf16 v224, v220, v228, v224
    v_dot2_f32_bf16 v225, v220, v220, v225
    v_dot2_f32_bf16 v224, v221, v228, v224
    v_dot2_f32_bf16 v225, v221, v221, v225
    v_dot2_f32_bf16 v224, v222, v228, v224
    v_dot2_f32_bf16 v225, v222, v222, v225
    v_dot2_f32_bf16 v224, v223, v228, v224
    v_dot2_f32_bf16 v225, v223, v223, v225
    s_lshl_b32 s27, s24, 2
    buffer_load_dword v228, off, s[60:63], s27 sc1
    s_nop 0
    v_add_f32_dpp v224, v224, v224 row_ror:8 row_mask:0xf bank_mask:0xf
    v_add_f32_dpp v225, v225, v225 row_ror:8 row_mask:0xf bank_mask:0xf
    s_nop 0
    v_add_f32_dpp v224, v224, v224 row_ror:4 row_mask:0xf bank_mask:0xf
    v_add_f32_dpp v225, v225, v225 row_ror:4 row_mask:0xf bank_mask:0xf
    s_nop 0
    v_add_f32_dpp v224, v224, v224 row_ror:2 row_mask:0xf bank_mask:0xf
    v_add_f32_dpp v225, v225, v225 row_ror:2 row_mask:0xf bank_mask:0xf
    s_nop 0
    v_add_f32_dpp v224, v224, v224 row_ror:1 row_mask:0xf bank_mask:0xf
    v_add_f32_dpp v225, v225, v225 row_ror:1 row_mask:0xf bank_mask:0xf
    s_nop 0
    v_mov_b32 v226, v224
    v_mov_b32 v227, v225
    s_nop 1
    v_permlane16_swap_b32 v224, v226
    v_permlane16_swap_b32 v225, v227
    v_add_f32 v224, v224, v226
    v_add_f32 v225, v225, v227
    v_mul_f32 v224, 0xbacccccd, v224
    v_mul_f32 v225, 0x3acccccd, v225
    v_fma_f32 v225, -v224, v224, v225
    v_max_f32 v225, 0, v225
    v_add_f32 v225, 0x3727c5ac, v225
    v_rsq_f32 v225, v225
    s_lshl_b32 s27, s66, 3
    s_add_u32 s67, s27, 8192
    s_mov_b32 exec_lo, 1
    s_mov_b32 exec_hi, 1
    buffer_store_dword v224, v229, s[56:59], s27 offen sc1
    buffer_store_dword v225, v229, s[56:59], s67 offen sc1
    s_mov_b64 exec, -1
    s_mov_b32 s43, 400000
L_p1_rfa:
    s_waitcnt vmcnt(0)
    v_readfirstlane_b32 s67, v228
    s_cmp_eq_u32 s67, 0
    s_cbranch_scc1 L_p1_rfwa
    s_lshl_b32 s67, s66, 2
    s_add_u32 s67, s67, 16384
    s_mov_b64 exec, 1
    buffer_store_dword v228, off, s[56:59], s67 sc1
    s_mov_b64 exec, -1
L_p1_rfxa:
    s_barrier
    s_mov_b32 s68, 32642176
    s_branch L_m_entry
    s_endpgm
L_p1_rfwq:
    s_sub_u32 s43, s43, 1
    s_cmp_eq_u32 s43, 0
    s_cbranch_scc1 L_p1_rfxq
    s_lshl_b32 s67, s24, 2
    s_sleep 2
    buffer_load_dword v228, off, s[60:63], s67 sc1
    s_branch L_p1_rfq
L_p1_spwq:
    s_sub_u32 s43, s43, 1
    s_cmp_eq_u32 s43, 0
    s_cbranch_scc1 L_p1_spxq
    s_sleep 2
    buffer_load_dword v240, v241, s[56:59], s42 offen sc1
    s_branch L_p1_spq
L_p1_rfwv:
    s_sub_u32 s43, s43, 1
    s_cmp_eq_u32 s43, 0
    s_cbranch_scc1 L_p1_rfxv
    s_lshl_b32 s67, s24, 2
    s_sleep 2
    buffer_load_dword v228, off, s[60:63], s67 sc1
    s_branch L_p1_rfv
L_p1_spwv:
    s_sub_u32 s43, s43, 1
    s_cmp_eq_u32 s43, 0
    s_cbranch_scc1 L_p1_spxv
    s_sleep 2
    buffer_load_dword v240, v241, s[56:59], s42 offen sc1
    s_branch L_p1_spv
L_p1_rfwa:
    s_sub_u32 s43, s43, 1
    s_cmp_eq_u32 s43, 0
    s_cbranch_scc1 L_p1_rfxa
    s_lshl_b32 s67, s24, 2
    s_sleep 2
    buffer_load_dword v228, off, s[60:63], s67 sc1
    s_branch L_p1_rfa
L_p1_aux1:
    s_waitcnt lgkmcnt(0)
    s_add_u32 s20, s10, 32526336
    s_addc_u32 s21, s11, 0
    s_mov_b32 s22, 196608
    s_mov_b32 s23, 0x20000
    s_mul_i32 s27, s24, 12288
    v_and_b32 v5, 255, v0
    v_lshlrev_b32 v4, 4, v5
    v_mov_b32 v8, 0
    v_mov_b32 v9, 0
    v_mov_b32 v10, 0
    v_mov_b32 v11, 0
    buffer_store_dwordx4 v[8:11], v4, s[20:23], s27 offen sc1
    s_add_u32 s27, s27, 4096
    buffer_store_dwordx4 v[8:11], v4, s[20:23], s27 offen sc1
    s_add_u32 s27, s27, 4096
    buffer_store_dwordx4 v[8:11], v4, s[20:23], s27 offen sc1
    s_add_u32 s27, s27, 4096
L_p1_aux2:
    s_waitcnt vmcnt(0)
    s_barrier
    s_mov_b32 s60, s8
    s_mov_b32 s61, s9
    s_mov_b32 s62, 256
    s_mov_b32 s63, 0x20000
    s_cmp_lg_u32 s26, 4
    s_cbranch_scc1 L_p1_aux3
    s_lshl_b32 s27, s24, 2
    v_mov_b32 v8, 1
    s_mov_b64 exec, 1
    buffer_store_dword v8, off, s[60:63], s27 offset:64 sc1
    s_mov_b64 exec, -1
L_p1_aux3:
    s_getpc_b64 s[28:29]
L_p1_pc:
    s_add_u32 s28, s28, L_m_entry-L_p1_pc
    s_addc_u32 s29, s29, 0
    s_mov_b32 s30, L_m_last-L_m_entry
    s_mov_b32 s31, 0x20000
    s_lshr_b32 s27, s24, 3
    s_lshl_b32 s27, s27, 12
    buffer_load_dwordx4 v[16:19], v4, s[28:31], s27 offen
    s_add_u32 s27, s27, 8192
    buffer_load_dwordx4 v[20:23], v4, s[28:31], s27 offen
    s_add_u32 s27, s27, 8192
    buffer_load_dwordx4 v[24:27], v4, s[28:31], s27 offen
    s_add_u32 s27, s27, 8192
    buffer_load_dwordx4 v[28:31], v4, s[28:31], s27 offen
    s_add_u32 s27, s27, 8192
    buffer_load_dwordx4 v[32:35], v4, s[28:31], s27 offen
    s_add_u32 s27, s27, 8192
    buffer_load_dwordx4 v[36:39], v4, s[28:31], s27 offen
    s_add_u32 s27, s27, 8192
    buffer_load_dwordx4 v[40:43], v4, s[28:31], s27 offen
    s_add_u32 s27, s27, 8192
    buffer_load_dwordx4 v[44:47], v4, s[28:31], s27 offen
    s_add_u32 s27, s27, 8192
    v_lshlrev_b32 v6, 2, v3
    v_lshlrev_b32 v4, 2, v1
    v_add_u32 v4, 162304, v4
    v_mov_b32 v5, 0
    ds_write_b32 v4, v5
    s_mov_b32 s43, 400000
L_p1_z0a:
    buffer_load_dword v7, v6, s[60:63], 0 offen offset:64 sc1
L_p1_z1a:
    s_sub_u32 s43, s43, 1
    s_waitcnt vmcnt(0) lgkmcnt(0)
    v_cmp_eq_u32 vcc, 0, v7
    s_cmp_eq_u32 s43, 0
    s_cbranch_scc1 L_p1_z2a
    s_cbranch_vccnz L_p1_z0a
L_p1_z2a:
    s_barrier
    s_branch L_m_entry
    s_endpgm
.p2align 6
L_m_entry:
    s_load_dwordx2 s[8:9], s[0:1], 80
    s_load_dwordx2 s[4:5], s[0:1], 0
    s_load_dwordx2 s[6:7], s[0:1], 16
    s_load_dwordx8 s[44:51], s[0:1], 32
    s_load_dwordx2 s[10:11], s[0:1], 64
    v_lshrrev_b32 v8, 6, v0
    v_and_b32 v1, 63, v0
    v_readfirstlane_b32 s26, v8
    v_lshlrev_b32 v2, 4, v1
    v_lshrrev_b32 v3, 4, v1
    v_and_b32 v4, 15, v1
    v_mov_b32 v6, 1
    s_and_b32 s30, s2, 7
    s_lshr_b32 s31, s2, 3
    s_and_b32 s24, s31, 3
    s_lshl_b32 s30, s30, 2
    s_add_u32 s24, s24, s30
    s_lshr_b32 s25, s2, 5
    s_mov_b32 s29, 0
    s_mul_i32 s31, s24, 245760
    s_add_u32 s30, s31, 81920
    s_mov_b32 s14, 163840
    s_mov_b32 s15, 0x20000
    s_mov_b32 s18, 81920
    s_mov_b32 s19, 0x20000
    s_mov_b32 s22, 33234944
    s_mov_b32 s23, 0x20000
    s_cmp_ge_u32 s26, 4
    s_cbranch_scc1 L_m_H
    v_mov_b32 v7, 162352
    s_mov_b64 exec, 1
    ds_add_u32 v7, v6 offset:72
    s_mov_b64 exec, -1
    s_setprio 2
    s_and_b32 s27, s26, 1
    s_lshr_b32 s28, s26, 1
    s_lshl_b32 s32, s25, 3
    s_lshl_b32 s33, s27, 2
    s_add_u32 s32, s32, s33
    s_lshl_b32 s33, s28, 1
    s_add_u32 s36, s32, s33
    s_xor_b32 s37, s36, 1
    s_xor_b32 s38, s36, 2
    s_xor_b32 s39, s36, 3
    v_and_b32 v8, 31, v1
    v_lshrrev_b32 v9, 5, v1
    v_lshlrev_b32 v10, 2, v9
    v_lshl_add_u32 v31, v8, 3, v10
    v_add_u32 v31, 4096, v31
    v_lshlrev_b32 v10, 11, v9
    v_lshl_add_u32 v32, v8, 3, v10
    s_mov_b32 s67, 0
    s_mov_b32 s40, 0x000fffff
    s_mov_b32 s41, 0x000fffff
    s_mul_i32 s52, s28, 40960
    v_mul_u32_u24 v10, 320, v9
    v_lshl_add_u32 v10, v8, 4, v10
    v_add_u32 v36, s52, v10
    v_add_u32 v34, s52, v32
    v_add_u32 v33, 256, v34
    v_add_u32 v35, s52, v31
    v_cmp_eq_u32 vcc, 20, v8
    v_mov_b32 v10, 0x3f803f80
    v_mov_b32 v30, 0xdddddddd
    v_cndmask_b32 v11, 0, v10, vcc
    v_mov_b32 v81, 0x3f803f80
    v_mov_b32 v84, v11
    v_mov_b32 v85, v11
    v_mov_b32 v86, v11
    v_mov_b32 v87, v11
    v_mov_b32 v88, v11
    v_mov_b32 v89, v11
    v_mov_b32 v90, v11
    v_mov_b32 v91, v11
    v_mov_b32 v83, 0x3f803f80
    v_mov_b32 v92, v11
    v_mov_b32 v93, v11
    v_mov_b32 v94, v11
    v_mov_b32 v95, v11
    v_mov_b32 v96, v11
    v_mov_b32 v97, v11
    v_mov_b32 v98, v11
    v_mov_b32 v99, v11
    s_lshr_b32 s52, s24, 3
    s_mul_i32 s52, s52, 5120
    s_add_u32 s52, s52, 8912896
    s_mul_i32 s53, s36, 40960
    s_add_u32 s52, s52, s53
    s_and_b32 s53, s24, 7
    s_lshl_b32 s54, s53, 9
    s_add_u32 s54, s54, s52
    v_bfe_u32 v10, v1, 4, 1
    v_mul_u32_u24 v10, 20480, v10
    v_lshl_add_u32 v10, v9, 8, v10
    v_lshl_add_u32 v10, v4, 4, v10
    v_add_u32 v44, s54, v10
    s_lshl_b32 s53, s53, 7
    s_add_u32 s53, s53, s52
    s_add_u32 s53, s53, 4096
    v_mul_u32_u24 v10, 20480, v3
    v_lshl_add_u32 v10, v4, 3, v10
    v_add_u32 v45, s53, v10
    s_lshl_b32 s52, s26, 2
    s_add_u32 s52, s52, 162320
    v_mov_b32 v5, s52
    s_lshl_b32 s52, s28, 2
    s_add_u32 s52, s52, 162304
    v_mov_b32 v37, s52
    s_lshr_b32 s33, s36, 2
    s_mul_i32 s33, s33, 5120
    s_mul_i32 s52, s28, 3072
    s_add_u32 s33, s33, s52
    s_mul_i32 s34, s27, 6144
    s_add_u32 s34, s34, 122880
    s_add_u32 s35, s34, s52
    s_mul_i32 s52, s27, 5120
    s_mul_i32 s62, s28, 81920
    s_add_u32 s62, s62, s52
    s_mul_i32 s63, s28, 40960
    s_add_u32 s63, s63, s52
    s_waitcnt lgkmcnt(0)
    s_add_u32 s12, s8, s30
    s_addc_u32 s13, s9, 0
    s_add_u32 s16, s8, s31
    s_addc_u32 s17, s9, 0
    s_mov_b32 s20, s8
    s_mov_b32 s21, s9
    s_mov_b64 exec, 1
    s_waitcnt vmcnt(0)
    ds_add_rtn_u32 v10, v7, v6 offset:64
    s_waitcnt lgkmcnt(0)
    v_readfirstlane_b32 s52, v10
    s_cmp_lg_u32 s52, 3
    s_cbranch_scc1 L_m_kw
    buffer_store_dword v6, off, s[20:23], s68 sc1
L_m_kw:
    s_mov_b64 exec, -1
L_m_att:
    v_mov_b32 v65, 0
    v_mov_b32 v40, 0xff800000
    v_mov_b32 v164, 0
    v_mov_b32 v165, 0
    v_mov_b32 v166, 0
    v_mov_b32 v167, 0
    v_mov_b32 v168, 0
    v_mov_b32 v169, 0
    v_mov_b32 v170, 0
    v_mov_b32 v171, 0
    v_mov_b32 v172, 0
    v_mov_b32 v173, 0
    v_mov_b32 v174, 0
    v_mov_b32 v175, 0
    v_mov_b32 v176, 0
    v_mov_b32 v177, 0
    v_mov_b32 v178, 0
    v_mov_b32 v179, 0
    v_mov_b32 v67, 0
    v_mov_b32 v41, 0xff800000
    v_mov_b32 v180, 0
    v_mov_b32 v181, 0
    v_mov_b32 v182, 0
    v_mov_b32 v183, 0
    v_mov_b32 v184, 0
    v_mov_b32 v185, 0
    v_mov_b32 v186, 0
    v_mov_b32 v187, 0
    v_mov_b32 v188, 0
    v_mov_b32 v189, 0
    v_mov_b32 v190, 0
    v_mov_b32 v191, 0
    v_mov_b32 v192, 0
    v_mov_b32 v193, 0
    v_mov_b32 v194, 0
    v_mov_b32 v195, 0
    v_mov_b32 v69, 0
    v_mov_b32 v42, 0xff800000
    v_mov_b32 v196, 0
    v_mov_b32 v197, 0
    v_mov_b32 v198, 0
    v_mov_b32 v199, 0
    v_mov_b32 v200, 0
    v_mov_b32 v201, 0
    v_mov_b32 v202, 0
    v_mov_b32 v203, 0
    v_mov_b32 v204, 0
    v_mov_b32 v205, 0
    v_mov_b32 v206, 0
    v_mov_b32 v207, 0
    v_mov_b32 v208, 0
    v_mov_b32 v209, 0
    v_mov_b32 v210, 0
    v_mov_b32 v211, 0
    v_mov_b32 v71, 0
    v_mov_b32 v43, 0xff800000
    v_mov_b32 v212, 0
    v_mov_b32 v213, 0
    v_mov_b32 v214, 0
    v_mov_b32 v215, 0
    v_mov_b32 v216, 0
    v_mov_b32 v217, 0
    v_mov_b32 v218, 0
    v_mov_b32 v219, 0
    v_mov_b32 v220, 0
    v_mov_b32 v221, 0
    v_mov_b32 v222, 0
    v_mov_b32 v223, 0
    v_mov_b32 v224, 0
    v_mov_b32 v225, 0
    v_mov_b32 v226, 0
    v_mov_b32 v227, 0
    s_and_b32 s30, s36, 3
    s_lshl_b32 s30, s30, 8
    s_add_u32 s30, s30, s34
    v_add_u32 v12, s30, v32
    v_add_u32 v16, s30, v31
    s_and_b32 s30, s37, 3
    s_lshl_b32 s30, s30, 8
    s_add_u32 s30, s30, s34
    v_add_u32 v13, s30, v32
    v_add_u32 v17, s30, v31
    s_and_b32 s30, s38, 3
    s_lshl_b32 s30, s30, 8
    s_add_u32 s30, s30, s34
    v_add_u32 v14, s30, v32
    v_add_u32 v18, s30, v31
    s_and_b32 s30, s39, 3
    s_lshl_b32 s30, s30, 8
    s_add_u32 s30, s30, s34
    v_add_u32 v15, s30, v32
    v_add_u32 v19, s30, v31
    s_mov_b32 s30, 0
    s_lshl_b32 s52, s29, 1
    s_add_u32 s52, s52, 2
L_m_sc:
    ds_read_b32 v8, v7 offset:68
    s_waitcnt lgkmcnt(0)
    v_cmp_gt_u32 vcc, s52, v8
    s_cbranch_vccnz L_m_sc
    ds_read2st64_b64 v[76:79], v32 offset0:0 offset1:2
    ds_read_b32 v82, v31
    ds_read2st64_b64 v[48:51], v12 offset0:0 offset1:2
    ds_read_b32 v64, v16
    ds_read2st64_b64 v[52:55], v13 offset0:0 offset1:2
    ds_read_b32 v66, v17
    ds_read2st64_b64 v[56:59], v14 offset0:0 offset1:2
    ds_read_b32 v68, v18
    ds_read2st64_b64 v[60:63], v15 offset0:0 offset1:2
    ds_read_b32 v70, v19
    ds_read2st64_b64 v[72:75], v34 offset0:0 offset1:2
    ds_read_b32 v80, v35 offset:0
L_m_scan:
    s_waitcnt lgkmcnt(8)
    v_mfma_f32_32x32x16_bf16 v[100:115], v[76:79], v[48:51], 0
    v_mfma_f32_32x32x8_bf16 v[100:115], v[82:83], v[64:65], v[100:115]
    s_waitcnt lgkmcnt(6)
    v_mfma_f32_32x32x16_bf16 v[116:131], v[76:79], v[52:55], 0
    v_mfma_f32_32x32x8_bf16 v[116:131], v[82:83], v[66:67], v[116:131]
    s_waitcnt lgkmcnt(4)
    v_mfma_f32_32x32x16_bf16 v[132:147], v[76:79], v[56:59], 0
    v_mfma_f32_32x32x8_bf16 v[132:147], v[82:83], v[68:69], v[132:147]
    s_nop 3
    s_waitcnt lgkmcnt(2)
    v_mfma_f32_32x32x16_bf16 v[148:163], v[76:79], v[60:63], 0
    v_max3_f32 v40, v100, v101, v40
    v_max3_f32 v40, v102, v103, v40
    v_max3_f32 v40, v104, v105, v40
    v_max3_f32 v40, v106, v107, v40
    v_mfma_f32_32x32x8_bf16 v[148:163], v[82:83], v[70:71], v[148:163]
    v_max3_f32 v40, v108, v109, v40
    v_max3_f32 v40, v110, v111, v40
    v_max3_f32 v40, v112, v113, v40
    v_max3_f32 v40, v114, v115, v40
    v_max3_f32 v41, v116, v117, v41
    v_max3_f32 v41, v118, v119, v41
    v_max3_f32 v41, v120, v121, v41
    v_max3_f32 v41, v122, v123, v41
    v_max3_f32 v41, v124, v125, v41
    v_max3_f32 v41, v126, v127, v41
    v_max3_f32 v41, v128, v129, v41
    v_max3_f32 v41, v130, v131, v41
    v_max3_f32 v42, v132, v133, v42
    v_max3_f32 v42, v134, v135, v42
    v_max3_f32 v42, v136, v137, v42
    v_max3_f32 v42, v138, v139, v42
    v_max3_f32 v42, v140, v141, v42
    v_max3_f32 v42, v142, v143, v42
    v_max3_f32 v42, v144, v145, v42
    v_max3_f32 v42, v146, v147, v42
    v_max3_f32 v43, v148, v149, v43
    v_max3_f32 v43, v150, v151, v43
    v_max3_f32 v43, v152, v153, v43
    v_max3_f32 v43, v154, v155, v43
    v_max3_f32 v43, v156, v157, v43
    v_max3_f32 v43, v158, v159, v43
    v_max3_f32 v43, v160, v161, v43
    v_max3_f32 v43, v162, v163, v43
    s_cmp_lg_u32 s29, 0
    s_cbranch_scc1 L_m_scanmore
    v_mov_b32 v8, v40
    v_mov_b32 v9, v41
    v_mov_b32 v10, v42
    v_mov_b32 v11, v43
    s_nop 0
    v_permlane32_swap_b32 v40, v8
    v_permlane32_swap_b32 v41, v9
    v_permlane32_swap_b32 v42, v10
    v_permlane32_swap_b32 v43, v11
    v_max_f32 v40, v40, v8
    v_max_f32 v41, v41, v9
    v_max_f32 v42, v42, v10
    v_max_f32 v43, v43, v11
    v_mul_f32 v40, -0.5, v40
    v_mul_f32 v41, -0.5, v41
    v_mul_f32 v42, -0.5, v42
    v_mul_f32 v43, -0.5, v43
    v_lshrrev_b32 v65, 16, v40
    v_lshrrev_b32 v67, 16, v41
    v_lshrrev_b32 v69, 16, v42
    v_lshrrev_b32 v71, 16, v43
L_m_scandone:
    v_mov_b32 v39, 0
    s_mov_b32 s31, 0
    s_waitcnt lgkmcnt(0)
    v_mfma_f32_32x32x16_bf16 v[100:115], v[72:75], v[48:51], 0
    v_mfma_f32_32x32x8_bf16 v[100:115], v[80:81], v[64:65], v[100:115]
    v_mov_b32 v148, 0
    v_mov_b32 v149, 0
    v_mov_b32 v150, 0
    v_mov_b32 v151, 0
    v_mov_b32 v152, 0
    v_mov_b32 v153, 0
    v_mov_b32 v154, 0
    v_mov_b32 v155, 0
    v_mov_b32 v156, 0
    v_mov_b32 v157, 0
    v_mov_b32 v158, 0
    v_mov_b32 v159, 0
    v_mov_b32 v160, 0
    v_mov_b32 v161, 0
    v_mov_b32 v162, 0
    v_mov_b32 v163, 0
.p2align 6
L_m_loop:
    v_mfma_f32_32x32x16_bf16 v[116:131], v[72:75], v[52:55], 0
    ds_read_b32 v82, v35 offset:256
    v_exp_f32 v100, v100
    v_exp_f32 v101, v101
    v_exp_f32 v102, v102
    v_exp_f32 v103, v103
    v_mfma_f32_32x32x8_bf16 v[116:131], v[80:81], v[66:67], v[116:131]
    v_exp_f32 v104, v104
    v_exp_f32 v105, v105
    v_exp_f32 v106, v106
    v_exp_f32 v107, v107
    v_smfmac_f32_32x32x32_bf16 v[212:227], v[92:95], v[148:155], v30
    s_mov_b64 exec, s[40:41]
    ds_read_b128 v[84:87], v36 offset:5120
    ds_read_b128 v[88:91], v36 offset:5760
    s_mov_b64 exec, -1
    v_exp_f32 v108, v108
    v_exp_f32 v109, v109
    v_exp_f32 v110, v110
    v_exp_f32 v111, v111
    v_smfmac_f32_32x32x32_bf16 v[212:227], v[96:99], v[156:163], v30
    ds_read2st64_b64 v[76:79], v33 offset0:0 offset1:2
    v_exp_f32 v112, v112
    v_exp_f32 v113, v113
    v_exp_f32 v114, v114
    v_exp_f32 v115, v115
    v_mfma_f32_32x32x16_bf16 v[132:147], v[72:75], v[56:59], 0
    v_exp_f32 v116, v116
    v_exp_f32 v117, v117
    v_exp_f32 v118, v118
    v_exp_f32 v119, v119
    v_mfma_f32_32x32x8_bf16 v[132:147], v[80:81], v[68:69], v[132:147]
    s_waitcnt lgkmcnt(0)
    v_exp_f32 v120, v120
    v_exp_f32 v121, v121
    v_exp_f32 v122, v122
    v_exp_f32 v123, v123
    v_smfmac_f32_32x32x32_bf16 v[164:179], v[84:87], v[100:107], v30
    v_exp_f32 v124, v124
    v_exp_f32 v125, v125
    v_exp_f32 v126, v126
    v_exp_f32 v127, v127
    v_smfmac_f32_32x32x32_bf16 v[164:179], v[88:91], v[108:115], v30
    v_exp_f32 v128, v128
    v_exp_f32 v129, v129
    v_exp_f32 v130, v130
    v_exp_f32 v131, v131
    v_mfma_f32_32x32x16_bf16 v[148:163], v[72:75], v[60:63], 0
    v_exp_f32 v132, v132
    v_exp_f32 v133, v133
    v_exp_f32 v134, v134
    v_exp_f32 v135, v135
    v_mfma_f32_32x32x8_bf16 v[148:163], v[80:81], v[70:71], v[148:163]
    v_exp_f32 v136, v136
    v_exp_f32 v137, v137
    v_exp_f32 v138, v138
    v_exp_f32 v139, v139
    v_smfmac_f32_32x32x32_bf16 v[180:195], v[84:87], v[116:123], v30
    v_exp_f32 v140, v140
    v_exp_f32 v141, v141
    v_exp_f32 v142, v142
    v_exp_f32 v143, v143
    v_smfmac_f32_32x32x32_bf16 v[180:195], v[88:91], v[124:131], v30
    v_exp_f32 v144, v144
    v_exp_f32 v145, v145
    v_exp_f32 v146, v146
    v_exp_f32 v147, v147
    v_mfma_f32_32x32x16_bf16 v[100:115], v[76:79], v[48:51], 0
    v_exp_f32 v148, v148
    v_exp_f32 v149, v149
    v_exp_f32 v150, v150
    v_exp_f32 v151, v151
    v_mfma_f32_32x32x8_bf16 v[100:115], v[82:83], v[64:65], v[100:115]
    v_exp_f32 v152, v152
    v_exp_f32 v153, v153
    v_exp_f32 v154, v154
    v_exp_f32 v155, v155
    v_smfmac_f32_32x32x32_bf16 v[196:211], v[84:87], v[132:139], v30
    v_exp_f32 v156, v156
    v_exp_f32 v157, v157
    v_exp_f32 v158, v158
    v_exp_f32 v159, v159
    v_smfmac_f32_32x32x32_bf16 v[196:211], v[88:91], v[140:147], v30
    v_exp_f32 v160, v160
    v_exp_f32 v161, v161
    v_exp_f32 v162, v162
    v_exp_f32 v163, v163
    v_mfma_f32_32x32x16_bf16 v[116:131], v[76:79], v[52:55], 0
    ds_read_b32 v80, v35 offset:512
    v_exp_f32 v100, v100
    v_exp_f32 v101, v101
    v_exp_f32 v102, v102
    v_exp_f32 v103, v103
    v_mfma_f32_32x32x8_bf16 v[116:131], v[82:83], v[66:67], v[116:131]
    v_exp_f32 v104, v104
    v_exp_f32 v105, v105
    v_exp_f32 v106, v106
    v_exp_f32 v107, v107
    v_smfmac_f32_32x32x32_bf16 v[212:227], v[84:87], v[148:155], v30
    s_mov_b64 exec, s[40:41]
    ds_read_b128 v[92:95], v36 offset:6400
    ds_read_b128 v[96:99], v36 offset:7040
    s_mov_b64 exec, -1
    v_exp_f32 v108, v108
    v_exp_f32 v109, v109
    v_exp_f32 v110, v110
    v_exp_f32 v111, v111
    v_smfmac_f32_32x32x32_bf16 v[212:227], v[88:91], v[156:163], v30
    ds_read2st64_b64 v[72:75], v34 offset0:1 offset1:3
    v_exp_f32 v112, v112
    v_exp_f32 v113, v113
    v_exp_f32 v114, v114
    v_exp_f32 v115, v115
    v_mfma_f32_32x32x16_bf16 v[132:147], v[76:79], v[56:59], 0
    v_exp_f32 v116, v116
    v_exp_f32 v117, v117
    v_exp_f32 v118, v118
    v_exp_f32 v119, v119
    v_mfma_f32_32x32x8_bf16 v[132:147], v[82:83], v[68:69], v[132:147]
    s_waitcnt lgkmcnt(0)
    v_exp_f32 v120, v120
    v_exp_f32 v121, v121
    v_exp_f32 v122, v122
    v_exp_f32 v123, v123
    v_smfmac_f32_32x32x32_bf16 v[164:179], v[92:95], v[100:107], v30
    v_exp_f32 v124, v124
    v_exp_f32 v125, v125
    v_exp_f32 v126, v126
    v_exp_f32 v127, v127
    v_smfmac_f32_32x32x32_bf16 v[164:179], v[96:99], v[108:115], v30
    v_exp_f32 v128, v128
    v_exp_f32 v129, v129
    v_exp_f32 v130, v130
    v_exp_f32 v131, v131
    v_mfma_f32_32x32x16_bf16 v[148:163], v[76:79], v[60:63], 0
    v_exp_f32 v132, v132
    v_exp_f32 v133, v133
    v_exp_f32 v134, v134
    v_exp_f32 v135, v135
    v_mfma_f32_32x32x8_bf16 v[148:163], v[82:83], v[70:71], v[148:163]
    v_exp_f32 v136, v136
    v_exp_f32 v137, v137
    v_exp_f32 v138, v138
    v_exp_f32 v139, v139
    v_smfmac_f32_32x32x32_bf16 v[180:195], v[92:95], v[116:123], v30
    v_exp_f32 v140, v140
    v_exp_f32 v141, v141
    v_exp_f32 v142, v142
    v_exp_f32 v143, v143
    v_smfmac_f32_32x32x32_bf16 v[180:195], v[96:99], v[124:131], v30
    v_exp_f32 v144, v144
    v_exp_f32 v145, v145
    v_exp_f32 v146, v146
    v_exp_f32 v147, v147
    v_mfma_f32_32x32x16_bf16 v[100:115], v[72:75], v[48:51], 0
    v_exp_f32 v148, v148
    v_exp_f32 v149, v149
    v_exp_f32 v150, v150
    v_exp_f32 v151, v151
    v_mfma_f32_32x32x8_bf16 v[100:115], v[80:81], v[64:65], v[100:115]
    v_exp_f32 v152, v152
    v_exp_f32 v153, v153
    v_exp_f32 v154, v154
    v_exp_f32 v155, v155
    v_smfmac_f32_32x32x32_bf16 v[196:211], v[92:95], v[132:139], v30
    v_exp_f32 v156, v156
    v_exp_f32 v157, v157
    v_exp_f32 v158, v158
    v_exp_f32 v159, v159
    v_smfmac_f32_32x32x32_bf16 v[196:211], v[96:99], v[140:147], v30
    v_exp_f32 v160, v160
    v_exp_f32 v161, v161
    v_exp_f32 v162, v162
    v_exp_f32 v163, v163
    v_mfma_f32_32x32x16_bf16 v[116:131], v[72:75], v[52:55], 0
    ds_read_b32 v82, v35 offset:768
    v_exp_f32 v100, v100
    v_exp_f32 v101, v101
    v_exp_f32 v102, v102
    v_exp_f32 v103, v103
    v_mfma_f32_32x32x8_bf16 v[116:131], v[80:81], v[66:67], v[116:131]
    ds_read_b32 v38, v37
    v_exp_f32 v104, v104
    v_exp_f32 v105, v105
    v_exp_f32 v106, v106
    v_exp_f32 v107, v107
    v_smfmac_f32_32x32x32_bf16 v[212:227], v[92:95], v[148:155], v30
    s_mov_b64 exec, s[40:41]
    ds_read_b128 v[84:87], v36 offset:7680
    ds_read_b128 v[88:91], v36 offset:8320
    s_mov_b64 exec, -1
    v_exp_f32 v108, v108
    v_exp_f32 v109, v109
    v_exp_f32 v110, v110
    v_exp_f32 v111, v111
    v_smfmac_f32_32x32x32_bf16 v[212:227], v[96:99], v[156:163], v30
    ds_read2st64_b64 v[76:79], v33 offset0:1 offset1:3
    v_exp_f32 v112, v112
    v_exp_f32 v113, v113
    v_exp_f32 v114, v114
    v_exp_f32 v115, v115
    v_mfma_f32_32x32x16_bf16 v[132:147], v[72:75], v[56:59], 0
    v_exp_f32 v116, v116
    v_exp_f32 v117, v117
    v_exp_f32 v118, v118
    v_exp_f32 v119, v119
    v_mfma_f32_32x32x8_bf16 v[132:147], v[80:81], v[68:69], v[132:147]
    s_waitcnt lgkmcnt(0)
    v_exp_f32 v120, v120
    v_exp_f32 v121, v121
    v_exp_f32 v122, v122
    v_exp_f32 v123, v123
    v_smfmac_f32_32x32x32_bf16 v[164:179], v[84:87], v[100:107], v30
    v_exp_f32 v124, v124
    v_exp_f32 v125, v125
    v_exp_f32 v126, v126
    v_exp_f32 v127, v127
    v_smfmac_f32_32x32x32_bf16 v[164:179], v[88:91], v[108:115], v30
    v_exp_f32 v128, v128
    v_exp_f32 v129, v129
    v_exp_f32 v130, v130
    v_exp_f32 v131, v131
    v_mfma_f32_32x32x16_bf16 v[148:163], v[72:75], v[60:63], 0
    v_add_u32 v39, 1, v39
    v_exp_f32 v132, v132
    v_exp_f32 v133, v133
    v_exp_f32 v134, v134
    v_exp_f32 v135, v135
    v_mfma_f32_32x32x8_bf16 v[148:163], v[80:81], v[70:71], v[148:163]
    v_exp_f32 v136, v136
    v_exp_f32 v137, v137
    v_exp_f32 v138, v138
    v_exp_f32 v139, v139
    v_smfmac_f32_32x32x32_bf16 v[180:195], v[84:87], v[116:123], v30
    v_exp_f32 v140, v140
    v_exp_f32 v141, v141
    v_exp_f32 v142, v142
    v_exp_f32 v143, v143
    v_smfmac_f32_32x32x32_bf16 v[180:195], v[88:91], v[124:131], v30
    v_exp_f32 v144, v144
    v_exp_f32 v145, v145
    v_exp_f32 v146, v146
    v_exp_f32 v147, v147
    v_mfma_f32_32x32x16_bf16 v[100:115], v[76:79], v[48:51], 0
    v_exp_f32 v148, v148
    v_exp_f32 v149, v149
    v_exp_f32 v150, v150
    v_exp_f32 v151, v151
    v_mfma_f32_32x32x8_bf16 v[100:115], v[82:83], v[64:65], v[100:115]
    v_exp_f32 v152, v152
    v_exp_f32 v153, v153
    v_exp_f32 v154, v154
    v_exp_f32 v155, v155
    v_smfmac_f32_32x32x32_bf16 v[196:211], v[84:87], v[132:139], v30
    v_cmp_le_u32 vcc, v38, v39
    v_exp_f32 v156, v156
    v_exp_f32 v157, v157
    v_exp_f32 v158, v158
    v_exp_f32 v159, v159
    v_smfmac_f32_32x32x32_bf16 v[196:211], v[88:91], v[140:147], v30
    s_cbranch_vccnz L_m_rw_g0
L_m_rb_g0:
    v_exp_f32 v160, v160
    v_exp_f32 v161, v161
    v_exp_f32 v162, v162
    v_exp_f32 v163, v163
    v_mfma_f32_32x32x16_bf16 v[116:131], v[76:79], v[52:55], 0
    ds_read_b32 v80, v35 offset:10240
    v_exp_f32 v100, v100
    v_exp_f32 v101, v101
    v_exp_f32 v102, v102
    v_exp_f32 v103, v103
    v_mfma_f32_32x32x8_bf16 v[116:131], v[82:83], v[66:67], v[116:131]
    v_exp_f32 v104, v104
    v_exp_f32 v105, v105
    v_exp_f32 v106, v106
    v_exp_f32 v107, v107
    v_smfmac_f32_32x32x32_bf16 v[212:227], v[84:87], v[148:155], v30
    s_mov_b64 exec, s[40:41]
    ds_read_b128 v[92:95], v36 offset:8960
    ds_read_b128 v[96:99], v36 offset:9600
    s_mov_b64 exec, -1
    v_exp_f32 v108, v108
    v_exp_f32 v109, v109
    v_exp_f32 v110, v110
    v_exp_f32 v111, v111
    v_smfmac_f32_32x32x32_bf16 v[212:227], v[88:91], v[156:163], v30
    ds_read2st64_b64 v[72:75], v34 offset0:20 offset1:22
    v_exp_f32 v112, v112
    v_exp_f32 v113, v113
    v_exp_f32 v114, v114
    v_exp_f32 v115, v115
    v_mfma_f32_32x32x16_bf16 v[132:147], v[76:79], v[56:59], 0
    v_exp_f32 v116, v116
    v_exp_f32 v117, v117
    v_exp_f32 v118, v118
    v_exp_f32 v119, v119
    v_mfma_f32_32x32x8_bf16 v[132:147], v[82:83], v[68:69], v[132:147]
    s_waitcnt lgkmcnt(0)
    v_exp_f32 v120, v120
    v_exp_f32 v121, v121
    v_exp_f32 v122, v122
    v_exp_f32 v123, v123
    v_smfmac_f32_32x32x32_bf16 v[164:179], v[92:95], v[100:107], v30
    v_exp_f32 v124, v124
    v_exp_f32 v125, v125
    v_exp_f32 v126, v126
    v_exp_f32 v127, v127
    v_smfmac_f32_32x32x32_bf16 v[164:179], v[96:99], v[108:115], v30
    v_exp_f32 v128, v128
    v_exp_f32 v129, v129
    v_exp_f32 v130, v130
    v_exp_f32 v131, v131
    v_mfma_f32_32x32x16_bf16 v[148:163], v[76:79], v[60:63], 0
    v_exp_f32 v132, v132
    v_exp_f32 v133, v133
    v_exp_f32 v134, v134
    v_exp_f32 v135, v135
    v_mfma_f32_32x32x8_bf16 v[148:163], v[82:83], v[70:71], v[148:163]
    v_exp_f32 v136, v136
    v_exp_f32 v137, v137
    v_exp_f32 v138, v138
    v_exp_f32 v139, v139
    v_smfmac_f32_32x32x32_bf16 v[180:195], v[92:95], v[116:123], v30
    ds_write_b32 v5, v39
    v_exp_f32 v140, v140
    v_exp_f32 v141, v141
    v_exp_f32 v142, v142
    v_exp_f32 v143, v143
    v_smfmac_f32_32x32x32_bf16 v[180:195], v[96:99], v[124:131], v30
    v_exp_f32 v144, v144
    v_exp_f32 v145, v145
    v_exp_f32 v146, v146
    v_exp_f32 v147, v147
    v_mfma_f32_32x32x16_bf16 v[100:115], v[72:75], v[48:51], 0
    v_exp_f32 v148, v148
    v_exp_f32 v149, v149
    v_exp_f32 v150, v150
    v_exp_f32 v151, v151
    v_mfma_f32_32x32x8_bf16 v[100:115], v[80:81], v[64:65], v[100:115]
    v_exp_f32 v152, v152
    v_exp_f32 v153, v153
    v_exp_f32 v154, v154
    v_exp_f32 v155, v155
    v_smfmac_f32_32x32x32_bf16 v[196:211], v[92:95], v[132:139], v30
    v_exp_f32 v156, v156
    v_exp_f32 v157, v157
    v_exp_f32 v158, v158
    v_exp_f32 v159, v159
    v_smfmac_f32_32x32x32_bf16 v[196:211], v[96:99], v[140:147], v30
    v_exp_f32 v160, v160
    v_exp_f32 v161, v161
    v_exp_f32 v162, v162
    v_exp_f32 v163, v163
    v_mfma_f32_32x32x16_bf16 v[116:131], v[72:75], v[52:55], 0
    ds_read_b32 v82, v35 offset:10496
    v_exp_f32 v100, v100
    v_exp_f32 v101, v101
    v_exp_f32 v102, v102
    v_exp_f32 v103, v103
    v_mfma_f32_32x32x8_bf16 v[116:131], v[80:81], v[66:67], v[116:131]
    v_exp_f32 v104, v104
    v_exp_f32 v105, v105
    v_exp_f32 v106, v106
    v_exp_f32 v107, v107
    v_smfmac_f32_32x32x32_bf16 v[212:227], v[92:95], v[148:155], v30
    s_mov_b64 exec, s[40:41]
    ds_read_b128 v[84:87], v36 offset:15360
    ds_read_b128 v[88:91], v36 offset:16000
    s_mov_b64 exec, -1
    v_exp_f32 v108, v108
    v_exp_f32 v109, v109
    v_exp_f32 v110, v110
    v_exp_f32 v111, v111
    v_smfmac_f32_32x32x32_bf16 v[212:227], v[96:99], v[156:163], v30
    ds_read2st64_b64 v[76:79], v33 offset0:20 offset1:22
    v_exp_f32 v112, v112
    v_exp_f32 v113, v113
    v_exp_f32 v114, v114
    v_exp_f32 v115, v115
    v_mfma_f32_32x32x16_bf16 v[132:147], v[72:75], v[56:59], 0
    v_exp_f32 v116, v116
    v_exp_f32 v117, v117
    v_exp_f32 v118, v118
    v_exp_f32 v119, v119
    v_mfma_f32_32x32x8_bf16 v[132:147], v[80:81], v[68:69], v[132:147]
    s_waitcnt lgkmcnt(0)
    v_exp_f32 v120, v120
    v_exp_f32 v121, v121
    v_exp_f32 v122, v122
    v_exp_f32 v123, v123
    v_smfmac_f32_32x32x32_bf16 v[164:179], v[84:87], v[100:107], v30
    v_exp_f32 v124, v124
    v_exp_f32 v125, v125
    v_exp_f32 v126, v126
    v_exp_f32 v127, v127
    v_smfmac_f32_32x32x32_bf16 v[164:179], v[88:91], v[108:115], v30
    v_exp_f32 v128, v128
    v_exp_f32 v129, v129
    v_exp_f32 v130, v130
    v_exp_f32 v131, v131
    v_mfma_f32_32x32x16_bf16 v[148:163], v[72:75], v[60:63], 0
    v_exp_f32 v132, v132
    v_exp_f32 v133, v133
    v_exp_f32 v134, v134
    v_exp_f32 v135, v135
    v_mfma_f32_32x32x8_bf16 v[148:163], v[80:81], v[70:71], v[148:163]
    v_exp_f32 v136, v136
    v_exp_f32 v137, v137
    v_exp_f32 v138, v138
    v_exp_f32 v139, v139
    v_smfmac_f32_32x32x32_bf16 v[180:195], v[84:87], v[116:123], v30
    v_exp_f32 v140, v140
    v_exp_f32 v141, v141
    v_exp_f32 v142, v142
    v_exp_f32 v143, v143
    v_smfmac_f32_32x32x32_bf16 v[180:195], v[88:91], v[124:131], v30
    v_exp_f32 v144, v144
    v_exp_f32 v145, v145
    v_exp_f32 v146, v146
    v_exp_f32 v147, v147
    v_mfma_f32_32x32x16_bf16 v[100:115], v[76:79], v[48:51], 0
    v_exp_f32 v148, v148
    v_exp_f32 v149, v149
    v_exp_f32 v150, v150
    v_exp_f32 v151, v151
    v_mfma_f32_32x32x8_bf16 v[100:115], v[82:83], v[64:65], v[100:115]
    v_exp_f32 v152, v152
    v_exp_f32 v153, v153
    v_exp_f32 v154, v154
    v_exp_f32 v155, v155
    v_smfmac_f32_32x32x32_bf16 v[196:211], v[84:87], v[132:139], v30
    v_exp_f32 v156, v156
    v_exp_f32 v157, v157
    v_exp_f32 v158, v158
    v_exp_f32 v159, v159
    v_smfmac_f32_32x32x32_bf16 v[196:211], v[88:91], v[140:147], v30
    v_exp_f32 v160, v160
    v_exp_f32 v161, v161
    v_exp_f32 v162, v162
    v_exp_f32 v163, v163
    v_mfma_f32_32x32x16_bf16 v[116:131], v[76:79], v[52:55], 0
    ds_read_b32 v80, v35 offset:10752
    v_exp_f32 v100, v100
    v_exp_f32 v101, v101
    v_exp_f32 v102, v102
    v_exp_f32 v103, v103
    v_mfma_f32_32x32x8_bf16 v[116:131], v[82:83], v[66:67], v[116:131]
    v_exp_f32 v104, v104
    v_exp_f32 v105, v105
    v_exp_f32 v106, v106
    v_exp_f32 v107, v107
    v_smfmac_f32_32x32x32_bf16 v[212:227], v[84:87], v[148:155], v30
    s_mov_b64 exec, s[40:41]
    ds_read_b128 v[92:95], v36 offset:16640
    ds_read_b128 v[96:99], v36 offset:17280
    s_mov_b64 exec, -1
    v_exp_f32 v108, v108
    v_exp_f32 v109, v109
    v_exp_f32 v110, v110
    v_exp_f32 v111, v111
    v_smfmac_f32_32x32x32_bf16 v[212:227], v[88:91], v[156:163], v30
    ds_read2st64_b64 v[72:75], v34 offset0:21 offset1:23
    v_exp_f32 v112, v112
    v_exp_f32 v113, v113
    v_exp_f32 v114, v114
    v_exp_f32 v115, v115
    v_mfma_f32_32x32x16_bf16 v[132:147], v[76:79], v[56:59], 0
    v_exp_f32 v116, v116
    v_exp_f32 v117, v117
    v_exp_f32 v118, v118
    v_exp_f32 v119, v119
    v_mfma_f32_32x32x8_bf16 v[132:147], v[82:83], v[68:69], v[132:147]
    s_waitcnt lgkmcnt(0)
    v_exp_f32 v120, v120
    v_exp_f32 v121, v121
    v_exp_f32 v122, v122
    v_exp_f32 v123, v123
    v_smfmac_f32_32x32x32_bf16 v[164:179], v[92:95], v[100:107], v30
    v_exp_f32 v124, v124
    v_exp_f32 v125, v125
    v_exp_f32 v126, v126
    v_exp_f32 v127, v127
    v_smfmac_f32_32x32x32_bf16 v[164:179], v[96:99], v[108:115], v30
    v_exp_f32 v128, v128
    v_exp_f32 v129, v129
    v_exp_f32 v130, v130
    v_exp_f32 v131, v131
    v_mfma_f32_32x32x16_bf16 v[148:163], v[76:79], v[60:63], 0
    v_exp_f32 v132, v132
    v_exp_f32 v133, v133
    v_exp_f32 v134, v134
    v_exp_f32 v135, v135
    v_mfma_f32_32x32x8_bf16 v[148:163], v[82:83], v[70:71], v[148:163]
    v_exp_f32 v136, v136
    v_exp_f32 v137, v137
    v_exp_f32 v138, v138
    v_exp_f32 v139, v139
    v_smfmac_f32_32x32x32_bf16 v[180:195], v[92:95], v[116:123], v30
    v_exp_f32 v140, v140
    v_exp_f32 v141, v141
    v_exp_f32 v142, v142
    v_exp_f32 v143, v143
    v_smfmac_f32_32x32x32_bf16 v[180:195], v[96:99], v[124:131], v30
    v_exp_f32 v144, v144
    v_exp_f32 v145, v145
    v_exp_f32 v146, v146
    v_exp_f32 v147, v147
    v_mfma_f32_32x32x16_bf16 v[100:115], v[72:75], v[48:51], 0
    v_exp_f32 v148, v148
    v_exp_f32 v149, v149
    v_exp_f32 v150, v150
    v_exp_f32 v151, v151
    v_mfma_f32_32x32x8_bf16 v[100:115], v[80:81], v[64:65], v[100:115]
    v_exp_f32 v152, v152
    v_exp_f32 v153, v153
    v_exp_f32 v154, v154
    v_exp_f32 v155, v155
    v_smfmac_f32_32x32x32_bf16 v[196:211], v[92:95], v[132:139], v30
    v_exp_f32 v156, v156
    v_exp_f32 v157, v157
    v_exp_f32 v158, v158
    v_exp_f32 v159, v159
    v_smfmac_f32_32x32x32_bf16 v[196:211], v[96:99], v[140:147], v30
    v_exp_f32 v160, v160
    v_exp_f32 v161, v161
    v_exp_f32 v162, v162
    v_exp_f32 v163, v163
    v_mfma_f32_32x32x16_bf16 v[116:131], v[72:75], v[52:55], 0
    ds_read_b32 v82, v35 offset:11008
    v_exp_f32 v100, v100
    v_exp_f32 v101, v101
    v_exp_f32 v102, v102
    v_exp_f32 v103, v103
    v_mfma_f32_32x32x8_bf16 v[116:131], v[80:81], v[66:67], v[116:131]
    ds_read_b32 v38, v37
    v_exp_f32 v104, v104
    v_exp_f32 v105, v105
    v_exp_f32 v106, v106
    v_exp_f32 v107, v107
    v_smfmac_f32_32x32x32_bf16 v[212:227], v[92:95], v[148:155], v30
    s_mov_b64 exec, s[40:41]
    ds_read_b128 v[84:87], v36 offset:17920
    ds_read_b128 v[88:91], v36 offset:18560
    s_mov_b64 exec, -1
    v_exp_f32 v108, v108
    v_exp_f32 v109, v109
    v_exp_f32 v110, v110
    v_exp_f32 v111, v111
    v_smfmac_f32_32x32x32_bf16 v[212:227], v[96:99], v[156:163], v30
    ds_read2st64_b64 v[76:79], v33 offset0:21 offset1:23
    v_exp_f32 v112, v112
    v_exp_f32 v113, v113
    v_exp_f32 v114, v114
    v_exp_f32 v115, v115
    v_mfma_f32_32x32x16_bf16 v[132:147], v[72:75], v[56:59], 0
    v_exp_f32 v116, v116
    v_exp_f32 v117, v117
    v_exp_f32 v118, v118
    v_exp_f32 v119, v119
    v_mfma_f32_32x32x8_bf16 v[132:147], v[80:81], v[68:69], v[132:147]
    s_waitcnt lgkmcnt(0)
    v_exp_f32 v120, v120
    v_exp_f32 v121, v121
    v_exp_f32 v122, v122
    v_exp_f32 v123, v123
    v_smfmac_f32_32x32x32_bf16 v[164:179], v[84:87], v[100:107], v30
    v_exp_f32 v124, v124
    v_exp_f32 v125, v125
    v_exp_f32 v126, v126
    v_exp_f32 v127, v127
    v_smfmac_f32_32x32x32_bf16 v[164:179], v[88:91], v[108:115], v30
    v_exp_f32 v128, v128
    v_exp_f32 v129, v129
    v_exp_f32 v130, v130
    v_exp_f32 v131, v131
    v_mfma_f32_32x32x16_bf16 v[148:163], v[72:75], v[60:63], 0
    v_add_u32 v39, 1, v39
    v_exp_f32 v132, v132
    v_exp_f32 v133, v133
    v_exp_f32 v134, v134
    v_exp_f32 v135, v135
    v_mfma_f32_32x32x8_bf16 v[148:163], v[80:81], v[70:71], v[148:163]
    v_exp_f32 v136, v136
    v_exp_f32 v137, v137
    v_exp_f32 v138, v138
    v_exp_f32 v139, v139
    v_smfmac_f32_32x32x32_bf16 v[180:195], v[84:87], v[116:123], v30
    v_exp_f32 v140, v140
    v_exp_f32 v141, v141
    v_exp_f32 v142, v142
    v_exp_f32 v143, v143
    v_smfmac_f32_32x32x32_bf16 v[180:195], v[88:91], v[124:131], v30
    v_exp_f32 v144, v144
    v_exp_f32 v145, v145
    v_exp_f32 v146, v146
    v_exp_f32 v147, v147
    v_mfma_f32_32x32x16_bf16 v[100:115], v[76:79], v[48:51], 0
    v_exp_f32 v148, v148
    v_exp_f32 v149, v149
    v_exp_f32 v150, v150
    v_exp_f32 v151, v151
    v_mfma_f32_32x32x8_bf16 v[100:115], v[82:83], v[64:65], v[100:115]
    v_exp_f32 v152, v152
    v_exp_f32 v153, v153
    v_exp_f32 v154, v154
    v_exp_f32 v155, v155
    v_smfmac_f32_32x32x32_bf16 v[196:211], v[84:87], v[132:139], v30
    v_cmp_le_u32 vcc, v38, v39
    v_exp_f32 v156, v156
    v_exp_f32 v157, v157
    v_exp_f32 v158, v158
    v_exp_f32 v159, v159
    v_smfmac_f32_32x32x32_bf16 v[196:211], v[88:91], v[140:147], v30
    s_cbranch_vccnz L_m_rw_g1
L_m_rb_g1:
    v_exp_f32 v160, v160
    v_exp_f32 v161, v161
    v_exp_f32 v162, v162
    v_exp_f32 v163, v163
    v_mfma_f32_32x32x16_bf16 v[116:131], v[76:79], v[52:55], 0
    ds_read_b32 v80, v35 offset:20480
    v_exp_f32 v100, v100
    v_exp_f32 v101, v101
    v_exp_f32 v102, v102
    v_exp_f32 v103, v103
    v_mfma_f32_32x32x8_bf16 v[116:131], v[82:83], v[66:67], v[116:131]
    v_exp_f32 v104, v104
    v_exp_f32 v105, v105
    v_exp_f32 v106, v106
    v_exp_f32 v107, v107
    v_smfmac_f32_32x32x32_bf16 v[212:227], v[84:87], v[148:155], v30
    s_mov_b64 exec, s[40:41]
    ds_read_b128 v[92:95], v36 offset:19200
    ds_read_b128 v[96:99], v36 offset:19840
    s_mov_b64 exec, -1
    v_exp_f32 v108, v108
    v_exp_f32 v109, v109
    v_exp_f32 v110, v110
    v_exp_f32 v111, v111
    v_smfmac_f32_32x32x32_bf16 v[212:227], v[88:91], v[156:163], v30
    ds_read2st64_b64 v[72:75], v34 offset0:40 offset1:42
    v_exp_f32 v112, v112
    v_exp_f32 v113, v113
    v_exp_f32 v114, v114
    v_exp_f32 v115, v115
    v_mfma_f32_32x32x16_bf16 v[132:147], v[76:79], v[56:59], 0
    v_exp_f32 v116, v116
    v_exp_f32 v117, v117
    v_exp_f32 v118, v118
    v_exp_f32 v119, v119
    v_mfma_f32_32x32x8_bf16 v[132:147], v[82:83], v[68:69], v[132:147]
    s_waitcnt lgkmcnt(0)
    v_exp_f32 v120, v120
    v_exp_f32 v121, v121
    v_exp_f32 v122, v122
    v_exp_f32 v123, v123
    v_smfmac_f32_32x32x32_bf16 v[164:179], v[92:95], v[100:107], v30
    v_exp_f32 v124, v124
    v_exp_f32 v125, v125
    v_exp_f32 v126, v126
    v_exp_f32 v127, v127
    v_smfmac_f32_32x32x32_bf16 v[164:179], v[96:99], v[108:115], v30
    v_exp_f32 v128, v128
    v_exp_f32 v129, v129
    v_exp_f32 v130, v130
    v_exp_f32 v131, v131
    v_mfma_f32_32x32x16_bf16 v[148:163], v[76:79], v[60:63], 0
    v_exp_f32 v132, v132
    v_exp_f32 v133, v133
    v_exp_f32 v134, v134
    v_exp_f32 v135, v135
    v_mfma_f32_32x32x8_bf16 v[148:163], v[82:83], v[70:71], v[148:163]
    v_exp_f32 v136, v136
    v_exp_f32 v137, v137
    v_exp_f32 v138, v138
    v_exp_f32 v139, v139
    v_smfmac_f32_32x32x32_bf16 v[180:195], v[92:95], v[116:123], v30
    ds_write_b32 v5, v39
    v_exp_f32 v140, v140
    v_exp_f32 v141, v141
    v_exp_f32 v142, v142
    v_exp_f32 v143, v143
    v_smfmac_f32_32x32x32_bf16 v[180:195], v[96:99], v[124:131], v30
    v_exp_f32 v144, v144
    v_exp_f32 v145, v145
    v_exp_f32 v146, v146
    v_exp_f32 v147, v147
    v_mfma_f32_32x32x16_bf16 v[100:115], v[72:75], v[48:51], 0
    v_exp_f32 v148, v148
    v_exp_f32 v149, v149
    v_exp_f32 v150, v150
    v_exp_f32 v151, v151
    v_mfma_f32_32x32x8_bf16 v[100:115], v[80:81], v[64:65], v[100:115]
    v_exp_f32 v152, v152
    v_exp_f32 v153, v153
    v_exp_f32 v154, v154
    v_exp_f32 v155, v155
    v_smfmac_f32_32x32x32_bf16 v[196:211], v[92:95], v[132:139], v30
    v_exp_f32 v156, v156
    v_exp_f32 v157, v157
    v_exp_f32 v158, v158
    v_exp_f32 v159, v159
    v_smfmac_f32_32x32x32_bf16 v[196:211], v[96:99], v[140:147], v30
    v_exp_f32 v160, v160
    v_exp_f32 v161, v161
    v_exp_f32 v162, v162
    v_exp_f32 v163, v163
    v_mfma_f32_32x32x16_bf16 v[116:131], v[72:75], v[52:55], 0
    ds_read_b32 v82, v35 offset:20736
    v_exp_f32 v100, v100
    v_exp_f32 v101, v101
    v_exp_f32 v102, v102
    v_exp_f32 v103, v103
    v_mfma_f32_32x32x8_bf16 v[116:131], v[80:81], v[66:67], v[116:131]
    v_exp_f32 v104, v104
    v_exp_f32 v105, v105
    v_exp_f32 v106, v106
    v_exp_f32 v107, v107
    v_smfmac_f32_32x32x32_bf16 v[212:227], v[92:95], v[148:155], v30
    s_mov_b64 exec, s[40:41]
    ds_read_b128 v[84:87], v36 offset:25600
    ds_read_b128 v[88:91], v36 offset:26240
    s_mov_b64 exec, -1
    v_exp_f32 v108, v108
    v_exp_f32 v109, v109
    v_exp_f32 v110, v110
    v_exp_f32 v111, v111
    v_smfmac_f32_32x32x32_bf16 v[212:227], v[96:99], v[156:163], v30
    ds_read2st64_b64 v[76:79], v33 offset0:40 offset1:42
    v_exp_f32 v112, v112
    v_exp_f32 v113, v113
    v_exp_f32 v114, v114
    v_exp_f32 v115, v115
    v_mfma_f32_32x32x16_bf16 v[132:147], v[72:75], v[56:59], 0
    v_exp_f32 v116, v116
    v_exp_f32 v117, v117
    v_exp_f32 v118, v118
    v_exp_f32 v119, v119
    v_mfma_f32_32x32x8_bf16 v[132:147], v[80:81], v[68:69], v[132:147]
    s_waitcnt lgkmcnt(0)
    v_exp_f32 v120, v120
    v_exp_f32 v121, v121
    v_exp_f32 v122, v122
    v_exp_f32 v123, v123
    v_smfmac_f32_32x32x32_bf16 v[164:179], v[84:87], v[100:107], v30
    v_exp_f32 v124, v124
    v_exp_f32 v125, v125
    v_exp_f32 v126, v126
    v_exp_f32 v127, v127
    v_smfmac_f32_32x32x32_bf16 v[164:179], v[88:91], v[108:115], v30
    v_exp_f32 v128, v128
    v_exp_f32 v129, v129
    v_exp_f32 v130, v130
    v_exp_f32 v131, v131
    v_mfma_f32_32x32x16_bf16 v[148:163], v[72:75], v[60:63], 0
    v_exp_f32 v132, v132
    v_exp_f32 v133, v133
    v_exp_f32 v134, v134
    v_exp_f32 v135, v135
    v_mfma_f32_32x32x8_bf16 v[148:163], v[80:81], v[70:71], v[148:163]
    v_exp_f32 v136, v136
    v_exp_f32 v137, v137
    v_exp_f32 v138, v138
    v_exp_f32 v139, v139
    v_smfmac_f32_32x32x32_bf16 v[180:195], v[84:87], v[116:123], v30
    v_exp_f32 v140, v140
    v_exp_f32 v141, v141
    v_exp_f32 v142, v142
    v_exp_f32 v143, v143
    v_smfmac_f32_32x32x32_bf16 v[180:195], v[88:91], v[124:131], v30
    v_exp_f32 v144, v144
    v_exp_f32 v145, v145
    v_exp_f32 v146, v146
    v_exp_f32 v147, v147
    v_mfma_f32_32x32x16_bf16 v[100:115], v[76:79], v[48:51], 0
    v_exp_f32 v148, v148
    v_exp_f32 v149, v149
    v_exp_f32 v150, v150
    v_exp_f32 v151, v151
    v_mfma_f32_32x32x8_bf16 v[100:115], v[82:83], v[64:65], v[100:115]
    v_exp_f32 v152, v152
    v_exp_f32 v153, v153
    v_exp_f32 v154, v154
    v_exp_f32 v155, v155
    v_smfmac_f32_32x32x32_bf16 v[196:211], v[84:87], v[132:139], v30
    v_exp_f32 v156, v156
    v_exp_f32 v157, v157
    v_exp_f32 v158, v158
    v_exp_f32 v159, v159
    v_smfmac_f32_32x32x32_bf16 v[196:211], v[88:91], v[140:147], v30
    v_exp_f32 v160, v160
    v_exp_f32 v161, v161
    v_exp_f32 v162, v162
    v_exp_f32 v163, v163
    v_mfma_f32_32x32x16_bf16 v[116:131], v[76:79], v[52:55], 0
    ds_read_b32 v80, v35 offset:20992
    v_exp_f32 v100, v100
    v_exp_f32 v101, v101
    v_exp_f32 v102, v102
    v_exp_f32 v103, v103
    v_mfma_f32_32x32x8_bf16 v[116:131], v[82:83], v[66:67], v[116:131]
    v_exp_f32 v104, v104
    v_exp_f32 v105, v105
    v_exp_f32 v106, v106
    v_exp_f32 v107, v107
    v_smfmac_f32_32x32x32_bf16 v[212:227], v[84:87], v[148:155], v30
    s_mov_b64 exec, s[40:41]
    ds_read_b128 v[92:95], v36 offset:26880
    ds_read_b128 v[96:99], v36 offset:27520
    s_mov_b64 exec, -1
    v_exp_f32 v108, v108
    v_exp_f32 v109, v109
    v_exp_f32 v110, v110
    v_exp_f32 v111, v111
    v_smfmac_f32_32x32x32_bf16 v[212:227], v[88:91], v[156:163], v30
    ds_read2st64_b64 v[72:75], v34 offset0:41 offset1:43
    v_exp_f32 v112, v112
    v_exp_f32 v113, v113
    v_exp_f32 v114, v114
    v_exp_f32 v115, v115
    v_mfma_f32_32x32x16_bf16 v[132:147], v[76:79], v[56:59], 0
    v_exp_f32 v116, v116
    v_exp_f32 v117, v117
    v_exp_f32 v118, v118
    v_exp_f32 v119, v119
    v_mfma_f32_32x32x8_bf16 v[132:147], v[82:83], v[68:69], v[132:147]
    s_waitcnt lgkmcnt(0)
    v_exp_f32 v120, v120
    v_exp_f32 v121, v121
    v_exp_f32 v122, v122
    v_exp_f32 v123, v123
    v_smfmac_f32_32x32x32_bf16 v[164:179], v[92:95], v[100:107], v30
    v_exp_f32 v124, v124
    v_exp_f32 v125, v125
    v_exp_f32 v126, v126
    v_exp_f32 v127, v127
    v_smfmac_f32_32x32x32_bf16 v[164:179], v[96:99], v[108:115], v30
    v_exp_f32 v128, v128
    v_exp_f32 v129, v129
    v_exp_f32 v130, v130
    v_exp_f32 v131, v131
    v_mfma_f32_32x32x16_bf16 v[148:163], v[76:79], v[60:63], 0
    v_exp_f32 v132, v132
    v_exp_f32 v133, v133
    v_exp_f32 v134, v134
    v_exp_f32 v135, v135
    v_mfma_f32_32x32x8_bf16 v[148:163], v[82:83], v[70:71], v[148:163]
    v_exp_f32 v136, v136
    v_exp_f32 v137, v137
    v_exp_f32 v138, v138
    v_exp_f32 v139, v139
    v_smfmac_f32_32x32x32_bf16 v[180:195], v[92:95], v[116:123], v30
    v_exp_f32 v140, v140
    v_exp_f32 v141, v141
    v_exp_f32 v142, v142
    v_exp_f32 v143, v143
    v_smfmac_f32_32x32x32_bf16 v[180:195], v[96:99], v[124:131], v30
    v_exp_f32 v144, v144
    v_exp_f32 v145, v145
    v_exp_f32 v146, v146
    v_exp_f32 v147, v147
    v_mfma_f32_32x32x16_bf16 v[100:115], v[72:75], v[48:51], 0
    v_exp_f32 v148, v148
    v_exp_f32 v149, v149
    v_exp_f32 v150, v150
    v_exp_f32 v151, v151
    v_mfma_f32_32x32x8_bf16 v[100:115], v[80:81], v[64:65], v[100:115]
    v_exp_f32 v152, v152
    v_exp_f32 v153, v153
    v_exp_f32 v154, v154
    v_exp_f32 v155, v155
    v_smfmac_f32_32x32x32_bf16 v[196:211], v[92:95], v[132:139], v30
    v_exp_f32 v156, v156
    v_exp_f32 v157, v157
    v_exp_f32 v158, v158
    v_exp_f32 v159, v159
    v_smfmac_f32_32x32x32_bf16 v[196:211], v[96:99], v[140:147], v30
    v_exp_f32 v160, v160
    v_exp_f32 v161, v161
    v_exp_f32 v162, v162
    v_exp_f32 v163, v163
    v_mfma_f32_32x32x16_bf16 v[116:131], v[72:75], v[52:55], 0
    ds_read_b32 v82, v35 offset:21248
    v_exp_f32 v100, v100
    v_exp_f32 v101, v101
    v_exp_f32 v102, v102
    v_exp_f32 v103, v103
    v_mfma_f32_32x32x8_bf16 v[116:131], v[80:81], v[66:67], v[116:131]
    ds_read_b32 v38, v37
    v_exp_f32 v104, v104
    v_exp_f32 v105, v105
    v_exp_f32 v106, v106
    v_exp_f32 v107, v107
    v_smfmac_f32_32x32x32_bf16 v[212:227], v[92:95], v[148:155], v30
    s_mov_b64 exec, s[40:41]
    ds_read_b128 v[84:87], v36 offset:28160
    ds_read_b128 v[88:91], v36 offset:28800
    s_mov_b64 exec, -1
    v_exp_f32 v108, v108
    v_exp_f32 v109, v109
    v_exp_f32 v110, v110
    v_exp_f32 v111, v111
    v_smfmac_f32_32x32x32_bf16 v[212:227], v[96:99], v[156:163], v30
    ds_read2st64_b64 v[76:79], v33 offset0:41 offset1:43
    v_exp_f32 v112, v112
    v_exp_f32 v113, v113
    v_exp_f32 v114, v114
    v_exp_f32 v115, v115
    v_mfma_f32_32x32x16_bf16 v[132:147], v[72:75], v[56:59], 0
    v_exp_f32 v116, v116
    v_exp_f32 v117, v117
    v_exp_f32 v118, v118
    v_exp_f32 v119, v119
    v_mfma_f32_32x32x8_bf16 v[132:147], v[80:81], v[68:69], v[132:147]
    s_waitcnt lgkmcnt(0)
    v_exp_f32 v120, v120
    v_exp_f32 v121, v121
    v_exp_f32 v122, v122
    v_exp_f32 v123, v123
    v_smfmac_f32_32x32x32_bf16 v[164:179], v[84:87], v[100:107], v30
    v_exp_f32 v124, v124
    v_exp_f32 v125, v125
    v_exp_f32 v126, v126
    v_exp_f32 v127, v127
    v_smfmac_f32_32x32x32_bf16 v[164:179], v[88:91], v[108:115], v30
    v_exp_f32 v128, v128
    v_exp_f32 v129, v129
    v_exp_f32 v130, v130
    v_exp_f32 v131, v131
    v_mfma_f32_32x32x16_bf16 v[148:163], v[72:75], v[60:63], 0
    v_add_u32 v39, 1, v39
    v_exp_f32 v132, v132
    v_exp_f32 v133, v133
    v_exp_f32 v134, v134
    v_exp_f32 v135, v135
    v_mfma_f32_32x32x8_bf16 v[148:163], v[80:81], v[70:71], v[148:163]
    v_exp_f32 v136, v136
    v_exp_f32 v137, v137
    v_exp_f32 v138, v138
    v_exp_f32 v139, v139
    v_smfmac_f32_32x32x32_bf16 v[180:195], v[84:87], v[116:123], v30
    v_exp_f32 v140, v140
    v_exp_f32 v141, v141
    v_exp_f32 v142, v142
    v_exp_f32 v143, v143
    v_smfmac_f32_32x32x32_bf16 v[180:195], v[88:91], v[124:131], v30
    v_exp_f32 v144, v144
    v_exp_f32 v145, v145
    v_exp_f32 v146, v146
    v_exp_f32 v147, v147
    v_mfma_f32_32x32x16_bf16 v[100:115], v[76:79], v[48:51], 0
    v_exp_f32 v148, v148
    v_exp_f32 v149, v149
    v_exp_f32 v150, v150
    v_exp_f32 v151, v151
    v_mfma_f32_32x32x8_bf16 v[100:115], v[82:83], v[64:65], v[100:115]
    v_exp_f32 v152, v152
    v_exp_f32 v153, v153
    v_exp_f32 v154, v154
    v_exp_f32 v155, v155
    v_smfmac_f32_32x32x32_bf16 v[196:211], v[84:87], v[132:139], v30
    v_cmp_le_u32 vcc, v38, v39
    v_exp_f32 v156, v156
    v_exp_f32 v157, v157
    v_exp_f32 v158, v158
    v_exp_f32 v159, v159
    v_smfmac_f32_32x32x32_bf16 v[196:211], v[88:91], v[140:147], v30
    s_cbranch_vccnz L_m_rw_g2
L_m_rb_g2:
    v_exp_f32 v160, v160
    v_exp_f32 v161, v161
    v_exp_f32 v162, v162
    v_exp_f32 v163, v163
    v_mfma_f32_32x32x16_bf16 v[116:131], v[76:79], v[52:55], 0
    ds_read_b32 v80, v35 offset:30720
    v_exp_f32 v100, v100
    v_exp_f32 v101, v101
    v_exp_f32 v102, v102
    v_exp_f32 v103, v103
    v_mfma_f32_32x32x8_bf16 v[116:131], v[82:83], v[66:67], v[116:131]
    v_exp_f32 v104, v104
    v_exp_f32 v105, v105
    v_exp_f32 v106, v106
    v_exp_f32 v107, v107
    v_smfmac_f32_32x32x32_bf16 v[212:227], v[84:87], v[148:155], v30
    s_mov_b64 exec, s[40:41]
    ds_read_b128 v[92:95], v36 offset:29440
    ds_read_b128 v[96:99], v36 offset:30080
    s_mov_b64 exec, -1
    v_exp_f32 v108, v108
    v_exp_f32 v109, v109
    v_exp_f32 v110, v110
    v_exp_f32 v111, v111
    v_smfmac_f32_32x32x32_bf16 v[212:227], v[88:91], v[156:163], v30
    ds_read2st64_b64 v[72:75], v34 offset0:60 offset1:62
    v_exp_f32 v112, v112
    v_exp_f32 v113, v113
    v_exp_f32 v114, v114
    v_exp_f32 v115, v115
    v_mfma_f32_32x32x16_bf16 v[132:147], v[76:79], v[56:59], 0
    v_exp_f32 v116, v116
    v_exp_f32 v117, v117
    v_exp_f32 v118, v118
    v_exp_f32 v119, v119
    v_mfma_f32_32x32x8_bf16 v[132:147], v[82:83], v[68:69], v[132:147]
    s_waitcnt lgkmcnt(0)
    v_exp_f32 v120, v120
    v_exp_f32 v121, v121
    v_exp_f32 v122, v122
    v_exp_f32 v123, v123
    v_smfmac_f32_32x32x32_bf16 v[164:179], v[92:95], v[100:107], v30
    v_exp_f32 v124, v124
    v_exp_f32 v125, v125
    v_exp_f32 v126, v126
    v_exp_f32 v127, v127
    v_smfmac_f32_32x32x32_bf16 v[164:179], v[96:99], v[108:115], v30
    v_exp_f32 v128, v128
    v_exp_f32 v129, v129
    v_exp_f32 v130, v130
    v_exp_f32 v131, v131
    v_mfma_f32_32x32x16_bf16 v[148:163], v[76:79], v[60:63], 0
    v_exp_f32 v132, v132
    v_exp_f32 v133, v133
    v_exp_f32 v134, v134
    v_exp_f32 v135, v135
    v_mfma_f32_32x32x8_bf16 v[148:163], v[82:83], v[70:71], v[148:163]
    v_exp_f32 v136, v136
    v_exp_f32 v137, v137
    v_exp_f32 v138, v138
    v_exp_f32 v139, v139
    v_smfmac_f32_32x32x32_bf16 v[180:195], v[92:95], v[116:123], v30
    ds_write_b32 v5, v39
    v_exp_f32 v140, v140
    v_exp_f32 v141, v141
    v_exp_f32 v142, v142
    v_exp_f32 v143, v143
    v_smfmac_f32_32x32x32_bf16 v[180:195], v[96:99], v[124:131], v30
    v_exp_f32 v144, v144
    v_exp_f32 v145, v145
    v_exp_f32 v146, v146
    v_exp_f32 v147, v147
    v_mfma_f32_32x32x16_bf16 v[100:115], v[72:75], v[48:51], 0
    v_exp_f32 v148, v148
    v_exp_f32 v149, v149
    v_exp_f32 v150, v150
    v_exp_f32 v151, v151
    v_mfma_f32_32x32x8_bf16 v[100:115], v[80:81], v[64:65], v[100:115]
    v_exp_f32 v152, v152
    v_exp_f32 v153, v153
    v_exp_f32 v154, v154
    v_exp_f32 v155, v155
    v_smfmac_f32_32x32x32_bf16 v[196:211], v[92:95], v[132:139], v30
    v_exp_f32 v156, v156
    v_exp_f32 v157, v157
    v_exp_f32 v158, v158
    v_exp_f32 v159, v159
    v_smfmac_f32_32x32x32_bf16 v[196:211], v[96:99], v[140:147], v30
    v_exp_f32 v160, v160
    v_exp_f32 v161, v161
    v_exp_f32 v162, v162
    v_exp_f32 v163, v163
    v_mfma_f32_32x32x16_bf16 v[116:131], v[72:75], v[52:55], 0
    ds_read_b32 v82, v35 offset:30976
    v_exp_f32 v100, v100
    v_exp_f32 v101, v101
    v_exp_f32 v102, v102
    v_exp_f32 v103, v103
    v_mfma_f32_32x32x8_bf16 v[116:131], v[80:81], v[66:67], v[116:131]
    v_exp_f32 v104, v104
    v_exp_f32 v105, v105
    v_exp_f32 v106, v106
    v_exp_f32 v107, v107
    v_smfmac_f32_32x32x32_bf16 v[212:227], v[92:95], v[148:155], v30
    s_mov_b64 exec, s[40:41]
    ds_read_b128 v[84:87], v36 offset:35840
    ds_read_b128 v[88:91], v36 offset:36480
    s_mov_b64 exec, -1
    v_exp_f32 v108, v108
    v_exp_f32 v109, v109
    v_exp_f32 v110, v110
    v_exp_f32 v111, v111
    v_smfmac_f32_32x32x32_bf16 v[212:227], v[96:99], v[156:163], v30
    ds_read2st64_b64 v[76:79], v33 offset0:60 offset1:62
    v_exp_f32 v112, v112
    v_exp_f32 v113, v113
    v_exp_f32 v114, v114
    v_exp_f32 v115, v115
    v_mfma_f32_32x32x16_bf16 v[132:147], v[72:75], v[56:59], 0
    v_exp_f32 v116, v116
    v_exp_f32 v117, v117
    v_exp_f32 v118, v118
    v_exp_f32 v119, v119
    v_mfma_f32_32x32x8_bf16 v[132:147], v[80:81], v[68:69], v[132:147]
    s_waitcnt lgkmcnt(0)
    v_exp_f32 v120, v120
    v_exp_f32 v121, v121
    v_exp_f32 v122, v122
    v_exp_f32 v123, v123
    v_smfmac_f32_32x32x32_bf16 v[164:179], v[84:87], v[100:107], v30
    v_exp_f32 v124, v124
    v_exp_f32 v125, v125
    v_exp_f32 v126, v126
    v_exp_f32 v127, v127
    v_smfmac_f32_32x32x32_bf16 v[164:179], v[88:91], v[108:115], v30
    v_exp_f32 v128, v128
    v_exp_f32 v129, v129
    v_exp_f32 v130, v130
    v_exp_f32 v131, v131
    v_mfma_f32_32x32x16_bf16 v[148:163], v[72:75], v[60:63], 0
    v_exp_f32 v132, v132
    v_exp_f32 v133, v133
    v_exp_f32 v134, v134
    v_exp_f32 v135, v135
    v_mfma_f32_32x32x8_bf16 v[148:163], v[80:81], v[70:71], v[148:163]
    v_exp_f32 v136, v136
    v_exp_f32 v137, v137
    v_exp_f32 v138, v138
    v_exp_f32 v139, v139
    v_smfmac_f32_32x32x32_bf16 v[180:195], v[84:87], v[116:123], v30
    v_exp_f32 v140, v140
    v_exp_f32 v141, v141
    v_exp_f32 v142, v142
    v_exp_f32 v143, v143
    v_smfmac_f32_32x32x32_bf16 v[180:195], v[88:91], v[124:131], v30
    v_exp_f32 v144, v144
    v_exp_f32 v145, v145
    v_exp_f32 v146, v146
    v_exp_f32 v147, v147
    v_mfma_f32_32x32x16_bf16 v[100:115], v[76:79], v[48:51], 0
    v_exp_f32 v148, v148
    v_exp_f32 v149, v149
    v_exp_f32 v150, v150
    v_exp_f32 v151, v151
    v_mfma_f32_32x32x8_bf16 v[100:115], v[82:83], v[64:65], v[100:115]
    v_exp_f32 v152, v152
    v_exp_f32 v153, v153
    v_exp_f32 v154, v154
    v_exp_f32 v155, v155
    v_smfmac_f32_32x32x32_bf16 v[196:211], v[84:87], v[132:139], v30
    v_exp_f32 v156, v156
    v_exp_f32 v157, v157
    v_exp_f32 v158, v158
    v_exp_f32 v159, v159
    v_smfmac_f32_32x32x32_bf16 v[196:211], v[88:91], v[140:147], v30
    v_exp_f32 v160, v160
    v_exp_f32 v161, v161
    v_exp_f32 v162, v162
    v_exp_f32 v163, v163
    v_mfma_f32_32x32x16_bf16 v[116:131], v[76:79], v[52:55], 0
    ds_read_b32 v80, v35 offset:31232
    v_exp_f32 v100, v100
    v_exp_f32 v101, v101
    v_exp_f32 v102, v102
    v_exp_f32 v103, v103
    v_mfma_f32_32x32x8_bf16 v[116:131], v[82:83], v[66:67], v[116:131]
    v_exp_f32 v104, v104
    v_exp_f32 v105, v105
    v_exp_f32 v106, v106
    v_exp_f32 v107, v107
    v_smfmac_f32_32x32x32_bf16 v[212:227], v[84:87], v[148:155], v30
    s_mov_b64 exec, s[40:41]
    ds_read_b128 v[92:95], v36 offset:37120
    ds_read_b128 v[96:99], v36 offset:37760
    s_mov_b64 exec, -1
    v_exp_f32 v108, v108
    v_exp_f32 v109, v109
    v_exp_f32 v110, v110
    v_exp_f32 v111, v111
    v_smfmac_f32_32x32x32_bf16 v[212:227], v[88:91], v[156:163], v30
    ds_read2st64_b64 v[72:75], v34 offset0:61 offset1:63
    v_exp_f32 v112, v112
    v_exp_f32 v113, v113
    v_exp_f32 v114, v114
    v_exp_f32 v115, v115
    v_mfma_f32_32x32x16_bf16 v[132:147], v[76:79], v[56:59], 0
    v_exp_f32 v116, v116
    v_exp_f32 v117, v117
    v_exp_f32 v118, v118
    v_exp_f32 v119, v119
    v_mfma_f32_32x32x8_bf16 v[132:147], v[82:83], v[68:69], v[132:147]
    s_waitcnt lgkmcnt(0)
    v_exp_f32 v120, v120
    v_exp_f32 v121, v121
    v_exp_f32 v122, v122
    v_exp_f32 v123, v123
    v_smfmac_f32_32x32x32_bf16 v[164:179], v[92:95], v[100:107], v30
    v_exp_f32 v124, v124
    v_exp_f32 v125, v125
    v_exp_f32 v126, v126
    v_exp_f32 v127, v127
    v_smfmac_f32_32x32x32_bf16 v[164:179], v[96:99], v[108:115], v30
    v_exp_f32 v128, v128
    v_exp_f32 v129, v129
    v_exp_f32 v130, v130
    v_exp_f32 v131, v131
    v_mfma_f32_32x32x16_bf16 v[148:163], v[76:79], v[60:63], 0
    v_exp_f32 v132, v132
    v_exp_f32 v133, v133
    v_exp_f32 v134, v134
    v_exp_f32 v135, v135
    v_mfma_f32_32x32x8_bf16 v[148:163], v[82:83], v[70:71], v[148:163]
    v_exp_f32 v136, v136
    v_exp_f32 v137, v137
    v_exp_f32 v138, v138
    v_exp_f32 v139, v139
    v_smfmac_f32_32x32x32_bf16 v[180:195], v[92:95], v[116:123], v30
    v_exp_f32 v140, v140
    v_exp_f32 v141, v141
    v_exp_f32 v142, v142
    v_exp_f32 v143, v143
    v_smfmac_f32_32x32x32_bf16 v[180:195], v[96:99], v[124:131], v30
    v_exp_f32 v144, v144
    v_exp_f32 v145, v145
    v_exp_f32 v146, v146
    v_exp_f32 v147, v147
    v_mfma_f32_32x32x16_bf16 v[100:115], v[72:75], v[48:51], 0
    v_exp_f32 v148, v148
    v_exp_f32 v149, v149
    v_exp_f32 v150, v150
    v_exp_f32 v151, v151
    v_mfma_f32_32x32x8_bf16 v[100:115], v[80:81], v[64:65], v[100:115]
    v_exp_f32 v152, v152
    v_exp_f32 v153, v153
    v_exp_f32 v154, v154
    v_exp_f32 v155, v155
    v_smfmac_f32_32x32x32_bf16 v[196:211], v[92:95], v[132:139], v30
    v_exp_f32 v156, v156
    v_exp_f32 v157, v157
    v_exp_f32 v158, v158
    v_exp_f32 v159, v159
    v_smfmac_f32_32x32x32_bf16 v[196:211], v[96:99], v[140:147], v30
    v_exp_f32 v160, v160
    v_exp_f32 v161, v161
    v_exp_f32 v162, v162
    v_exp_f32 v163, v163
    v_mfma_f32_32x32x16_bf16 v[116:131], v[72:75], v[52:55], 0
    ds_read_b32 v82, v35 offset:31488
    v_exp_f32 v100, v100
    v_exp_f32 v101, v101
    v_exp_f32 v102, v102
    v_exp_f32 v103, v103
    v_mfma_f32_32x32x8_bf16 v[116:131], v[80:81], v[66:67], v[116:131]
    ds_read_b32 v38, v37
    v_exp_f32 v104, v104
    v_exp_f32 v105, v105
    v_exp_f32 v106, v106
    v_exp_f32 v107, v107
    v_smfmac_f32_32x32x32_bf16 v[212:227], v[92:95], v[148:155], v30
    s_mov_b64 exec, s[40:41]
    ds_read_b128 v[84:87], v36 offset:38400
    ds_read_b128 v[88:91], v36 offset:39040
    s_mov_b64 exec, -1
    v_exp_f32 v108, v108
    v_exp_f32 v109, v109
    v_exp_f32 v110, v110
    v_exp_f32 v111, v111
    v_smfmac_f32_32x32x32_bf16 v[212:227], v[96:99], v[156:163], v30
    ds_read2st64_b64 v[76:79], v33 offset0:61 offset1:63
    v_exp_f32 v112, v112
    v_exp_f32 v113, v113
    v_exp_f32 v114, v114
    v_exp_f32 v115, v115
    v_mfma_f32_32x32x16_bf16 v[132:147], v[72:75], v[56:59], 0
    v_exp_f32 v116, v116
    v_exp_f32 v117, v117
    v_exp_f32 v118, v118
    v_exp_f32 v119, v119
    v_mfma_f32_32x32x8_bf16 v[132:147], v[80:81], v[68:69], v[132:147]
    s_waitcnt lgkmcnt(0)
    v_exp_f32 v120, v120
    v_exp_f32 v121, v121
    v_exp_f32 v122, v122
    v_exp_f32 v123, v123
    v_smfmac_f32_32x32x32_bf16 v[164:179], v[84:87], v[100:107], v30
    v_exp_f32 v124, v124
    v_exp_f32 v125, v125
    v_exp_f32 v126, v126
    v_exp_f32 v127, v127
    v_smfmac_f32_32x32x32_bf16 v[164:179], v[88:91], v[108:115], v30
    v_exp_f32 v128, v128
    v_exp_f32 v129, v129
    v_exp_f32 v130, v130
    v_exp_f32 v131, v131
    v_mfma_f32_32x32x16_bf16 v[148:163], v[72:75], v[60:63], 0
    v_add_u32 v39, 1, v39
    v_exp_f32 v132, v132
    v_exp_f32 v133, v133
    v_exp_f32 v134, v134
    v_exp_f32 v135, v135
    v_mfma_f32_32x32x8_bf16 v[148:163], v[80:81], v[70:71], v[148:163]
    v_exp_f32 v136, v136
    v_exp_f32 v137, v137
    v_exp_f32 v138, v138
    v_exp_f32 v139, v139
    v_smfmac_f32_32x32x32_bf16 v[180:195], v[84:87], v[116:123], v30
    v_exp_f32 v140, v140
    v_exp_f32 v141, v141
    v_exp_f32 v142, v142
    v_exp_f32 v143, v143
    v_smfmac_f32_32x32x32_bf16 v[180:195], v[88:91], v[124:131], v30
    v_exp_f32 v144, v144
    v_exp_f32 v145, v145
    v_exp_f32 v146, v146
    v_exp_f32 v147, v147
    v_mfma_f32_32x32x16_bf16 v[100:115], v[76:79], v[48:51], 0
    v_exp_f32 v148, v148
    v_exp_f32 v149, v149
    v_exp_f32 v150, v150
    v_exp_f32 v151, v151
    v_mfma_f32_32x32x8_bf16 v[100:115], v[82:83], v[64:65], v[100:115]
    v_exp_f32 v152, v152
    v_exp_f32 v153, v153
    v_exp_f32 v154, v154
    v_exp_f32 v155, v155
    v_smfmac_f32_32x32x32_bf16 v[196:211], v[84:87], v[132:139], v30
    v_cmp_le_u32 vcc, v38, v39
    v_exp_f32 v156, v156
    v_exp_f32 v157, v157
    v_exp_f32 v158, v158
    v_exp_f32 v159, v159
    v_smfmac_f32_32x32x32_bf16 v[196:211], v[88:91], v[140:147], v30
    s_cbranch_vccnz L_m_rw_g3
L_m_rb_g3:
    v_exp_f32 v160, v160
    v_exp_f32 v161, v161
    v_exp_f32 v162, v162
    v_exp_f32 v163, v163
    v_mfma_f32_32x32x16_bf16 v[116:131], v[76:79], v[52:55], 0
    ds_read_b32 v80, v35 offset:0
    v_exp_f32 v100, v100
    v_exp_f32 v101, v101
    v_exp_f32 v102, v102
    v_exp_f32 v103, v103
    v_mfma_f32_32x32x8_bf16 v[116:131], v[82:83], v[66:67], v[116:131]
    v_exp_f32 v104, v104
    v_exp_f32 v105, v105
    v_exp_f32 v106, v106
    v_exp_f32 v107, v107
    v_smfmac_f32_32x32x32_bf16 v[212:227], v[84:87], v[148:155], v30
    s_mov_b64 exec, s[40:41]
    ds_read_b128 v[92:95], v36 offset:39680
    ds_read_b128 v[96:99], v36 offset:40320
    s_mov_b64 exec, -1
    v_exp_f32 v108, v108
    v_exp_f32 v109, v109
    v_exp_f32 v110, v110
    v_exp_f32 v111, v111
    v_smfmac_f32_32x32x32_bf16 v[212:227], v[88:91], v[156:163], v30
    ds_read2st64_b64 v[72:75], v34 offset0:0 offset1:2
    v_exp_f32 v112, v112
    v_exp_f32 v113, v113
    v_exp_f32 v114, v114
    v_exp_f32 v115, v115
    v_mfma_f32_32x32x16_bf16 v[132:147], v[76:79], v[56:59], 0
    v_exp_f32 v116, v116
    v_exp_f32 v117, v117
    v_exp_f32 v118, v118
    v_exp_f32 v119, v119
    v_mfma_f32_32x32x8_bf16 v[132:147], v[82:83], v[68:69], v[132:147]
    s_waitcnt lgkmcnt(0)
    v_exp_f32 v120, v120
    v_exp_f32 v121, v121
    v_exp_f32 v122, v122
    v_exp_f32 v123, v123
    v_smfmac_f32_32x32x32_bf16 v[164:179], v[92:95], v[100:107], v30
    v_exp_f32 v124, v124
    v_exp_f32 v125, v125
    v_exp_f32 v126, v126
    v_exp_f32 v127, v127
    v_smfmac_f32_32x32x32_bf16 v[164:179], v[96:99], v[108:115], v30
    v_exp_f32 v128, v128
    v_exp_f32 v129, v129
    v_exp_f32 v130, v130
    v_exp_f32 v131, v131
    v_mfma_f32_32x32x16_bf16 v[148:163], v[76:79], v[60:63], 0
    v_exp_f32 v132, v132
    v_exp_f32 v133, v133
    v_exp_f32 v134, v134
    v_exp_f32 v135, v135
    v_mfma_f32_32x32x8_bf16 v[148:163], v[82:83], v[70:71], v[148:163]
    v_exp_f32 v136, v136
    v_exp_f32 v137, v137
    v_exp_f32 v138, v138
    v_exp_f32 v139, v139
    v_smfmac_f32_32x32x32_bf16 v[180:195], v[92:95], v[116:123], v30
    ds_write_b32 v5, v39
    v_exp_f32 v140, v140
    v_exp_f32 v141, v141
    v_exp_f32 v142, v142
    v_exp_f32 v143, v143
    v_smfmac_f32_32x32x32_bf16 v[180:195], v[96:99], v[124:131], v30
    v_exp_f32 v144, v144
    v_exp_f32 v145, v145
    v_exp_f32 v146, v146
    v_exp_f32 v147, v147
    v_mfma_f32_32x32x16_bf16 v[100:115], v[72:75], v[48:51], 0
    v_exp_f32 v148, v148
    v_exp_f32 v149, v149
    v_exp_f32 v150, v150
    v_exp_f32 v151, v151
    v_mfma_f32_32x32x8_bf16 v[100:115], v[80:81], v[64:65], v[100:115]
    v_exp_f32 v152, v152
    v_exp_f32 v153, v153
    v_exp_f32 v154, v154
    v_exp_f32 v155, v155
    v_smfmac_f32_32x32x32_bf16 v[196:211], v[92:95], v[132:139], v30
    v_exp_f32 v156, v156
    v_exp_f32 v157, v157
    v_exp_f32 v158, v158
    v_exp_f32 v159, v159
    v_smfmac_f32_32x32x32_bf16 v[196:211], v[96:99], v[140:147], v30
    v_exp_f32 v160, v160
    v_exp_f32 v161, v161
    v_exp_f32 v162, v162
    v_exp_f32 v163, v163
    s_add_u32 s31, s31, 1
    s_cmp_lt_u32 s31, 2
    s_cbranch_scc1 L_m_loop
    s_nop 0
    v_smfmac_f32_32x32x32_bf16 v[212:227], v[92:95], v[148:155], v30
    v_smfmac_f32_32x32x32_bf16 v[212:227], v[96:99], v[156:163], v30
    s_xor_b32 s30, s26, 2
    s_mul_i32 s30, s30, 6144
    s_add_u32 s30, s30, 122880
    v_add_u32 v9, s30, v2
    s_mul_i32 s30, s26, 6144
    s_add_u32 s30, s30, 122880
    v_add_u32 v8, s30, v2
    ds_write_b128 v9, v[196:199] offset:0
    ds_write_b128 v9, v[200:203] offset:1024
    ds_write_b128 v9, v[204:207] offset:2048
    s_nop 1
    ds_write_b128 v9, v[212:215] offset:3072
    ds_write_b128 v9, v[216:219] offset:4096
    ds_write_b128 v9, v[220:223] offset:5120
    s_waitcnt lgkmcnt(0)
    s_barrier
    ds_read_b128 v[108:111], v8 offset:2048
    ds_read_b128 v[100:103], v8 offset:0
    ds_read_b128 v[104:107], v8 offset:1024
    ds_read_b128 v[124:127], v8 offset:5120
    ds_read_b128 v[116:119], v8 offset:3072
    ds_read_b128 v[120:123], v8 offset:4096
    v_mov_b32 v14, 0x53800000
    v_mov_b32 v16, 0
    v_mov_b32 v17, 0
    v_mov_b32 v18, 0
    v_mov_b32 v19, 0
    s_mov_b64 s[56:57], 0
    s_waitcnt lgkmcnt(5)
    v_pk_add_f32 v[172:173], v[172:173], v[108:109]
    v_pk_add_f32 v[174:175], v[174:175], v[110:111]
    v_mov_b32 v10, v172
    v_mov_b32 v12, v172
    s_waitcnt lgkmcnt(3)
    v_pk_add_f32 v[164:165], v[164:165], v[100:101]
    v_pk_add_f32 v[166:167], v[166:167], v[102:103]
    v_permlane32_swap_b32 v10, v12
    v_pk_add_f32 v[168:169], v[168:169], v[104:105]
    v_pk_add_f32 v[170:171], v[170:171], v[106:107]
    v_rcp_f32 v10, v12
    v_cmp_nle_f32 vcc, 0x2b800000, v12
    v_cmp_nge_f32 s[30:31], v14, v12
    v_pk_fma_f32 v[16:17], v[164:165], v[18:19], v[16:17]
    v_pk_fma_f32 v[16:17], v[166:167], v[18:19], v[16:17]
    v_pk_fma_f32 v[16:17], v[168:169], v[18:19], v[16:17]
    v_pk_fma_f32 v[16:17], v[170:171], v[18:19], v[16:17]
    v_pk_fma_f32 v[16:17], v[172:173], v[18:19], v[16:17]
    v_pk_fma_f32 v[16:17], v[174:175], v[18:19], v[16:17]
    v_pk_mul_f32 v[164:165], v[164:165], v[10:11] op_sel_hi:[1,0]
    v_pk_mul_f32 v[166:167], v[166:167], v[10:11] op_sel_hi:[1,0]
    v_pk_mul_f32 v[168:169], v[168:169], v[10:11] op_sel_hi:[1,0]
    v_pk_mul_f32 v[170:171], v[170:171], v[10:11] op_sel_hi:[1,0]
    v_pk_mul_f32 v[172:173], v[172:173], v[10:11] op_sel_hi:[1,0]
    v_pk_mul_f32 v[174:175], v[174:175], v[10:11] op_sel_hi:[1,0]
    s_or_b64 s[56:57], s[56:57], vcc
    s_or_b64 s[56:57], s[56:57], s[30:31]
    v_cvt_pk_bf16_f32 v164, v164, v165
    v_cvt_pk_bf16_f32 v165, v166, v167
    v_cvt_pk_bf16_f32 v166, v168, v169
    v_cvt_pk_bf16_f32 v167, v170, v171
    v_cvt_pk_bf16_f32 v168, v172, v173
    v_cvt_pk_bf16_f32 v169, v174, v175
    s_waitcnt lgkmcnt(2)
    v_pk_add_f32 v[188:189], v[188:189], v[124:125]
    v_pk_add_f32 v[190:191], v[190:191], v[126:127]
    v_mov_b32 v10, v188
    v_mov_b32 v12, v188
    s_waitcnt lgkmcnt(0)
    v_pk_add_f32 v[180:181], v[180:181], v[116:117]
    v_pk_add_f32 v[182:183], v[182:183], v[118:119]
    v_permlane32_swap_b32 v10, v12
    v_pk_add_f32 v[184:185], v[184:185], v[120:121]
    v_pk_add_f32 v[186:187], v[186:187], v[122:123]
    v_rcp_f32 v10, v12
    v_cmp_nle_f32 vcc, 0x2b800000, v12
    v_cmp_nge_f32 s[30:31], v14, v12
    v_pk_fma_f32 v[16:17], v[180:181], v[18:19], v[16:17]
    v_pk_fma_f32 v[16:17], v[182:183], v[18:19], v[16:17]
    v_pk_fma_f32 v[16:17], v[184:185], v[18:19], v[16:17]
    v_pk_fma_f32 v[16:17], v[186:187], v[18:19], v[16:17]
    v_pk_fma_f32 v[16:17], v[188:189], v[18:19], v[16:17]
    v_pk_fma_f32 v[16:17], v[190:191], v[18:19], v[16:17]
    v_pk_mul_f32 v[180:181], v[180:181], v[10:11] op_sel_hi:[1,0]
    v_pk_mul_f32 v[182:183], v[182:183], v[10:11] op_sel_hi:[1,0]
    v_pk_mul_f32 v[184:185], v[184:185], v[10:11] op_sel_hi:[1,0]
    v_pk_mul_f32 v[186:187], v[186:187], v[10:11] op_sel_hi:[1,0]
    v_pk_mul_f32 v[188:189], v[188:189], v[10:11] op_sel_hi:[1,0]
    v_pk_mul_f32 v[190:191], v[190:191], v[10:11] op_sel_hi:[1,0]
    s_or_b64 s[56:57], s[56:57], vcc
    s_or_b64 s[56:57], s[56:57], s[30:31]
    v_cvt_pk_bf16_f32 v180, v180, v181
    v_cvt_pk_bf16_f32 v181, v182, v183
    v_cvt_pk_bf16_f32 v182, v184, v185
    v_cvt_pk_bf16_f32 v183, v186, v187
    v_cvt_pk_bf16_f32 v184, v188, v189
    v_cvt_pk_bf16_f32 v185, v190, v191
    v_cmp_u_f32 vcc, v16, v17
    v_permlane32_swap_b32 v168, v184
    v_permlane32_swap_b32 v169, v185
    s_or_b64 s[56:57], s[56:57], vcc
    s_cmp_lg_u64 s[56:57], 0
    s_cselect_b32 s30, 1, 0
    s_andn2_b32 s30, s30, s29
    v_mov_b32 v14, s30
    ds_write_b32 v5, v14 offset:16
    s_or_b32 s30, s30, s67
    s_cmp_lg_u32 s30, 0
    s_cbranch_scc1 L_m_nopub
    s_mov_b32 s43, 40960
    buffer_store_dwordx4 v[164:167], v44, s[20:23], 0 offen sc1
    buffer_store_dwordx4 v[180:183], v44, s[20:23], s43 offen sc1
    buffer_store_dwordx2 v[168:169], v45, s[20:23], 0 offen sc1
    s_lshl_b32 s30, s25, 5
    s_add_u32 s30, s30, s24
    s_lshl_b32 s30, s30, 7
    s_and_b32 s52, s36, 7
    s_lshl_b32 s52, s52, 1
    s_add_u32 s30, s30, s52
    s_add_u32 s30, s30, 32644224
    s_mov_b32 s67, 1
    s_mul_i32 s64, s25, 798720
    s_mul_i32 s31, s26, 20480
    s_add_u32 s64, s64, s31
    s_add_u32 s31, s64, 26161152
    buffer_load_dwordx4 v[176:179], v2, s[20:23], s31 offen offset:0 sc1
    buffer_load_dwordx4 v[180:183], v2, s[20:23], s31 offen offset:1024 sc1
    buffer_load_dwordx4 v[184:187], v2, s[20:23], s31 offen offset:2048 sc1
    buffer_load_dwordx4 v[188:191], v2, s[20:23], s31 offen offset:3072 sc1
    s_add_u32 s31, s64, 26165248
    buffer_load_dwordx4 v[192:195], v2, s[20:23], s31 offen offset:0 sc1
    buffer_load_dwordx4 v[196:199], v2, s[20:23], s31 offen offset:1024 sc1
    buffer_load_dwordx4 v[200:203], v2, s[20:23], s31 offen offset:2048 sc1
    buffer_load_dwordx4 v[204:207], v2, s[20:23], s31 offen offset:3072 sc1
    s_waitcnt vmcnt(8)
    s_mov_b64 exec, 1
    buffer_store_dword v6, off, s[20:23], s30 sc1
    s_mov_b64 exec, -1
L_m_nopub:
    s_waitcnt lgkmcnt(0)
    s_barrier
    v_and_b32 v15, 3, v1
    v_lshlrev_b32 v15, 2, v15
    v_add_u32 v15, 162336, v15
    ds_read_b32 v14, v15
    s_waitcnt lgkmcnt(0)
    v_cmp_ne_u32 vcc, 0, v14
    s_nop 1
    s_cmp_eq_u64 vcc, 0
    s_cbranch_scc1 L_m_attok
    s_mov_b32 s29, 1
    s_waitcnt vmcnt(0)
    s_branch L_m_Credo
L_m_attok:
    s_setprio 2
    s_cmp_eq_u32 s29, 0
    s_cbranch_scc1 L_m_w3ok
    s_mul_i32 s64, s25, 798720
    s_mul_i32 s31, s26, 20480
    s_add_u32 s64, s64, s31
    s_add_u32 s31, s64, 26161152
    buffer_load_dwordx4 v[176:179], v2, s[20:23], s31 offen offset:0 sc1
    buffer_load_dwordx4 v[180:183], v2, s[20:23], s31 offen offset:1024 sc1
    buffer_load_dwordx4 v[184:187], v2, s[20:23], s31 offen offset:2048 sc1
    buffer_load_dwordx4 v[188:191], v2, s[20:23], s31 offen offset:3072 sc1
    s_add_u32 s31, s64, 26165248
    buffer_load_dwordx4 v[192:195], v2, s[20:23], s31 offen offset:0 sc1
    buffer_load_dwordx4 v[196:199], v2, s[20:23], s31 offen offset:1024 sc1
    buffer_load_dwordx4 v[200:203], v2, s[20:23], s31 offen offset:2048 sc1
    buffer_load_dwordx4 v[204:207], v2, s[20:23], s31 offen offset:3072 sc1
L_m_w3ok:
    s_lshl_b32 s35, s24, 2
    s_add_u32 s35, s35, s26
    s_mul_i32 s30, s26, 2560
    s_add_u32 s30, s30, 152064
    v_mul_u32_u24 v8, 160, v4
    v_lshl_add_u32 v8, v3, 3, v8
    v_add_u32 v34, s30, v8
    ds_read_b64 v[20:21], v34 offset:0
    ds_read_b64 v[22:23], v34 offset:32
    ds_read_b64 v[24:25], v34 offset:64
    ds_read_b64 v[26:27], v34 offset:96
    ds_read_b64 v[28:29], v34 offset:128
    v_lshlrev_b32 v8, 4, v3
    v_add_u32 v35, 162560, v8
    v_mov_b32 v7, 162352
    ds_read_b32 v17, v7 offset:16
    s_mov_b32 s59, 0xff0000
    s_cmp_eq_u32 s26, 0
    s_cselect_b32 s59, 0xff00, s59
    v_add_u32 v30, 0, v2
    v_add_u32 v31, 65536, v2
    v_add_u32 v32, 131072, v2
    v_lshlrev_b32 v38, 3, v4
    v_lshl_add_u32 v38, v3, 8, v38
    s_mul_i32 s44, s24, 245760
    s_mul_i32 s30, s26, 2560
    s_add_u32 s44, s44, s30
    s_add_u32 s44, s44, 0
    s_mul_i32 s45, s24, 245760
    s_add_u32 s45, s45, 81920
    s_lshr_b32 s30, s25, 2
    s_add_u32 s30, s30, 1
    s_sub_u32 s31, 0, s30
    s_bitcmp1_b32 s25, 1
    s_cselect_b32 s30, s31, s30
    s_cselect_b32 s32, -1, 1
    s_cselect_b32 s33, 1, 0
    s_add_u32 s32, s32, s24
    s_cmp_gt_u32 s32, 31
    s_cselect_b32 s49, 1, 0
    s_and_b32 s32, s32, 31
    s_lshl_b32 s32, s32, 1
    s_add_u32 s32, s32, s33
    s_lshl_b32 s48, s32, 7
    s_lshl_b32 s33, s25, 2
    s_add_u32 s48, s48, s33
    s_add_u32 s48, s48, 32603264
    s_lshr_b32 s33, s32, 3
    s_mul_i32 s33, s33, 20480
    s_and_b32 s32, s32, 7
    s_lshl_b32 s32, s32, 7
    s_add_u32 s32, s32, s33
    s_add_u32 s32, s32, 33071104
    s_lshl_b32 s31, s26, 4
    s_add_u32 s30, s30, s31
    v_add_u32 v8, s30, v4
    v_cmp_lt_u32 s[68:69], 63, v8
    v_lshrrev_b32 v9, 4, v8
    v_mul_u32_u24 v9, 20480, v9
    v_and_b32 v10, 15, v8
    v_lshl_add_u32 v9, v10, 4, v9
    v_lshl_add_u32 v9, v3, 8, v9
    v_add_u32 v9, s45, v9
    v_and_b32 v10, 1, v8
    v_lshlrev_b32 v10, 4, v10
    v_lshl_add_u32 v10, v3, 5, v10
    v_add_u32 v10, s32, v10
    v_cndmask_b32 v36, v9, v10, s[68:69]
    s_cmp_eq_u32 s26, 0
    s_cselect_b32 s50, 5120, 0
    s_cselect_b32 s31, 0, 1
    s_sub_u32 s51, 5120, s50
    s_mul_i32 s30, s26, 20480
    s_add_u32 s30, s30, s45
    s_add_u32 s46, s30, s50
    s_add_u32 s47, s30, s51
    s_lshl_b32 s32, s24, 1
    s_add_u32 s32, s32, s31
    s_lshl_b32 s65, s32, 7
    s_add_u32 s65, s65, 32603264
    s_lshr_b32 s33, s32, 3
    s_mul_i32 s33, s33, 20480
    s_and_b32 s32, s32, 7
    s_lshl_b32 s32, s32, 7
    s_add_u32 s32, s32, s33
    s_add_u32 s32, s32, 33071104
    s_sub_u32 s32, s32, s30
    v_and_b32 v10, 1, v4
    v_lshlrev_b32 v10, 4, v10
    v_lshl_add_u32 v10, v3, 5, v10
    v_add_u32 v10, s32, v10
    s_lshl_b32 s31, s26, 4
    s_cmp_eq_u32 s26, 0
    s_cselect_b32 s33, -1, 1
    s_add_u32 s33, s33, s31
    v_add_u32 v8, s33, v4
    v_cmp_lt_u32 vcc, 63, v8
    s_nop 1
    v_cndmask_b32 v42, v2, v10, vcc
    s_cmp_eq_u32 s26, 0
    s_cselect_b32 s33, -2, 2
    s_add_u32 s33, s33, s31
    v_add_u32 v8, s33, v4
    v_cmp_lt_u32 vcc, 63, v8
    s_nop 1
    v_cndmask_b32 v43, v2, v10, vcc
    v_and_b32 v9, 7, v1
    v_lshlrev_b32 v9, 2, v9
    v_lshrrev_b32 v8, 3, v1
    v_lshl_add_u32 v33, v8, 7, v9
    v_add_u32 v8, s35, v8
    v_subrev_u32 v8, 1, v8
    v_and_b32 v8, 127, v8
    v_lshl_add_u32 v37, v8, 7, v9
    s_mov_b32 s16, s10
    s_mov_b32 s17, s11
    s_mov_b32 s18, 2621440
    s_mov_b32 s19, 0x20000
    s_mul_i32 s36, s35, 20480
    s_lshr_b32 s30, s25, 1
    s_and_b32 s31, s25, 1
    s_mul_i32 s37, s30, 5120
    s_add_u32 s38, s37, 4096
    s_lshl_b32 s32, s31, 11
    s_add_u32 s37, s37, s32
    s_lshl_b32 s32, s31, 3
    s_add_u32 s38, s38, s32
    s_lshl_b32 s39, s35, 10
    s_lshl_b32 s33, s30, 8
    s_add_u32 s39, s39, s33
    s_add_u32 s39, s39, s32
    s_lshl_b32 s62, s35, 7
    s_add_u32 s62, s62, 32530432
    s_lshl_b32 s63, s25, 2
    s_add_u32 s63, s63, s62
    s_waitcnt lgkmcnt(0)
    v_readfirstlane_b32 s30, v17
    s_and_b32 s60, s30, 0xff
    s_and_b32 s61, s30, s59
    v_lshlrev_b32 v64, 16, v20
    v_and_b32 v65, 0xffff0000, v20
    v_lshlrev_b32 v66, 16, v21
    v_and_b32 v67, 0xffff0000, v21
    v_lshlrev_b32 v68, 16, v22
    v_and_b32 v69, 0xffff0000, v22
    v_lshlrev_b32 v70, 16, v23
    v_and_b32 v71, 0xffff0000, v23
    v_lshlrev_b32 v72, 16, v24
    v_and_b32 v73, 0xffff0000, v24
    v_lshlrev_b32 v74, 16, v25
    v_and_b32 v75, 0xffff0000, v25
    v_lshlrev_b32 v76, 16, v26
    v_and_b32 v77, 0xffff0000, v26
    v_lshlrev_b32 v78, 16, v27
    v_and_b32 v79, 0xffff0000, v27
    v_lshlrev_b32 v80, 16, v28
    v_and_b32 v81, 0xffff0000, v28
    v_lshlrev_b32 v82, 16, v29
    v_and_b32 v83, 0xffff0000, v29
    s_lshr_b32 s30, s24, 2
    s_lshl_b32 s30, s30, 12
    s_and_b32 s31, s24, 3
    s_lshl_b32 s31, s31, 2
    s_add_u32 s30, s30, s31
    s_add_u32 s30, s30, 32644224
    s_mov_b32 s67, s30
    v_lshlrev_b32 v54, 7, v1
    s_and_b32 s31, s24, 24
    s_lshl_b32 s56, 0xff, s31
    s_mov_b32 s57, 0
    s_mov_b32 s40, -1
    s_mov_b32 s41, 0
    s_lshr_b32 s31, s24, 3
    s_mov_b32 s31, 0
    s_and_b32 s31, s31, 3
    s_mul_i32 s31, s31, 5120
    s_add_u32 s52, s31, s36
    s_lshr_b32 s31, s24, 3
    s_mov_b32 s31, 1
    s_and_b32 s31, s31, 3
    s_mul_i32 s31, s31, 5120
    s_add_u32 s53, s31, s36
    s_lshr_b32 s31, s24, 3
    s_mov_b32 s31, 2
    s_and_b32 s31, s31, 3
    s_mul_i32 s31, s31, 5120
    s_add_u32 s54, s31, s36
    s_lshr_b32 s31, s24, 3
    s_mov_b32 s31, 3
    s_and_b32 s31, s31, 3
    s_mul_i32 s31, s31, 5120
    s_add_u32 s55, s31, s36
L_m_nd0:
    ds_read_b128 v[12:15], v7
    s_waitcnt lgkmcnt(0)
    v_min3_u32 v12, v12, v13, v14
    v_min_u32 v12, v12, v15
    s_nop 0
    v_readfirstlane_b32 s66, v12
    s_cmp_lt_u32 s66, 1
    s_cbranch_scc1 L_m_nd0
    ds_read_b128 v[84:87], v31 offset:16384
    ds_read_b128 v[88:91], v31 offset:36864
    ds_read_b128 v[92:95], v30 offset:0
    ds_read_b128 v[96:99], v30 offset:40960
    ds_read_b128 v[100:103], v30 offset:20480
    ds_read_b128 v[104:107], v31 offset:17408
    ds_read_b128 v[108:111], v31 offset:37888
    ds_read_b128 v[112:115], v30 offset:1024
    ds_read_b128 v[116:119], v30 offset:41984
    s_mov_b32 s58, 400000
    s_mov_b64 exec, s[40:41]
L_m_poll_o:
    buffer_load_dword v17, v54, s[20:23], s30 offen sc1
    s_sub_u32 s58, s58, 1
    s_waitcnt vmcnt(0)
    v_cmp_gt_u32 vcc, 1, v17
    s_cmp_eq_u32 s58, 0
    s_cbranch_scc1 L_m_poll_o_x
    s_cbranch_vccnz L_m_poll_o
L_m_poll_o_x:
    s_mov_b64 exec, -1
    s_add_u32 s30, s52, 8912896
    buffer_load_dwordx4 v[124:127], v2, s[20:23], s30 offen offset:0 sc1
    buffer_load_dwordx4 v[128:131], v2, s[20:23], s30 offen offset:1024 sc1
    buffer_load_dwordx4 v[132:135], v2, s[20:23], s30 offen offset:2048 sc1
    buffer_load_dwordx4 v[136:139], v2, s[20:23], s30 offen offset:3072 sc1
    s_add_u32 s30, s52, 8916992
    buffer_load_dwordx2 v[140:141], v38, s[20:23], s30 offen sc1
    buffer_load_dwordx2 v[142:143], v38, s[20:23], s30 offen offset:128 sc1
    s_add_u32 s30, s53, 8912896
    buffer_load_dwordx4 v[144:147], v2, s[20:23], s30 offen offset:0 sc1
    buffer_load_dwordx4 v[148:151], v2, s[20:23], s30 offen offset:1024 sc1
    buffer_load_dwordx4 v[152:155], v2, s[20:23], s30 offen offset:2048 sc1
    buffer_load_dwordx4 v[156:159], v2, s[20:23], s30 offen offset:3072 sc1
    s_add_u32 s30, s53, 8916992
    buffer_load_dwordx2 v[160:161], v38, s[20:23], s30 offen sc1
    buffer_load_dwordx2 v[162:163], v38, s[20:23], s30 offen offset:128 sc1
    s_waitcnt vmcnt(11) lgkmcnt(4)
    v_mfma_f32_16x16x32_bf16 v[64:67], v[84:87], v[124:127], v[64:67]
    s_add_u32 s30, s54, 8912896
    buffer_load_dwordx4 v[164:167], v2, s[20:23], s30 offen offset:0 sc1
    ds_read_b128 v[120:123], v30 offset:21504
    v_mfma_f32_16x16x32_bf16 v[68:71], v[88:91], v[124:127], v[68:71]
    ds_read_b128 v[84:87], v31 offset:18432
    v_mfma_f32_16x16x32_bf16 v[72:75], v[92:95], v[124:127], v[72:75]
    ds_read_b128 v[88:91], v31 offset:38912
    v_mfma_f32_16x16x32_bf16 v[76:79], v[96:99], v[124:127], v[76:79]
    ds_read_b128 v[92:95], v30 offset:2048
    v_mfma_f32_16x16x32_bf16 v[80:83], v[100:103], v[124:127], v[80:83]
    ds_read_b128 v[96:99], v30 offset:43008
    s_waitcnt vmcnt(11) lgkmcnt(4)
    v_mfma_f32_16x16x32_bf16 v[64:67], v[104:107], v[128:131], v[64:67]
    buffer_load_dwordx4 v[124:127], v2, s[20:23], s30 offen offset:1024 sc1
    ds_read_b128 v[100:103], v30 offset:22528
    v_mfma_f32_16x16x32_bf16 v[68:71], v[108:111], v[128:131], v[68:71]
    ds_read_b128 v[104:107], v31 offset:19456
    v_mfma_f32_16x16x32_bf16 v[72:75], v[112:115], v[128:131], v[72:75]
    ds_read_b128 v[108:111], v31 offset:39936
    v_mfma_f32_16x16x32_bf16 v[76:79], v[116:119], v[128:131], v[76:79]
    ds_read_b128 v[112:115], v30 offset:3072
    v_mfma_f32_16x16x32_bf16 v[80:83], v[120:123], v[128:131], v[80:83]
    ds_read_b128 v[116:119], v30 offset:44032
    s_waitcnt vmcnt(11) lgkmcnt(4)
    v_mfma_f32_16x16x32_bf16 v[64:67], v[84:87], v[132:135], v[64:67]
    buffer_load_dwordx4 v[128:131], v2, s[20:23], s30 offen offset:2048 sc1
    ds_read_b128 v[120:123], v30 offset:23552
    v_mfma_f32_16x16x32_bf16 v[68:71], v[88:91], v[132:135], v[68:71]
    ds_read_b128 v[84:87], v31 offset:20480
    v_mfma_f32_16x16x32_bf16 v[72:75], v[92:95], v[132:135], v[72:75]
    ds_read_b128 v[88:91], v31 offset:40960
    v_mfma_f32_16x16x32_bf16 v[76:79], v[96:99], v[132:135], v[76:79]
    ds_read_b128 v[92:95], v30 offset:4096
    v_mfma_f32_16x16x32_bf16 v[80:83], v[100:103], v[132:135], v[80:83]
    ds_read_b128 v[96:99], v30 offset:45056
    s_waitcnt vmcnt(11) lgkmcnt(4)
    v_mfma_f32_16x16x32_bf16 v[64:67], v[104:107], v[136:139], v[64:67]
    buffer_load_dwordx4 v[132:135], v2, s[20:23], s30 offen offset:3072 sc1
    ds_read_b128 v[100:103], v30 offset:24576
    v_mfma_f32_16x16x32_bf16 v[68:71], v[108:111], v[136:139], v[68:71]
    ds_read_b128 v[104:107], v31 offset:21504
    v_mfma_f32_16x16x32_bf16 v[72:75], v[112:115], v[136:139], v[72:75]
    ds_read_b128 v[108:111], v31 offset:41984
    v_mfma_f32_16x16x32_bf16 v[76:79], v[116:119], v[136:139], v[76:79]
    ds_read_b128 v[112:115], v30 offset:5120
    v_mfma_f32_16x16x32_bf16 v[80:83], v[120:123], v[136:139], v[80:83]
    ds_read_b128 v[116:119], v30 offset:46080
    s_waitcnt vmcnt(10) lgkmcnt(4)
    v_mfma_f32_16x16x32_bf16 v[64:67], v[84:87], v[140:143], v[64:67]
    s_add_u32 s30, s54, 8916992
    buffer_load_dwordx2 v[136:137], v38, s[20:23], s30 offen sc1
    buffer_load_dwordx2 v[138:139], v38, s[20:23], s30 offen offset:128 sc1
    ds_read_b128 v[120:123], v30 offset:25600
    v_mfma_f32_16x16x32_bf16 v[68:71], v[88:91], v[140:143], v[68:71]
    ds_read_b128 v[84:87], v31 offset:22528
    v_mfma_f32_16x16x32_bf16 v[72:75], v[92:95], v[140:143], v[72:75]
    ds_read_b128 v[88:91], v31 offset:43008
    v_mfma_f32_16x16x32_bf16 v[76:79], v[96:99], v[140:143], v[76:79]
    ds_read_b128 v[92:95], v30 offset:6144
    v_mfma_f32_16x16x32_bf16 v[80:83], v[100:103], v[140:143], v[80:83]
    ds_read_b128 v[96:99], v30 offset:47104
    s_waitcnt vmcnt(11) lgkmcnt(4)
    v_mfma_f32_16x16x32_bf16 v[64:67], v[104:107], v[144:147], v[64:67]
L_m_ownb:
    s_add_u32 s30, s55, 8912896
    buffer_load_dwordx4 v[140:143], v2, s[20:23], s30 offen offset:0 sc1
    ds_read_b128 v[100:103], v30 offset:26624
    v_mfma_f32_16x16x32_bf16 v[68:71], v[108:111], v[144:147], v[68:71]
    ds_read_b128 v[104:107], v31 offset:23552
    v_mfma_f32_16x16x32_bf16 v[72:75], v[112:115], v[144:147], v[72:75]
    ds_read_b128 v[108:111], v31 offset:44032
    v_mfma_f32_16x16x32_bf16 v[76:79], v[116:119], v[144:147], v[76:79]
    ds_read_b128 v[112:115], v30 offset:7168
    v_mfma_f32_16x16x32_bf16 v[80:83], v[120:123], v[144:147], v[80:83]
    ds_read_b128 v[116:119], v30 offset:48128
    s_waitcnt vmcnt(11) lgkmcnt(4)
    v_mfma_f32_16x16x32_bf16 v[64:67], v[84:87], v[148:151], v[64:67]
    buffer_load_dwordx4 v[144:147], v2, s[20:23], s30 offen offset:1024 sc1
    ds_read_b128 v[120:123], v30 offset:27648
    v_mfma_f32_16x16x32_bf16 v[68:71], v[88:91], v[148:151], v[68:71]
    ds_read_b128 v[84:87], v31 offset:24576
    v_mfma_f32_16x16x32_bf16 v[72:75], v[92:95], v[148:151], v[72:75]
    ds_read_b128 v[88:91], v31 offset:45056
    v_mfma_f32_16x16x32_bf16 v[76:79], v[96:99], v[148:151], v[76:79]
    ds_read_b128 v[92:95], v30 offset:8192
    v_mfma_f32_16x16x32_bf16 v[80:83], v[100:103], v[148:151], v[80:83]
    ds_read_b128 v[96:99], v30 offset:49152
    s_waitcnt vmcnt(11) lgkmcnt(4)
    v_mfma_f32_16x16x32_bf16 v[64:67], v[104:107], v[152:155], v[64:67]
    buffer_load_dwordx4 v[148:151], v2, s[20:23], s30 offen offset:2048 sc1
    ds_read_b128 v[100:103], v30 offset:28672
    v_mfma_f32_16x16x32_bf16 v[68:71], v[108:111], v[152:155], v[68:71]
    ds_read_b128 v[104:107], v31 offset:25600
    v_mfma_f32_16x16x32_bf16 v[72:75], v[112:115], v[152:155], v[72:75]
    ds_read_b128 v[108:111], v31 offset:46080
    v_mfma_f32_16x16x32_bf16 v[76:79], v[116:119], v[152:155], v[76:79]
    ds_read_b128 v[112:115], v30 offset:9216
    v_mfma_f32_16x16x32_bf16 v[80:83], v[120:123], v[152:155], v[80:83]
    ds_read_b128 v[116:119], v30 offset:50176
    s_waitcnt vmcnt(11) lgkmcnt(4)
    v_mfma_f32_16x16x32_bf16 v[64:67], v[84:87], v[156:159], v[64:67]
    buffer_load_dwordx4 v[152:155], v2, s[20:23], s30 offen offset:3072 sc1
    ds_read_b128 v[120:123], v30 offset:29696
    v_mfma_f32_16x16x32_bf16 v[68:71], v[88:91], v[156:159], v[68:71]
    ds_read_b128 v[84:87], v31 offset:26624
    v_mfma_f32_16x16x32_bf16 v[72:75], v[92:95], v[156:159], v[72:75]
    ds_read_b128 v[88:91], v31 offset:47104
    v_mfma_f32_16x16x32_bf16 v[76:79], v[96:99], v[156:159], v[76:79]
    ds_read_b128 v[92:95], v30 offset:10240
    v_mfma_f32_16x16x32_bf16 v[80:83], v[100:103], v[156:159], v[80:83]
    ds_read_b128 v[96:99], v30 offset:51200
    s_waitcnt vmcnt(10) lgkmcnt(4)
    v_mfma_f32_16x16x32_bf16 v[64:67], v[104:107], v[160:163], v[64:67]
    s_add_u32 s30, s55, 8916992
    buffer_load_dwordx2 v[156:157], v38, s[20:23], s30 offen sc1
    buffer_load_dwordx2 v[158:159], v38, s[20:23], s30 offen offset:128 sc1
    ds_read_b128 v[100:103], v30 offset:30720
    v_mfma_f32_16x16x32_bf16 v[68:71], v[108:111], v[160:163], v[68:71]
    ds_read_b128 v[104:107], v31 offset:27648
    v_mfma_f32_16x16x32_bf16 v[72:75], v[112:115], v[160:163], v[72:75]
    ds_read_b128 v[108:111], v31 offset:48128
    v_mfma_f32_16x16x32_bf16 v[76:79], v[116:119], v[160:163], v[76:79]
    ds_read_b128 v[112:115], v30 offset:11264
    v_mfma_f32_16x16x32_bf16 v[80:83], v[120:123], v[160:163], v[80:83]
    ds_read_b128 v[116:119], v30 offset:52224
    s_waitcnt vmcnt(11) lgkmcnt(4)
    v_mfma_f32_16x16x32_bf16 v[64:67], v[84:87], v[164:167], v[64:67]
    v_mov_b32 v16, 1
    ds_write_b32 v5, v16 offset:80
    ds_read_b128 v[120:123], v30 offset:31744
    v_mfma_f32_16x16x32_bf16 v[68:71], v[88:91], v[164:167], v[68:71]
    ds_read_b128 v[84:87], v31 offset:28672
    v_mfma_f32_16x16x32_bf16 v[72:75], v[92:95], v[164:167], v[72:75]
    ds_read_b128 v[88:91], v31 offset:49152
    v_mfma_f32_16x16x32_bf16 v[76:79], v[96:99], v[164:167], v[76:79]
    ds_read_b128 v[92:95], v30 offset:12288
    v_mfma_f32_16x16x32_bf16 v[80:83], v[100:103], v[164:167], v[80:83]
    ds_read_b128 v[96:99], v30 offset:53248
    s_waitcnt vmcnt(10) lgkmcnt(4)
    v_mfma_f32_16x16x32_bf16 v[64:67], v[104:107], v[124:127], v[64:67]
    ds_read_b128 v[100:103], v30 offset:32768
    v_mfma_f32_16x16x32_bf16 v[68:71], v[108:111], v[124:127], v[68:71]
    ds_read_b128 v[104:107], v31 offset:29696
    v_mfma_f32_16x16x32_bf16 v[72:75], v[112:115], v[124:127], v[72:75]
    ds_read_b128 v[108:111], v31 offset:50176
    v_mfma_f32_16x16x32_bf16 v[76:79], v[116:119], v[124:127], v[76:79]
    ds_read_b128 v[112:115], v30 offset:13312
    v_mfma_f32_16x16x32_bf16 v[80:83], v[120:123], v[124:127], v[80:83]
    ds_read_b128 v[116:119], v30 offset:54272
    s_waitcnt vmcnt(9) lgkmcnt(4)
    v_mfma_f32_16x16x32_bf16 v[64:67], v[84:87], v[128:131], v[64:67]
    ds_read_b128 v[120:123], v30 offset:33792
    v_mfma_f32_16x16x32_bf16 v[68:71], v[88:91], v[128:131], v[68:71]
    ds_read_b128 v[84:87], v31 offset:30720
    v_mfma_f32_16x16x32_bf16 v[72:75], v[92:95], v[128:131], v[72:75]
    ds_read_b128 v[88:91], v31 offset:51200
    v_mfma_f32_16x16x32_bf16 v[76:79], v[96:99], v[128:131], v[76:79]
    ds_read_b128 v[92:95], v30 offset:14336
    v_mfma_f32_16x16x32_bf16 v[80:83], v[100:103], v[128:131], v[80:83]
    ds_read_b128 v[96:99], v30 offset:55296
    s_waitcnt vmcnt(8) lgkmcnt(4)
    v_mfma_f32_16x16x32_bf16 v[64:67], v[104:107], v[132:135], v[64:67]
    ds_read_b128 v[100:103], v30 offset:34816
    v_mfma_f32_16x16x32_bf16 v[68:71], v[108:111], v[132:135], v[68:71]
    ds_read_b128 v[104:107], v31 offset:31744
    v_mfma_f32_16x16x32_bf16 v[72:75], v[112:115], v[132:135], v[72:75]
    ds_read_b128 v[108:111], v31 offset:52224
    v_mfma_f32_16x16x32_bf16 v[76:79], v[116:119], v[132:135], v[76:79]
    ds_read_b128 v[112:115], v30 offset:15360
    v_mfma_f32_16x16x32_bf16 v[80:83], v[120:123], v[132:135], v[80:83]
    ds_read_b128 v[116:119], v30 offset:56320
    s_waitcnt vmcnt(6) lgkmcnt(4)
    v_mfma_f32_16x16x32_bf16 v[64:67], v[84:87], v[136:139], v[64:67]
    ds_read_b128 v[120:123], v30 offset:35840
    v_mfma_f32_16x16x32_bf16 v[68:71], v[88:91], v[136:139], v[68:71]
    ds_read_b128 v[84:87], v31 offset:32768
    v_mfma_f32_16x16x32_bf16 v[72:75], v[92:95], v[136:139], v[72:75]
    ds_read_b128 v[88:91], v31 offset:53248
    v_mfma_f32_16x16x32_bf16 v[76:79], v[96:99], v[136:139], v[76:79]
    ds_read_b128 v[92:95], v30 offset:16384
    v_mfma_f32_16x16x32_bf16 v[80:83], v[100:103], v[136:139], v[80:83]
    ds_read_b128 v[96:99], v30 offset:57344
    s_waitcnt vmcnt(5) lgkmcnt(4)
    v_mfma_f32_16x16x32_bf16 v[64:67], v[104:107], v[140:143], v[64:67]
    ds_read_b128 v[100:103], v30 offset:36864
    v_mfma_f32_16x16x32_bf16 v[68:71], v[108:111], v[140:143], v[68:71]
    ds_read_b128 v[104:107], v31 offset:33792
    v_mfma_f32_16x16x32_bf16 v[72:75], v[112:115], v[140:143], v[72:75]
    ds_read_b128 v[108:111], v31 offset:54272
    v_mfma_f32_16x16x32_bf16 v[76:79], v[116:119], v[140:143], v[76:79]
    ds_read_b128 v[112:115], v30 offset:17408
    v_mfma_f32_16x16x32_bf16 v[80:83], v[120:123], v[140:143], v[80:83]
    ds_read_b128 v[116:119], v30 offset:58368
    s_waitcnt vmcnt(4) lgkmcnt(4)
    v_mfma_f32_16x16x32_bf16 v[64:67], v[84:87], v[144:147], v[64:67]
    ds_read_b128 v[120:123], v30 offset:37888
    v_mfma_f32_16x16x32_bf16 v[68:71], v[88:91], v[144:147], v[68:71]
    ds_read_b128 v[84:87], v31 offset:34816
    v_mfma_f32_16x16x32_bf16 v[72:75], v[92:95], v[144:147], v[72:75]
    ds_read_b128 v[88:91], v31 offset:55296
    v_mfma_f32_16x16x32_bf16 v[76:79], v[96:99], v[144:147], v[76:79]
    ds_read_b128 v[92:95], v30 offset:18432
    v_mfma_f32_16x16x32_bf16 v[80:83], v[100:103], v[144:147], v[80:83]
    ds_read_b128 v[96:99], v30 offset:59392
    s_waitcnt vmcnt(3) lgkmcnt(4)
    v_mfma_f32_16x16x32_bf16 v[64:67], v[104:107], v[148:151], v[64:67]
    ds_read_b128 v[100:103], v30 offset:38912
    v_mfma_f32_16x16x32_bf16 v[68:71], v[108:111], v[148:151], v[68:71]
    ds_read_b128 v[104:107], v31 offset:35840
    v_mfma_f32_16x16x32_bf16 v[72:75], v[112:115], v[148:151], v[72:75]
    ds_read_b128 v[108:111], v31 offset:56320
    v_mfma_f32_16x16x32_bf16 v[76:79], v[116:119], v[148:151], v[76:79]
    ds_read_b128 v[112:115], v30 offset:19456
    v_mfma_f32_16x16x32_bf16 v[80:83], v[120:123], v[148:151], v[80:83]
    ds_read_b128 v[116:119], v30 offset:60416
    s_waitcnt vmcnt(2) lgkmcnt(4)
    v_mfma_f32_16x16x32_bf16 v[64:67], v[84:87], v[152:155], v[64:67]
    ds_read_b128 v[120:123], v30 offset:39936
    v_mfma_f32_16x16x32_bf16 v[68:71], v[88:91], v[152:155], v[68:71]
    v_mfma_f32_16x16x32_bf16 v[72:75], v[92:95], v[152:155], v[72:75]
    v_mfma_f32_16x16x32_bf16 v[76:79], v[96:99], v[152:155], v[76:79]
    v_mfma_f32_16x16x32_bf16 v[80:83], v[100:103], v[152:155], v[80:83]
    s_waitcnt vmcnt(0) lgkmcnt(0)
    v_mfma_f32_16x16x32_bf16 v[64:67], v[104:107], v[156:159], v[64:67]
    v_mfma_f32_16x16x32_bf16 v[68:71], v[108:111], v[156:159], v[68:71]
    v_mfma_f32_16x16x32_bf16 v[72:75], v[112:115], v[156:159], v[72:75]
    v_mfma_f32_16x16x32_bf16 v[76:79], v[116:119], v[156:159], v[76:79]
    v_mfma_f32_16x16x32_bf16 v[80:83], v[120:123], v[156:159], v[80:83]
    v_mov_b32 v16, 20
    ds_write_b32 v5, v16 offset:0
    v_lshlrev_b32 v38, 3, v1
    s_nop 5
    v_cvt_pk_bf16_f32 v20, v64, v65
    v_cvt_pk_bf16_f32 v21, v66, v67
    v_cvt_pk_bf16_f32 v22, v68, v69
    v_cvt_pk_bf16_f32 v23, v70, v71
    v_cvt_pk_bf16_f32 v24, v72, v73
    v_cvt_pk_bf16_f32 v25, v74, v75
    v_cvt_pk_bf16_f32 v26, v76, v77
    v_cvt_pk_bf16_f32 v27, v78, v79
    v_cvt_pk_bf16_f32 v28, v80, v81
    v_cvt_pk_bf16_f32 v29, v82, v83
    s_cmp_lg_u32 s60, 0
    s_cbranch_scc1 L_m_pub_h_s
    s_mul_i32 s30, s25, 10240
    s_add_u32 s30, s30, s44
    buffer_store_dwordx4 v[20:23], v2, s[20:23], s30 offen
    buffer_store_dwordx4 v[24:27], v2, s[20:23], s30 offen offset:1024
    buffer_store_dwordx2 v[28:29], v38, s[20:23], s30 offen offset:2048
    v_pk_add_f32 v[12:13], v[64:65], v[66:67]
    v_pk_mul_f32 v[14:15], v[64:65], v[64:65]
    v_pk_fma_f32 v[14:15], v[66:67], v[66:67], v[14:15]
    v_pk_add_f32 v[12:13], v[12:13], v[68:69]
    v_pk_fma_f32 v[14:15], v[68:69], v[68:69], v[14:15]
    v_pk_add_f32 v[12:13], v[12:13], v[70:71]
    v_pk_fma_f32 v[14:15], v[70:71], v[70:71], v[14:15]
    v_pk_add_f32 v[12:13], v[12:13], v[72:73]
    v_pk_fma_f32 v[14:15], v[72:73], v[72:73], v[14:15]
    v_pk_add_f32 v[12:13], v[12:13], v[74:75]
    v_pk_fma_f32 v[14:15], v[74:75], v[74:75], v[14:15]
    v_pk_add_f32 v[12:13], v[12:13], v[76:77]
    v_pk_fma_f32 v[14:15], v[76:77], v[76:77], v[14:15]
    v_pk_add_f32 v[12:13], v[12:13], v[78:79]
    v_pk_fma_f32 v[14:15], v[78:79], v[78:79], v[14:15]
    v_pk_add_f32 v[12:13], v[12:13], v[80:81]
    v_pk_fma_f32 v[14:15], v[80:81], v[80:81], v[14:15]
    v_pk_add_f32 v[12:13], v[12:13], v[82:83]
    v_pk_fma_f32 v[14:15], v[82:83], v[82:83], v[14:15]
    v_add_f32 v12, v12, v13
    v_add_f32 v13, v14, v15
    v_mov_b32 v8, v12
    v_mov_b32 v9, v13
    s_nop 1
    v_permlane16_swap_b32 v12, v8
    v_permlane16_swap_b32 v13, v9
    s_nop 1
    v_add_f32 v12, v12, v8
    v_add_f32 v13, v13, v9
    v_mov_b32 v8, v12
    v_mov_b32 v9, v13
    s_nop 1
    v_permlane32_swap_b32 v12, v8
    v_permlane32_swap_b32 v13, v9
    s_nop 1
    v_add_f32 v12, v12, v8
    v_add_f32 v13, v13, v9
    s_add_u32 s32, s39, 32079872
    s_mov_b64 exec, 0xffff
    buffer_store_dwordx2 v[12:13], v2, s[20:23], s32 offen
    s_mov_b64 exec, -1
    s_add_u32 s66, s63, 0
    s_mov_b64 exec, 1
    s_waitcnt vmcnt(0)
    buffer_store_dword v6, off, s[20:23], s66
    s_mov_b64 exec, -1
L_m_pub_h_d:
    s_mov_b32 s58, 400000
    s_mov_b64 exec, 0xff
L_m_poll_h:
    buffer_load_dword v17, v33, s[20:23], s62 offen sc1
    s_sub_u32 s58, s58, 1
    s_waitcnt vmcnt(0)
    v_cmp_gt_u32 vcc, 1, v17
    s_cmp_eq_u32 s58, 0
    s_cbranch_scc1 L_m_poll_h_x
    s_cbranch_vccnz L_m_poll_h
L_m_poll_h_x:
    s_mov_b64 exec, -1
    s_add_u32 s30, s44, 0
    s_add_u32 s31, s44, 10240
    buffer_load_dwordx4 v[124:127], v2, s[20:23], s30 offen offset:0 sc1
    buffer_load_dwordx4 v[128:131], v2, s[20:23], s30 offen offset:1024 sc1
    buffer_load_dwordx4 v[132:135], v2, s[20:23], s31 offen offset:0 sc1
    buffer_load_dwordx4 v[136:139], v2, s[20:23], s31 offen offset:1024 sc1
    buffer_load_dwordx2 v[140:141], v38, s[20:23], s30 offen offset:2048 sc1
    buffer_load_dwordx2 v[142:143], v38, s[20:23], s31 offen offset:2048 sc1
    s_add_u32 s30, s44, 20480
    s_add_u32 s31, s44, 30720
    buffer_load_dwordx4 v[144:147], v2, s[20:23], s30 offen offset:0 sc1
    s_lshl_b32 s32, s35, 10
    s_add_u32 s32, s32, 32079872
    buffer_load_dwordx4 v[54:57], v2, s[20:23], s32 offen sc1
L_m_nd1:
    ds_read_b128 v[12:15], v7
    s_waitcnt lgkmcnt(0)
    v_min3_u32 v12, v12, v13, v14
    v_min_u32 v12, v12, v15
    s_nop 0
    v_readfirstlane_b32 s66, v12
    s_cmp_lt_u32 s66, 2
    s_cbranch_scc1 L_m_nd1
    ds_read_b128 v[84:87], v30 offset:61440
    ds_read_b128 v[88:91], v31 offset:57344
    ds_read_b128 v[92:95], v30 offset:0
    ds_read_b128 v[96:99], v30 offset:20480
    ds_read_b128 v[100:103], v30 offset:40960
    ds_read_b128 v[104:107], v30 offset:62464
    ds_read_b128 v[108:111], v31 offset:58368
    ds_read_b128 v[112:115], v30 offset:1024
    ds_read_b128 v[116:119], v30 offset:21504
    s_waitcnt vmcnt(7) lgkmcnt(4)
    v_mfma_f32_16x16x32_bf16 v[64:67], v[84:87], v[124:127], 0
    buffer_load_dwordx4 v[148:151], v2, s[20:23], s30 offen offset:1024 sc1
    ds_read_b128 v[120:123], v30 offset:41984
    v_mfma_f32_16x16x32_bf16 v[68:71], v[88:91], v[124:127], 0
    ds_read_b128 v[84:87], v30 offset:63488
    v_mfma_f32_16x16x32_bf16 v[72:75], v[92:95], v[124:127], 0
    ds_read_b128 v[88:91], v31 offset:59392
    v_mfma_f32_16x16x32_bf16 v[76:79], v[96:99], v[124:127], 0
    ds_read_b128 v[92:95], v30 offset:2048
    v_mfma_f32_16x16x32_bf16 v[80:83], v[100:103], v[124:127], 0
    ds_read_b128 v[96:99], v30 offset:22528
    s_waitcnt vmcnt(7) lgkmcnt(4)
    v_mfma_f32_16x16x32_bf16 v[64:67], v[104:107], v[128:131], v[64:67]
    buffer_load_dwordx4 v[152:155], v2, s[20:23], s31 offen offset:0 sc1
    ds_read_b128 v[100:103], v30 offset:43008
    v_mfma_f32_16x16x32_bf16 v[68:71], v[108:111], v[128:131], v[68:71]
    ds_read_b128 v[104:107], v30 offset:64512
    v_mfma_f32_16x16x32_bf16 v[72:75], v[112:115], v[128:131], v[72:75]
    ds_read_b128 v[108:111], v31 offset:60416
    v_mfma_f32_16x16x32_bf16 v[76:79], v[116:119], v[128:131], v[76:79]
    ds_read_b128 v[112:115], v30 offset:3072
    v_mfma_f32_16x16x32_bf16 v[80:83], v[120:123], v[128:131], v[80:83]
    ds_read_b128 v[116:119], v30 offset:23552
    s_waitcnt vmcnt(7) lgkmcnt(4)
    v_mfma_f32_16x16x32_bf16 v[64:67], v[84:87], v[132:135], v[64:67]
    buffer_load_dwordx4 v[156:159], v2, s[20:23], s31 offen offset:1024 sc1
    ds_read_b128 v[120:123], v30 offset:44032
    v_mfma_f32_16x16x32_bf16 v[68:71], v[88:91], v[132:135], v[68:71]
    ds_read_b128 v[84:87], v31 offset:0
    v_mfma_f32_16x16x32_bf16 v[72:75], v[92:95], v[132:135], v[72:75]
    ds_read_b128 v[88:91], v31 offset:61440
    v_mfma_f32_16x16x32_bf16 v[76:79], v[96:99], v[132:135], v[76:79]
    ds_read_b128 v[92:95], v30 offset:4096
    v_mfma_f32_16x16x32_bf16 v[80:83], v[100:103], v[132:135], v[80:83]
    ds_read_b128 v[96:99], v30 offset:24576
    s_waitcnt vmcnt(7) lgkmcnt(4)
    v_mfma_f32_16x16x32_bf16 v[64:67], v[104:107], v[136:139], v[64:67]
    buffer_load_dwordx2 v[160:161], v38, s[20:23], s30 offen offset:2048 sc1
    buffer_load_dwordx2 v[162:163], v38, s[20:23], s31 offen offset:2048 sc1
    ds_read_b128 v[100:103], v30 offset:45056
    v_mfma_f32_16x16x32_bf16 v[68:71], v[108:111], v[136:139], v[68:71]
    ds_read_b128 v[104:107], v31 offset:1024
    v_mfma_f32_16x16x32_bf16 v[72:75], v[112:115], v[136:139], v[72:75]
    ds_read_b128 v[108:111], v31 offset:62464
    v_mfma_f32_16x16x32_bf16 v[76:79], v[116:119], v[136:139], v[76:79]
    ds_read_b128 v[112:115], v30 offset:5120
    v_mfma_f32_16x16x32_bf16 v[80:83], v[120:123], v[136:139], v[80:83]
    ds_read_b128 v[116:119], v30 offset:25600
    s_waitcnt vmcnt(7) lgkmcnt(4)
    v_mfma_f32_16x16x32_bf16 v[64:67], v[84:87], v[140:143], v[64:67]
    s_add_u32 s30, s44, 40960
    s_add_u32 s31, s44, 51200
    buffer_load_dwordx4 v[164:167], v2, s[20:23], s30 offen offset:0 sc1
    ds_read_b128 v[120:123], v30 offset:46080
    v_mfma_f32_16x16x32_bf16 v[68:71], v[88:91], v[140:143], v[68:71]
    ds_read_b128 v[84:87], v31 offset:2048
    v_mfma_f32_16x16x32_bf16 v[72:75], v[92:95], v[140:143], v[72:75]
    ds_read_b128 v[88:91], v31 offset:63488
    v_mfma_f32_16x16x32_bf16 v[76:79], v[96:99], v[140:143], v[76:79]
    ds_read_b128 v[92:95], v30 offset:6144
    v_mfma_f32_16x16x32_bf16 v[80:83], v[100:103], v[140:143], v[80:83]
    ds_read_b128 v[96:99], v30 offset:26624
    s_waitcnt vmcnt(6) lgkmcnt(4)
    v_mfma_f32_16x16x32_bf16 v[64:67], v[104:107], v[144:147], v[64:67]
    buffer_load_dwordx4 v[124:127], v2, s[20:23], s30 offen offset:1024 sc1
    ds_read_b128 v[100:103], v30 offset:47104
    v_mfma_f32_16x16x32_bf16 v[68:71], v[108:111], v[144:147], v[68:71]
    ds_read_b128 v[104:107], v31 offset:3072
    v_mfma_f32_16x16x32_bf16 v[72:75], v[112:115], v[144:147], v[72:75]
    ds_read_b128 v[108:111], v31 offset:64512
    v_mfma_f32_16x16x32_bf16 v[76:79], v[116:119], v[144:147], v[76:79]
    ds_read_b128 v[112:115], v30 offset:7168
    v_mfma_f32_16x16x32_bf16 v[80:83], v[120:123], v[144:147], v[80:83]
    ds_read_b128 v[116:119], v30 offset:27648
    s_waitcnt vmcnt(6) lgkmcnt(4)
    v_mfma_f32_16x16x32_bf16 v[64:67], v[84:87], v[148:151], v[64:67]
    buffer_load_dwordx4 v[128:131], v2, s[20:23], s31 offen offset:0 sc1
    ds_read_b128 v[120:123], v30 offset:48128
    v_mfma_f32_16x16x32_bf16 v[68:71], v[88:91], v[148:151], v[68:71]
    ds_read_b128 v[84:87], v31 offset:4096
    v_mfma_f32_16x16x32_bf16 v[72:75], v[92:95], v[148:151], v[72:75]
    ds_read_b128 v[88:91], v32 offset:0
    v_mfma_f32_16x16x32_bf16 v[76:79], v[96:99], v[148:151], v[76:79]
    ds_read_b128 v[92:95], v30 offset:8192
    v_mfma_f32_16x16x32_bf16 v[80:83], v[100:103], v[148:151], v[80:83]
    ds_read_b128 v[96:99], v30 offset:28672
    s_waitcnt vmcnt(6) lgkmcnt(4)
    v_mfma_f32_16x16x32_bf16 v[64:67], v[104:107], v[152:155], v[64:67]
    buffer_load_dwordx4 v[132:135], v2, s[20:23], s31 offen offset:1024 sc1
    ds_read_b128 v[100:103], v30 offset:49152
    v_mfma_f32_16x16x32_bf16 v[68:71], v[108:111], v[152:155], v[68:71]
    ds_read_b128 v[104:107], v31 offset:5120
    v_mfma_f32_16x16x32_bf16 v[72:75], v[112:115], v[152:155], v[72:75]
    ds_read_b128 v[108:111], v32 offset:1024
    v_mfma_f32_16x16x32_bf16 v[76:79], v[116:119], v[152:155], v[76:79]
    ds_read_b128 v[112:115], v30 offset:9216
    v_mfma_f32_16x16x32_bf16 v[80:83], v[120:123], v[152:155], v[80:83]
    ds_read_b128 v[116:119], v30 offset:29696
    s_waitcnt vmcnt(6) lgkmcnt(4)
    v_mfma_f32_16x16x32_bf16 v[64:67], v[84:87], v[156:159], v[64:67]
    buffer_load_dwordx2 v[136:137], v38, s[20:23], s30 offen offset:2048 sc1
    buffer_load_dwordx2 v[138:139], v38, s[20:23], s31 offen offset:2048 sc1
    ds_read_b128 v[120:123], v30 offset:50176
    v_mfma_f32_16x16x32_bf16 v[68:71], v[88:91], v[156:159], v[68:71]
    ds_read_b128 v[84:87], v31 offset:6144
    v_mfma_f32_16x16x32_bf16 v[72:75], v[92:95], v[156:159], v[72:75]
    ds_read_b128 v[88:91], v32 offset:2048
    v_mfma_f32_16x16x32_bf16 v[76:79], v[96:99], v[156:159], v[76:79]
    ds_read_b128 v[92:95], v30 offset:10240
    v_mfma_f32_16x16x32_bf16 v[80:83], v[100:103], v[156:159], v[80:83]
    ds_read_b128 v[96:99], v30 offset:30720
    s_waitcnt vmcnt(6) lgkmcnt(4)
    v_mfma_f32_16x16x32_bf16 v[64:67], v[104:107], v[160:163], v[64:67]
    s_add_u32 s30, s44, 61440
    s_add_u32 s31, s44, 71680
    buffer_load_dwordx4 v[140:143], v2, s[20:23], s30 offen offset:0 sc1
    ds_read_b128 v[100:103], v30 offset:51200
    v_mfma_f32_16x16x32_bf16 v[68:71], v[108:111], v[160:163], v[68:71]
    ds_read_b128 v[104:107], v31 offset:7168
    v_mfma_f32_16x16x32_bf16 v[72:75], v[112:115], v[160:163], v[72:75]
    ds_read_b128 v[108:111], v32 offset:3072
    v_mfma_f32_16x16x32_bf16 v[76:79], v[116:119], v[160:163], v[76:79]
    ds_read_b128 v[112:115], v30 offset:11264
    v_mfma_f32_16x16x32_bf16 v[80:83], v[120:123], v[160:163], v[80:83]
    ds_read_b128 v[116:119], v30 offset:31744
    s_waitcnt vmcnt(6) lgkmcnt(4)
    v_mfma_f32_16x16x32_bf16 v[64:67], v[84:87], v[164:167], v[64:67]
    buffer_load_dwordx4 v[144:147], v2, s[20:23], s30 offen offset:1024 sc1
    ds_read_b128 v[120:123], v30 offset:52224
    v_mfma_f32_16x16x32_bf16 v[68:71], v[88:91], v[164:167], v[68:71]
    ds_read_b128 v[84:87], v31 offset:8192
    v_mfma_f32_16x16x32_bf16 v[72:75], v[92:95], v[164:167], v[72:75]
    ds_read_b128 v[88:91], v32 offset:4096
    v_mfma_f32_16x16x32_bf16 v[76:79], v[96:99], v[164:167], v[76:79]
    ds_read_b128 v[92:95], v30 offset:12288
    v_mfma_f32_16x16x32_bf16 v[80:83], v[100:103], v[164:167], v[80:83]
    ds_read_b128 v[96:99], v30 offset:32768
    s_waitcnt vmcnt(6) lgkmcnt(4)
    v_mfma_f32_16x16x32_bf16 v[64:67], v[104:107], v[124:127], v[64:67]
    buffer_load_dwordx4 v[148:151], v2, s[20:23], s31 offen offset:0 sc1
    ds_read_b128 v[100:103], v30 offset:53248
    v_add_f32 v54, v54, v56
    v_mfma_f32_16x16x32_bf16 v[68:71], v[108:111], v[124:127], v[68:71]
    ds_read_b128 v[104:107], v31 offset:9216
    v_add_f32 v55, v55, v57
    v_mfma_f32_16x16x32_bf16 v[72:75], v[112:115], v[124:127], v[72:75]
    ds_read_b128 v[108:111], v32 offset:5120
    v_mov_b32 v56, v54
    v_mfma_f32_16x16x32_bf16 v[76:79], v[116:119], v[124:127], v[76:79]
    ds_read_b128 v[112:115], v30 offset:13312
    v_mov_b32 v57, v55
    v_mfma_f32_16x16x32_bf16 v[80:83], v[120:123], v[124:127], v[80:83]
    ds_read_b128 v[116:119], v30 offset:33792
    v_permlane16_swap_b32 v54, v56
    s_waitcnt vmcnt(6) lgkmcnt(4)
    v_mfma_f32_16x16x32_bf16 v[64:67], v[84:87], v[128:131], v[64:67]
    buffer_load_dwordx4 v[152:155], v2, s[20:23], s31 offen offset:1024 sc1
    ds_read_b128 v[120:123], v30 offset:54272
    v_permlane16_swap_b32 v55, v57
    v_mfma_f32_16x16x32_bf16 v[68:71], v[88:91], v[128:131], v[68:71]
    ds_read_b128 v[84:87], v31 offset:10240
    v_add_f32 v54, v54, v56
    v_mfma_f32_16x16x32_bf16 v[72:75], v[92:95], v[128:131], v[72:75]
    ds_read_b128 v[88:91], v32 offset:6144
    v_add_f32 v55, v55, v57
    v_mfma_f32_16x16x32_bf16 v[76:79], v[96:99], v[128:131], v[76:79]
    ds_read_b128 v[92:95], v30 offset:14336
    v_mov_b32 v56, v54
    v_mfma_f32_16x16x32_bf16 v[80:83], v[100:103], v[128:131], v[80:83]
    ds_read_b128 v[96:99], v30 offset:34816
    v_mov_b32 v57, v55
    s_waitcnt vmcnt(6) lgkmcnt(4)
    v_mfma_f32_16x16x32_bf16 v[64:67], v[104:107], v[132:135], v[64:67]
    buffer_load_dwordx2 v[156:157], v38, s[20:23], s30 offen offset:2048 sc1
    buffer_load_dwordx2 v[158:159], v38, s[20:23], s31 offen offset:2048 sc1
    ds_read_b128 v[100:103], v30 offset:55296
    v_permlane32_swap_b32 v54, v56
    v_mfma_f32_16x16x32_bf16 v[68:71], v[108:111], v[132:135], v[68:71]
    ds_read_b128 v[104:107], v31 offset:11264
    v_permlane32_swap_b32 v55, v57
    v_mfma_f32_16x16x32_bf16 v[72:75], v[112:115], v[132:135], v[72:75]
    ds_read_b128 v[108:111], v32 offset:7168
    v_add_f32 v54, v54, v56
    v_mfma_f32_16x16x32_bf16 v[76:79], v[116:119], v[132:135], v[76:79]
    ds_read_b128 v[112:115], v30 offset:15360
    v_add_f32 v55, v55, v57
    v_mfma_f32_16x16x32_bf16 v[80:83], v[120:123], v[132:135], v[80:83]
    ds_read_b128 v[116:119], v30 offset:35840
    v_mul_f32 v54, 0xbacccccd, v54
    s_waitcnt vmcnt(6) lgkmcnt(4)
    v_mfma_f32_16x16x32_bf16 v[64:67], v[84:87], v[136:139], v[64:67]
    v_mov_b32 v16, 2
    ds_write_b32 v5, v16 offset:80
    ds_read_b128 v[120:123], v30 offset:56320
    v_mul_f32 v55, 0x3acccccd, v55
    v_mfma_f32_16x16x32_bf16 v[68:71], v[88:91], v[136:139], v[68:71]
    ds_read_b128 v[84:87], v31 offset:12288
    v_fma_f32 v55, -v54, v54, v55
    v_mfma_f32_16x16x32_bf16 v[72:75], v[92:95], v[136:139], v[72:75]
    ds_read_b128 v[88:91], v32 offset:8192
    v_max_f32 v55, 0, v55
    v_mfma_f32_16x16x32_bf16 v[76:79], v[96:99], v[136:139], v[76:79]
    ds_read_b128 v[92:95], v30 offset:16384
    v_add_f32 v56, 0x3727c5ac, v55
    v_mfma_f32_16x16x32_bf16 v[80:83], v[100:103], v[136:139], v[80:83]
    ds_read_b128 v[96:99], v30 offset:36864
    v_rsq_f32 v56, v56
    s_waitcnt vmcnt(5) lgkmcnt(4)
    v_mfma_f32_16x16x32_bf16 v[64:67], v[104:107], v[140:143], v[64:67]
    ds_read_b128 v[100:103], v30 offset:57344
    v_mov_b32 v62, v56
    v_mfma_f32_16x16x32_bf16 v[68:71], v[108:111], v[140:143], v[68:71]
    ds_read_b128 v[104:107], v31 offset:13312
    v_mul_f32 v63, v54, v56
    v_mfma_f32_16x16x32_bf16 v[72:75], v[112:115], v[140:143], v[72:75]
    ds_read_b128 v[108:111], v32 offset:9216
    v_mul_f32 v57, v56, v56
    v_mfma_f32_16x16x32_bf16 v[76:79], v[116:119], v[140:143], v[76:79]
    ds_read_b128 v[112:115], v30 offset:17408
    v_mul_f32 v57, v57, v55
    v_mfma_f32_16x16x32_bf16 v[80:83], v[120:123], v[140:143], v[80:83]
    ds_read_b128 v[116:119], v30 offset:37888
    v_add_f32 v57, 0x3727c5ac, v57
    s_waitcnt vmcnt(4) lgkmcnt(4)
    v_mfma_f32_16x16x32_bf16 v[64:67], v[84:87], v[144:147], v[64:67]
    ds_read_b128 v[120:123], v30 offset:58368
    v_rsq_f32 v57, v57
    v_mfma_f32_16x16x32_bf16 v[68:71], v[88:91], v[144:147], v[68:71]
    ds_read_b128 v[84:87], v31 offset:14336
    v_mul_f32 v56, v56, v57
    v_mfma_f32_16x16x32_bf16 v[72:75], v[92:95], v[144:147], v[72:75]
    ds_read_b128 v[88:91], v32 offset:10240
    v_rcp_f32 v60, v56
    v_mfma_f32_16x16x32_bf16 v[76:79], v[96:99], v[144:147], v[76:79]
    ds_read_b128 v[92:95], v30 offset:18432
    v_mul_f32 v58, 0xc0135761, v56
    v_mfma_f32_16x16x32_bf16 v[80:83], v[100:103], v[144:147], v[80:83]
    ds_read_b128 v[96:99], v30 offset:38912
    v_mul_f32 v57, v56, v56
    s_waitcnt vmcnt(3) lgkmcnt(4)
    v_mfma_f32_16x16x32_bf16 v[64:67], v[104:107], v[148:151], v[64:67]
    ds_read_b128 v[100:103], v30 offset:59392
    v_mul_f32 v57, v57, v56
    v_mfma_f32_16x16x32_bf16 v[68:71], v[108:111], v[148:151], v[68:71]
    ds_read_b128 v[104:107], v31 offset:15360
    v_mul_f32 v59, 0xbdd2d3e8, v57
    v_mfma_f32_16x16x32_bf16 v[72:75], v[112:115], v[148:151], v[72:75]
    ds_read_b128 v[108:111], v32 offset:11264
    v_mfma_f32_16x16x32_bf16 v[76:79], v[116:119], v[148:151], v[76:79]
    ds_read_b128 v[112:115], v30 offset:19456
    v_mfma_f32_16x16x32_bf16 v[80:83], v[120:123], v[148:151], v[80:83]
    ds_read_b128 v[116:119], v30 offset:39936
    s_waitcnt vmcnt(2) lgkmcnt(4)
    v_mfma_f32_16x16x32_bf16 v[64:67], v[84:87], v[152:155], v[64:67]
    ds_read_b128 v[120:123], v30 offset:60416
    v_mfma_f32_16x16x32_bf16 v[68:71], v[88:91], v[152:155], v[68:71]
    ds_read_b128 v[124:127], v35 offset:0
    ds_read_b128 v[128:131], v35 offset:64
    ds_read_b128 v[132:135], v35 offset:128
    ds_read_b128 v[136:139], v35 offset:192
    ds_read_b128 v[140:143], v35 offset:256
    v_mfma_f32_16x16x32_bf16 v[72:75], v[92:95], v[152:155], v[72:75]
    v_mfma_f32_16x16x32_bf16 v[76:79], v[96:99], v[152:155], v[76:79]
    v_mfma_f32_16x16x32_bf16 v[80:83], v[100:103], v[152:155], v[80:83]
    s_waitcnt vmcnt(0) lgkmcnt(5)
    v_mfma_f32_16x16x32_bf16 v[64:67], v[104:107], v[156:159], v[64:67]
    v_mfma_f32_16x16x32_bf16 v[68:71], v[108:111], v[156:159], v[68:71]
    v_mfma_f32_16x16x32_bf16 v[72:75], v[112:115], v[156:159], v[72:75]
    v_mfma_f32_16x16x32_bf16 v[76:79], v[116:119], v[156:159], v[76:79]
    v_mfma_f32_16x16x32_bf16 v[80:83], v[120:123], v[156:159], v[80:83]
    v_mov_b32 v16, 25
    ds_write_b32 v5, v16 offset:0
    s_waitcnt lgkmcnt(0)
    s_nop 4
    v_pk_fma_f32 v[64:65], v[124:125], v[54:55], v[64:65] op_sel_hi:[1,0,1]
    v_pk_fma_f32 v[66:67], v[126:127], v[54:55], v[66:67] op_sel_hi:[1,0,1]
    v_pk_fma_f32 v[68:69], v[128:129], v[54:55], v[68:69] op_sel_hi:[1,0,1]
    v_pk_fma_f32 v[70:71], v[130:131], v[54:55], v[70:71] op_sel_hi:[1,0,1]
    v_pk_fma_f32 v[72:73], v[132:133], v[54:55], v[72:73] op_sel_hi:[1,0,1]
    v_pk_fma_f32 v[74:75], v[134:135], v[54:55], v[74:75] op_sel_hi:[1,0,1]
    v_pk_fma_f32 v[76:77], v[136:137], v[54:55], v[76:77] op_sel_hi:[1,0,1]
    v_pk_fma_f32 v[78:79], v[138:139], v[54:55], v[78:79] op_sel_hi:[1,0,1]
    v_pk_fma_f32 v[80:81], v[140:141], v[54:55], v[80:81] op_sel_hi:[1,0,1]
    v_pk_fma_f32 v[82:83], v[142:143], v[54:55], v[82:83] op_sel_hi:[1,0,1]
    v_pk_mul_f32 v[104:105], v[64:65], v[64:65]
    v_pk_mul_f32 v[106:107], v[66:67], v[66:67]
    v_pk_mul_f32 v[108:109], v[68:69], v[68:69]
    v_pk_mul_f32 v[110:111], v[70:71], v[70:71]
    v_pk_mul_f32 v[112:113], v[72:73], v[72:73]
    v_pk_mul_f32 v[114:115], v[74:75], v[74:75]
    v_pk_mul_f32 v[116:117], v[76:77], v[76:77]
    v_pk_mul_f32 v[118:119], v[78:79], v[78:79]
    v_pk_mul_f32 v[120:121], v[80:81], v[80:81]
    v_pk_mul_f32 v[122:123], v[82:83], v[82:83]
    v_pk_fma_f32 v[104:105], v[104:105], v[58:59], v[58:59] op_sel:[0,1,0] op_sel_hi:[1,1,0]
    v_pk_fma_f32 v[106:107], v[106:107], v[58:59], v[58:59] op_sel:[0,1,0] op_sel_hi:[1,1,0]
    v_pk_fma_f32 v[108:109], v[108:109], v[58:59], v[58:59] op_sel:[0,1,0] op_sel_hi:[1,1,0]
    v_pk_fma_f32 v[110:111], v[110:111], v[58:59], v[58:59] op_sel:[0,1,0] op_sel_hi:[1,1,0]
    v_pk_fma_f32 v[112:113], v[112:113], v[58:59], v[58:59] op_sel:[0,1,0] op_sel_hi:[1,1,0]
    v_pk_fma_f32 v[114:115], v[114:115], v[58:59], v[58:59] op_sel:[0,1,0] op_sel_hi:[1,1,0]
    v_pk_fma_f32 v[116:117], v[116:117], v[58:59], v[58:59] op_sel:[0,1,0] op_sel_hi:[1,1,0]
    v_pk_fma_f32 v[118:119], v[118:119], v[58:59], v[58:59] op_sel:[0,1,0] op_sel_hi:[1,1,0]
    v_pk_fma_f32 v[120:121], v[120:121], v[58:59], v[58:59] op_sel:[0,1,0] op_sel_hi:[1,1,0]
    v_pk_fma_f32 v[122:123], v[122:123], v[58:59], v[58:59] op_sel:[0,1,0] op_sel_hi:[1,1,0]
    v_pk_mul_f32 v[104:105], v[104:105], v[64:65]
    v_pk_mul_f32 v[106:107], v[106:107], v[66:67]
    v_pk_mul_f32 v[108:109], v[108:109], v[68:69]
    v_pk_mul_f32 v[110:111], v[110:111], v[70:71]
    v_pk_mul_f32 v[112:113], v[112:113], v[72:73]
    v_pk_mul_f32 v[114:115], v[114:115], v[74:75]
    v_pk_mul_f32 v[116:117], v[116:117], v[76:77]
    v_pk_mul_f32 v[118:119], v[118:119], v[78:79]
    v_pk_mul_f32 v[120:121], v[120:121], v[80:81]
    v_pk_mul_f32 v[122:123], v[122:123], v[82:83]
    v_exp_f32 v104, v104
    v_exp_f32 v105, v105
    v_exp_f32 v106, v106
    v_exp_f32 v107, v107
    v_exp_f32 v108, v108
    v_exp_f32 v109, v109
    v_exp_f32 v110, v110
    v_exp_f32 v111, v111
    v_exp_f32 v112, v112
    v_exp_f32 v113, v113
    v_exp_f32 v114, v114
    v_exp_f32 v115, v115
    v_exp_f32 v116, v116
    v_exp_f32 v117, v117
    v_exp_f32 v118, v118
    v_exp_f32 v119, v119
    v_exp_f32 v120, v120
    v_exp_f32 v121, v121
    v_exp_f32 v122, v122
    v_exp_f32 v123, v123
    v_pk_fma_f32 v[104:105], v[104:105], v[60:61], v[60:61] op_sel_hi:[1,0,0]
    v_pk_fma_f32 v[106:107], v[106:107], v[60:61], v[60:61] op_sel_hi:[1,0,0]
    v_pk_fma_f32 v[108:109], v[108:109], v[60:61], v[60:61] op_sel_hi:[1,0,0]
    v_pk_fma_f32 v[110:111], v[110:111], v[60:61], v[60:61] op_sel_hi:[1,0,0]
    v_pk_fma_f32 v[112:113], v[112:113], v[60:61], v[60:61] op_sel_hi:[1,0,0]
    v_pk_fma_f32 v[114:115], v[114:115], v[60:61], v[60:61] op_sel_hi:[1,0,0]
    v_pk_fma_f32 v[116:117], v[116:117], v[60:61], v[60:61] op_sel_hi:[1,0,0]
    v_pk_fma_f32 v[118:119], v[118:119], v[60:61], v[60:61] op_sel_hi:[1,0,0]
    v_pk_fma_f32 v[120:121], v[120:121], v[60:61], v[60:61] op_sel_hi:[1,0,0]
    v_pk_fma_f32 v[122:123], v[122:123], v[60:61], v[60:61] op_sel_hi:[1,0,0]
    v_rcp_f32 v104, v104
    v_rcp_f32 v105, v105
    v_rcp_f32 v106, v106
    v_rcp_f32 v107, v107
    v_rcp_f32 v108, v108
    v_rcp_f32 v109, v109
    v_rcp_f32 v110, v110
    v_rcp_f32 v111, v111
    v_rcp_f32 v112, v112
    v_rcp_f32 v113, v113
    v_rcp_f32 v114, v114
    v_rcp_f32 v115, v115
    v_rcp_f32 v116, v116
    v_rcp_f32 v117, v117
    v_rcp_f32 v118, v118
    v_rcp_f32 v119, v119
    v_rcp_f32 v120, v120
    v_rcp_f32 v121, v121
    v_rcp_f32 v122, v122
    v_rcp_f32 v123, v123
    v_pk_mul_f32 v[64:65], v[64:65], v[104:105]
    v_pk_mul_f32 v[66:67], v[66:67], v[106:107]
    v_pk_mul_f32 v[68:69], v[68:69], v[108:109]
    v_pk_mul_f32 v[70:71], v[70:71], v[110:111]
    v_pk_mul_f32 v[72:73], v[72:73], v[112:113]
    v_pk_mul_f32 v[74:75], v[74:75], v[114:115]
    v_pk_mul_f32 v[76:77], v[76:77], v[116:117]
    v_pk_mul_f32 v[78:79], v[78:79], v[118:119]
    v_pk_mul_f32 v[80:81], v[80:81], v[120:121]
    v_pk_mul_f32 v[82:83], v[82:83], v[122:123]
    v_cvt_pk_bf16_f32 v84, v64, v65
    v_cvt_pk_bf16_f32 v85, v66, v67
    v_cvt_pk_bf16_f32 v86, v68, v69
    v_cvt_pk_bf16_f32 v87, v70, v71
    v_cvt_pk_bf16_f32 v88, v72, v73
    v_cvt_pk_bf16_f32 v89, v74, v75
    v_cvt_pk_bf16_f32 v90, v76, v77
    v_cvt_pk_bf16_f32 v91, v78, v79
    v_cvt_pk_bf16_f32 v92, v80, v81
    v_cvt_pk_bf16_f32 v93, v82, v83
    s_cmp_lg_u64 s[68:69], 0
    s_cbranch_scc1 L_m_gz
    s_cmp_lg_u32 s60, 0
    s_cbranch_scc1 L_m_pub_g_s
    buffer_store_dwordx4 v[84:87], v36, s[20:23], s37 offen
    buffer_store_dwordx4 v[88:91], v36, s[20:23], s37 offen offset:1024
    buffer_store_dwordx2 v[92:93], v36, s[20:23], s38 offen offset:0
    s_mov_b64 exec, -1
    s_add_u32 s66, s63, 16384
    s_mov_b64 exec, 1
    s_waitcnt vmcnt(0)
    buffer_store_dword v6, off, s[20:23], s66
    s_mov_b64 exec, -1
L_m_pub_g_d:
L_m_gzb:
    v_lshlrev_b32 v64, 16, v20
    v_and_b32 v65, 0xffff0000, v20
    v_lshlrev_b32 v66, 16, v21
    v_and_b32 v67, 0xffff0000, v21
    v_pk_fma_f32 v[64:65], v[64:65], v[62:63], v[62:63] op_sel:[0,0,1] op_sel_hi:[1,0,1]
    v_pk_fma_f32 v[66:67], v[66:67], v[62:63], v[62:63] op_sel:[0,0,1] op_sel_hi:[1,0,1]
    v_lshlrev_b32 v68, 16, v22
    v_and_b32 v69, 0xffff0000, v22
    v_lshlrev_b32 v70, 16, v23
    v_and_b32 v71, 0xffff0000, v23
    v_pk_fma_f32 v[68:69], v[68:69], v[62:63], v[62:63] op_sel:[0,0,1] op_sel_hi:[1,0,1]
    v_pk_fma_f32 v[70:71], v[70:71], v[62:63], v[62:63] op_sel:[0,0,1] op_sel_hi:[1,0,1]
    v_lshlrev_b32 v72, 16, v24
    v_and_b32 v73, 0xffff0000, v24
    v_lshlrev_b32 v74, 16, v25
    v_and_b32 v75, 0xffff0000, v25
    v_pk_fma_f32 v[72:73], v[72:73], v[62:63], v[62:63] op_sel:[0,0,1] op_sel_hi:[1,0,1]
    v_pk_fma_f32 v[74:75], v[74:75], v[62:63], v[62:63] op_sel:[0,0,1] op_sel_hi:[1,0,1]
    v_lshlrev_b32 v76, 16, v26
    v_and_b32 v77, 0xffff0000, v26
    v_lshlrev_b32 v78, 16, v27
    v_and_b32 v79, 0xffff0000, v27
    v_pk_fma_f32 v[76:77], v[76:77], v[62:63], v[62:63] op_sel:[0,0,1] op_sel_hi:[1,0,1]
    v_pk_fma_f32 v[78:79], v[78:79], v[62:63], v[62:63] op_sel:[0,0,1] op_sel_hi:[1,0,1]
    v_lshlrev_b32 v80, 16, v28
    v_and_b32 v81, 0xffff0000, v28
    v_lshlrev_b32 v82, 16, v29
    v_and_b32 v83, 0xffff0000, v29
    v_pk_fma_f32 v[80:81], v[80:81], v[62:63], v[62:63] op_sel:[0,0,1] op_sel_hi:[1,0,1]
    v_pk_fma_f32 v[82:83], v[82:83], v[62:63], v[62:63] op_sel:[0,0,1] op_sel_hi:[1,0,1]
    s_mov_b32 s30, 32546816
    v_add_u32 v39, s51, v30
    v_add_u32 v30, s50, v30
    v_add_u32 v40, s51, v31
    v_add_u32 v31, s50, v31
    v_add_u32 v41, s51, v32
    v_add_u32 v32, s50, v32
    s_mov_b32 s40, 0xccff33
    s_mov_b32 s41, 0
    s_cmp_eq_u32 s26, 0
    s_cselect_b32 s40, 0xccff00, s40
    s_cmp_eq_u32 s26, 3
    s_cselect_b32 s40, 0x00ff33, s40
    s_mov_b32 s58, 400000
    s_mov_b64 exec, s[40:41]
L_m_poll_g:
    buffer_load_dword v17, v37, s[20:23], s30 offen sc1
    s_sub_u32 s58, s58, 1
    s_waitcnt vmcnt(0)
    v_cmp_gt_u32 vcc, 1, v17
    s_cmp_eq_u32 s58, 0
    s_cbranch_scc1 L_m_poll_g_x
    s_cbranch_vccnz L_m_poll_g
L_m_poll_g_x:
    s_mov_b64 exec, -1
    s_add_u32 s30, s46, 0
    buffer_load_dwordx4 v[124:127], v2, s[20:23], s30 offen offset:0 sc1
    buffer_load_dwordx4 v[128:131], v2, s[20:23], s30 offen offset:1024 sc1
    buffer_load_dwordx4 v[132:135], v2, s[20:23], s30 offen offset:2048 sc1
    buffer_load_dwordx4 v[136:139], v2, s[20:23], s30 offen offset:3072 sc1
    s_add_u32 s30, s46, 4096
    buffer_load_dwordx4 v[140:143], v2, s[20:23], s30 offen offset:0 sc1
    s_add_u32 s30, s46, 10240
    buffer_load_dwordx4 v[144:147], v2, s[20:23], s30 offen offset:0 sc1
L_m_nd2:
    ds_read_b128 v[12:15], v7
    s_waitcnt lgkmcnt(0)
    v_min3_u32 v12, v12, v13, v14
    v_min_u32 v12, v12, v15
    s_nop 0
    v_readfirstlane_b32 s66, v12
    s_cmp_lt_u32 s66, 3
    s_cbranch_scc1 L_m_nd2
    ds_read_b128 v[84:87], v31 offset:16384
    ds_read_b128 v[88:91], v31 offset:36864
    ds_read_b128 v[92:95], v31 offset:57344
    ds_read_b128 v[96:99], v30 offset:61440
    ds_read_b128 v[100:103], v30 offset:0
    ds_read_b128 v[104:107], v31 offset:17408
    ds_read_b128 v[108:111], v31 offset:37888
    ds_read_b128 v[112:115], v31 offset:58368
    ds_read_b128 v[116:119], v30 offset:62464
    s_waitcnt vmcnt(5) lgkmcnt(4)
    v_mfma_f32_16x16x32_bf16 v[64:67], v[84:87], v[124:127], v[64:67]
    buffer_load_dwordx4 v[148:151], v2, s[20:23], s30 offen offset:1024 sc1
    ds_read_b128 v[120:123], v30 offset:1024
    v_mfma_f32_16x16x32_bf16 v[68:71], v[88:91], v[124:127], v[68:71]
    ds_read_b128 v[84:87], v31 offset:18432
    v_mfma_f32_16x16x32_bf16 v[72:75], v[92:95], v[124:127], v[72:75]
    ds_read_b128 v[88:91], v31 offset:38912
    v_mfma_f32_16x16x32_bf16 v[76:79], v[96:99], v[124:127], v[76:79]
    ds_read_b128 v[92:95], v31 offset:59392
    v_mfma_f32_16x16x32_bf16 v[80:83], v[100:103], v[124:127], v[80:83]
    ds_read_b128 v[96:99], v30 offset:63488
    s_waitcnt vmcnt(5) lgkmcnt(4)
    v_mfma_f32_16x16x32_bf16 v[64:67], v[104:107], v[128:131], v[64:67]
    buffer_load_dwordx4 v[152:155], v2, s[20:23], s30 offen offset:2048 sc1
    ds_read_b128 v[100:103], v30 offset:2048
    v_mfma_f32_16x16x32_bf16 v[68:71], v[108:111], v[128:131], v[68:71]
    ds_read_b128 v[104:107], v31 offset:19456
    v_mfma_f32_16x16x32_bf16 v[72:75], v[112:115], v[128:131], v[72:75]
    ds_read_b128 v[108:111], v31 offset:39936
    v_mfma_f32_16x16x32_bf16 v[76:79], v[116:119], v[128:131], v[76:79]
    ds_read_b128 v[112:115], v31 offset:60416
    v_mfma_f32_16x16x32_bf16 v[80:83], v[120:123], v[128:131], v[80:83]
    ds_read_b128 v[116:119], v30 offset:64512
    s_waitcnt vmcnt(5) lgkmcnt(4)
    v_mfma_f32_16x16x32_bf16 v[64:67], v[84:87], v[132:135], v[64:67]
    buffer_load_dwordx4 v[156:159], v2, s[20:23], s30 offen offset:3072 sc1
    ds_read_b128 v[120:123], v30 offset:3072
    v_mfma_f32_16x16x32_bf16 v[68:71], v[88:91], v[132:135], v[68:71]
    ds_read_b128 v[84:87], v31 offset:20480
    v_mfma_f32_16x16x32_bf16 v[72:75], v[92:95], v[132:135], v[72:75]
    ds_read_b128 v[88:91], v31 offset:40960
    v_mfma_f32_16x16x32_bf16 v[76:79], v[96:99], v[132:135], v[76:79]
    ds_read_b128 v[92:95], v31 offset:61440
    v_mfma_f32_16x16x32_bf16 v[80:83], v[100:103], v[132:135], v[80:83]
    ds_read_b128 v[96:99], v31 offset:0
    s_waitcnt vmcnt(5) lgkmcnt(4)
    v_mfma_f32_16x16x32_bf16 v[64:67], v[104:107], v[136:139], v[64:67]
    s_add_u32 s30, s46, 14336
    buffer_load_dwordx4 v[160:163], v2, s[20:23], s30 offen offset:0 sc1
    ds_read_b128 v[100:103], v30 offset:4096
    v_mfma_f32_16x16x32_bf16 v[68:71], v[108:111], v[136:139], v[68:71]
    ds_read_b128 v[104:107], v31 offset:26624
    v_mfma_f32_16x16x32_bf16 v[72:75], v[112:115], v[136:139], v[72:75]
    ds_read_b128 v[108:111], v31 offset:47104
    v_mfma_f32_16x16x32_bf16 v[76:79], v[116:119], v[136:139], v[76:79]
    ds_read_b128 v[112:115], v32 offset:2048
    v_mfma_f32_16x16x32_bf16 v[80:83], v[120:123], v[136:139], v[80:83]
    ds_read_b128 v[116:119], v31 offset:6144
    s_waitcnt vmcnt(5) lgkmcnt(4)
    v_mfma_f32_16x16x32_bf16 v[64:67], v[84:87], v[140:143], v[64:67]
    s_bitcmp1_b32 9, s26
    s_cbranch_scc1 L_m_halo
L_m_halob:
    s_add_u32 s30, s47, 0
    buffer_load_dwordx4 v[164:167], v42, s[20:23], s30 offen offset:0 sc1
    ds_read_b128 v[120:123], v30 offset:10240
    v_mfma_f32_16x16x32_bf16 v[68:71], v[88:91], v[140:143], v[68:71]
    ds_read_b128 v[84:87], v31 offset:27648
    v_mfma_f32_16x16x32_bf16 v[72:75], v[92:95], v[140:143], v[72:75]
    ds_read_b128 v[88:91], v31 offset:48128
    v_mfma_f32_16x16x32_bf16 v[76:79], v[96:99], v[140:143], v[76:79]
    ds_read_b128 v[92:95], v32 offset:3072
    v_mfma_f32_16x16x32_bf16 v[80:83], v[100:103], v[140:143], v[80:83]
    ds_read_b128 v[96:99], v31 offset:7168
    s_waitcnt vmcnt(5) lgkmcnt(4)
    v_mfma_f32_16x16x32_bf16 v[64:67], v[104:107], v[144:147], v[64:67]
    buffer_load_dwordx4 v[124:127], v42, s[20:23], s30 offen offset:1024 sc1
    ds_read_b128 v[100:103], v30 offset:11264
    v_mfma_f32_16x16x32_bf16 v[68:71], v[108:111], v[144:147], v[68:71]
    ds_read_b128 v[104:107], v31 offset:28672
    v_mfma_f32_16x16x32_bf16 v[72:75], v[112:115], v[144:147], v[72:75]
    ds_read_b128 v[108:111], v31 offset:49152
    v_mfma_f32_16x16x32_bf16 v[76:79], v[116:119], v[144:147], v[76:79]
    ds_read_b128 v[112:115], v32 offset:4096
    v_mfma_f32_16x16x32_bf16 v[80:83], v[120:123], v[144:147], v[80:83]
    ds_read_b128 v[116:119], v31 offset:8192
    s_waitcnt vmcnt(5) lgkmcnt(4)
    v_mfma_f32_16x16x32_bf16 v[64:67], v[84:87], v[148:151], v[64:67]
    buffer_load_dwordx4 v[128:131], v42, s[20:23], s30 offen offset:2048 sc1
    ds_read_b128 v[120:123], v30 offset:12288
    v_mfma_f32_16x16x32_bf16 v[68:71], v[88:91], v[148:151], v[68:71]
    ds_read_b128 v[84:87], v31 offset:29696
    v_mfma_f32_16x16x32_bf16 v[72:75], v[92:95], v[148:151], v[72:75]
    ds_read_b128 v[88:91], v31 offset:50176
    v_mfma_f32_16x16x32_bf16 v[76:79], v[96:99], v[148:151], v[76:79]
    ds_read_b128 v[92:95], v32 offset:5120
    v_mfma_f32_16x16x32_bf16 v[80:83], v[100:103], v[148:151], v[80:83]
    ds_read_b128 v[96:99], v31 offset:9216
    s_waitcnt vmcnt(5) lgkmcnt(4)
    v_mfma_f32_16x16x32_bf16 v[64:67], v[104:107], v[152:155], v[64:67]
    buffer_load_dwordx4 v[132:135], v42, s[20:23], s30 offen offset:3072 sc1
    ds_read_b128 v[100:103], v30 offset:13312
    v_mfma_f32_16x16x32_bf16 v[68:71], v[108:111], v[152:155], v[68:71]
    ds_read_b128 v[104:107], v31 offset:30720
    v_mfma_f32_16x16x32_bf16 v[72:75], v[112:115], v[152:155], v[72:75]
    ds_read_b128 v[108:111], v31 offset:51200
    v_mfma_f32_16x16x32_bf16 v[76:79], v[116:119], v[152:155], v[76:79]
    ds_read_b128 v[112:115], v32 offset:6144
    v_mfma_f32_16x16x32_bf16 v[80:83], v[120:123], v[152:155], v[80:83]
    ds_read_b128 v[116:119], v31 offset:10240
    s_waitcnt vmcnt(5) lgkmcnt(4)
    v_mfma_f32_16x16x32_bf16 v[64:67], v[84:87], v[156:159], v[64:67]
    s_add_u32 s30, s47, 4096
    buffer_load_dwordx4 v[136:139], v42, s[20:23], s30 offen offset:0 sc1
    ds_read_b128 v[120:123], v30 offset:14336
    v_mfma_f32_16x16x32_bf16 v[68:71], v[88:91], v[156:159], v[68:71]
    ds_read_b128 v[84:87], v40 offset:16384
    v_mfma_f32_16x16x32_bf16 v[72:75], v[92:95], v[156:159], v[72:75]
    ds_read_b128 v[88:91], v40 offset:36864
    v_mfma_f32_16x16x32_bf16 v[76:79], v[96:99], v[156:159], v[76:79]
    ds_read_b128 v[92:95], v40 offset:57344
    v_mfma_f32_16x16x32_bf16 v[80:83], v[100:103], v[156:159], v[80:83]
    ds_read_b128 v[96:99], v39 offset:61440
    s_waitcnt vmcnt(5) lgkmcnt(4)
    v_mfma_f32_16x16x32_bf16 v[64:67], v[104:107], v[160:163], v[64:67]
    s_add_u32 s30, s47, 10240
    buffer_load_dwordx4 v[140:143], v43, s[20:23], s30 offen offset:0 sc1
    ds_read_b128 v[100:103], v39 offset:0
    v_mfma_f32_16x16x32_bf16 v[68:71], v[108:111], v[160:163], v[68:71]
    ds_read_b128 v[104:107], v40 offset:17408
    v_mfma_f32_16x16x32_bf16 v[72:75], v[112:115], v[160:163], v[72:75]
    ds_read_b128 v[108:111], v40 offset:37888
    v_mfma_f32_16x16x32_bf16 v[76:79], v[116:119], v[160:163], v[76:79]
    ds_read_b128 v[112:115], v40 offset:58368
    v_mfma_f32_16x16x32_bf16 v[80:83], v[120:123], v[160:163], v[80:83]
    ds_read_b128 v[116:119], v39 offset:62464
    s_waitcnt vmcnt(5) lgkmcnt(4)
    v_mfma_f32_16x16x32_bf16 v[64:67], v[84:87], v[164:167], v[64:67]
    buffer_load_dwordx4 v[144:147], v43, s[20:23], s30 offen offset:1024 sc1
    ds_read_b128 v[120:123], v39 offset:1024
    v_mfma_f32_16x16x32_bf16 v[68:71], v[88:91], v[164:167], v[68:71]
    ds_read_b128 v[84:87], v40 offset:18432
    v_mfma_f32_16x16x32_bf16 v[72:75], v[92:95], v[164:167], v[72:75]
    ds_read_b128 v[88:91], v40 offset:38912
    v_mfma_f32_16x16x32_bf16 v[76:79], v[96:99], v[164:167], v[76:79]
    ds_read_b128 v[92:95], v40 offset:59392
    v_mfma_f32_16x16x32_bf16 v[80:83], v[100:103], v[164:167], v[80:83]
    ds_read_b128 v[96:99], v39 offset:63488
    s_waitcnt vmcnt(5) lgkmcnt(4)
    v_mfma_f32_16x16x32_bf16 v[64:67], v[104:107], v[124:127], v[64:67]
    buffer_load_dwordx4 v[148:151], v43, s[20:23], s30 offen offset:2048 sc1
    ds_read_b128 v[100:103], v39 offset:2048
    v_mfma_f32_16x16x32_bf16 v[68:71], v[108:111], v[124:127], v[68:71]
    ds_read_b128 v[104:107], v40 offset:19456
    v_mfma_f32_16x16x32_bf16 v[72:75], v[112:115], v[124:127], v[72:75]
    ds_read_b128 v[108:111], v40 offset:39936
    v_mfma_f32_16x16x32_bf16 v[76:79], v[116:119], v[124:127], v[76:79]
    ds_read_b128 v[112:115], v40 offset:60416
    v_mfma_f32_16x16x32_bf16 v[80:83], v[120:123], v[124:127], v[80:83]
    ds_read_b128 v[116:119], v39 offset:64512
    s_waitcnt vmcnt(5) lgkmcnt(4)
    v_mfma_f32_16x16x32_bf16 v[64:67], v[84:87], v[128:131], v[64:67]
    buffer_load_dwordx4 v[152:155], v43, s[20:23], s30 offen offset:3072 sc1
    ds_read_b128 v[120:123], v39 offset:3072
    v_mfma_f32_16x16x32_bf16 v[68:71], v[88:91], v[128:131], v[68:71]
    ds_read_b128 v[84:87], v40 offset:20480
    v_mfma_f32_16x16x32_bf16 v[72:75], v[92:95], v[128:131], v[72:75]
    ds_read_b128 v[88:91], v40 offset:40960
    v_mfma_f32_16x16x32_bf16 v[76:79], v[96:99], v[128:131], v[76:79]
    ds_read_b128 v[92:95], v40 offset:61440
    v_mfma_f32_16x16x32_bf16 v[80:83], v[100:103], v[128:131], v[80:83]
    ds_read_b128 v[96:99], v40 offset:0
    s_waitcnt vmcnt(5) lgkmcnt(4)
    v_mfma_f32_16x16x32_bf16 v[64:67], v[104:107], v[132:135], v[64:67]
    s_add_u32 s30, s47, 14336
    buffer_load_dwordx4 v[156:159], v43, s[20:23], s30 offen offset:0 sc1
    ds_read_b128 v[100:103], v39 offset:4096
    v_mfma_f32_16x16x32_bf16 v[68:71], v[108:111], v[132:135], v[68:71]
    ds_read_b128 v[104:107], v40 offset:26624
    v_mfma_f32_16x16x32_bf16 v[72:75], v[112:115], v[132:135], v[72:75]
    ds_read_b128 v[108:111], v40 offset:47104
    v_mfma_f32_16x16x32_bf16 v[76:79], v[116:119], v[132:135], v[76:79]
    ds_read_b128 v[112:115], v41 offset:2048
    v_mfma_f32_16x16x32_bf16 v[80:83], v[120:123], v[132:135], v[80:83]
    ds_read_b128 v[116:119], v40 offset:6144
    s_waitcnt vmcnt(5) lgkmcnt(4)
    v_mfma_f32_16x16x32_bf16 v[64:67], v[84:87], v[136:139], v[64:67]
    v_mov_b32 v16, 3
    ds_write_b32 v5, v16 offset:80
    ds_read_b128 v[120:123], v39 offset:10240
    v_mfma_f32_16x16x32_bf16 v[68:71], v[88:91], v[136:139], v[68:71]
    ds_read_b128 v[84:87], v40 offset:27648
    v_mfma_f32_16x16x32_bf16 v[72:75], v[92:95], v[136:139], v[72:75]
    ds_read_b128 v[88:91], v40 offset:48128
    v_mfma_f32_16x16x32_bf16 v[76:79], v[96:99], v[136:139], v[76:79]
    ds_read_b128 v[92:95], v41 offset:3072
    v_mfma_f32_16x16x32_bf16 v[80:83], v[100:103], v[136:139], v[80:83]
    ds_read_b128 v[96:99], v40 offset:7168
    s_waitcnt vmcnt(4) lgkmcnt(4)
    v_mfma_f32_16x16x32_bf16 v[64:67], v[104:107], v[140:143], v[64:67]
    ds_read_b128 v[100:103], v39 offset:11264
    v_mfma_f32_16x16x32_bf16 v[68:71], v[108:111], v[140:143], v[68:71]
    ds_read_b128 v[104:107], v40 offset:28672
    v_mfma_f32_16x16x32_bf16 v[72:75], v[112:115], v[140:143], v[72:75]
    ds_read_b128 v[108:111], v40 offset:49152
    v_mfma_f32_16x16x32_bf16 v[76:79], v[116:119], v[140:143], v[76:79]
    ds_read_b128 v[112:115], v41 offset:4096
    v_mfma_f32_16x16x32_bf16 v[80:83], v[120:123], v[140:143], v[80:83]
    ds_read_b128 v[116:119], v40 offset:8192
    s_waitcnt vmcnt(3) lgkmcnt(4)
    v_mfma_f32_16x16x32_bf16 v[64:67], v[84:87], v[144:147], v[64:67]
    ds_read_b128 v[120:123], v39 offset:12288
    v_mfma_f32_16x16x32_bf16 v[68:71], v[88:91], v[144:147], v[68:71]
    ds_read_b128 v[84:87], v40 offset:29696
    v_mfma_f32_16x16x32_bf16 v[72:75], v[92:95], v[144:147], v[72:75]
    ds_read_b128 v[88:91], v40 offset:50176
    v_mfma_f32_16x16x32_bf16 v[76:79], v[96:99], v[144:147], v[76:79]
    ds_read_b128 v[92:95], v41 offset:5120
    v_mfma_f32_16x16x32_bf16 v[80:83], v[100:103], v[144:147], v[80:83]
    ds_read_b128 v[96:99], v40 offset:9216
    s_waitcnt vmcnt(2) lgkmcnt(4)
    v_mfma_f32_16x16x32_bf16 v[64:67], v[104:107], v[148:151], v[64:67]
    ds_read_b128 v[100:103], v39 offset:13312
    v_mfma_f32_16x16x32_bf16 v[68:71], v[108:111], v[148:151], v[68:71]
    ds_read_b128 v[104:107], v40 offset:30720
    v_mfma_f32_16x16x32_bf16 v[72:75], v[112:115], v[148:151], v[72:75]
    ds_read_b128 v[108:111], v40 offset:51200
    v_mfma_f32_16x16x32_bf16 v[76:79], v[116:119], v[148:151], v[76:79]
    ds_read_b128 v[112:115], v41 offset:6144
    v_mfma_f32_16x16x32_bf16 v[80:83], v[120:123], v[148:151], v[80:83]
    ds_read_b128 v[116:119], v40 offset:10240
    s_waitcnt vmcnt(1) lgkmcnt(4)
    v_mfma_f32_16x16x32_bf16 v[64:67], v[84:87], v[152:155], v[64:67]
    ds_read_b128 v[120:123], v39 offset:14336
    v_mfma_f32_16x16x32_bf16 v[68:71], v[88:91], v[152:155], v[68:71]
    v_mfma_f32_16x16x32_bf16 v[72:75], v[92:95], v[152:155], v[72:75]
    v_mfma_f32_16x16x32_bf16 v[76:79], v[96:99], v[152:155], v[76:79]
    v_mfma_f32_16x16x32_bf16 v[80:83], v[100:103], v[152:155], v[80:83]
    s_waitcnt vmcnt(0) lgkmcnt(0)
    v_mfma_f32_16x16x32_bf16 v[64:67], v[104:107], v[156:159], v[64:67]
    v_mfma_f32_16x16x32_bf16 v[68:71], v[108:111], v[156:159], v[68:71]
    v_mfma_f32_16x16x32_bf16 v[72:75], v[112:115], v[156:159], v[72:75]
    v_mfma_f32_16x16x32_bf16 v[76:79], v[116:119], v[156:159], v[76:79]
    v_mfma_f32_16x16x32_bf16 v[80:83], v[120:123], v[156:159], v[80:83]
    v_mov_b32 v16, 30
    ds_write_b32 v5, v16 offset:0
    s_nop 5
    v_cvt_pk_bf16_f32 v44, v64, v65
    v_cvt_pk_bf16_f32 v45, v66, v67
    v_cvt_pk_bf16_f32 v46, v68, v69
    v_cvt_pk_bf16_f32 v47, v70, v71
    v_cvt_pk_bf16_f32 v48, v72, v73
    v_cvt_pk_bf16_f32 v49, v74, v75
    v_cvt_pk_bf16_f32 v50, v76, v77
    v_cvt_pk_bf16_f32 v51, v78, v79
    v_cvt_pk_bf16_f32 v52, v80, v81
    v_cvt_pk_bf16_f32 v53, v82, v83
    s_cmp_lg_u32 s60, 0
    s_cbranch_scc1 L_m_pub_x1_s
    s_add_u32 s31, s36, 8912896
    s_add_u32 s30, s31, s37
    s_add_u32 s31, s31, s38
    buffer_store_dwordx4 v[44:47], v2, s[20:23], s30 offen
    buffer_store_dwordx4 v[48:51], v2, s[20:23], s30 offen offset:1024
    buffer_store_dwordx2 v[52:53], v2, s[20:23], s31 offen offset:0
    v_pk_add_f32 v[12:13], v[64:65], v[66:67]
    v_pk_mul_f32 v[14:15], v[64:65], v[64:65]
    v_pk_fma_f32 v[14:15], v[66:67], v[66:67], v[14:15]
    v_pk_add_f32 v[12:13], v[12:13], v[68:69]
    v_pk_fma_f32 v[14:15], v[68:69], v[68:69], v[14:15]
    v_pk_add_f32 v[12:13], v[12:13], v[70:71]
    v_pk_fma_f32 v[14:15], v[70:71], v[70:71], v[14:15]
    v_pk_add_f32 v[12:13], v[12:13], v[72:73]
    v_pk_fma_f32 v[14:15], v[72:73], v[72:73], v[14:15]
    v_pk_add_f32 v[12:13], v[12:13], v[74:75]
    v_pk_fma_f32 v[14:15], v[74:75], v[74:75], v[14:15]
    v_pk_add_f32 v[12:13], v[12:13], v[76:77]
    v_pk_fma_f32 v[14:15], v[76:77], v[76:77], v[14:15]
    v_pk_add_f32 v[12:13], v[12:13], v[78:79]
    v_pk_fma_f32 v[14:15], v[78:79], v[78:79], v[14:15]
    v_pk_add_f32 v[12:13], v[12:13], v[80:81]
    v_pk_fma_f32 v[14:15], v[80:81], v[80:81], v[14:15]
    v_pk_add_f32 v[12:13], v[12:13], v[82:83]
    v_pk_fma_f32 v[14:15], v[82:83], v[82:83], v[14:15]
    v_add_f32 v12, v12, v13
    v_add_f32 v13, v14, v15
    v_mov_b32 v8, v12
    v_mov_b32 v9, v13
    s_nop 1
    v_permlane16_swap_b32 v12, v8
    v_permlane16_swap_b32 v13, v9
    s_nop 1
    v_add_f32 v12, v12, v8
    v_add_f32 v13, v13, v9
    v_mov_b32 v8, v12
    v_mov_b32 v9, v13
    s_nop 1
    v_permlane32_swap_b32 v12, v8
    v_permlane32_swap_b32 v13, v9
    s_nop 1
    v_add_f32 v12, v12, v8
    v_add_f32 v13, v13, v9
    s_add_u32 s32, s39, 32210944
    s_mov_b64 exec, 0xffff
    buffer_store_dwordx2 v[12:13], v2, s[20:23], s32 offen
    s_mov_b64 exec, -1
    s_add_u32 s66, s63, 32768
    s_mov_b64 exec, 1
    s_waitcnt vmcnt(0)
    buffer_store_dword v6, off, s[20:23], s66
    s_mov_b64 exec, -1
L_m_pub_x1_d:
    v_add_u32 v30, 0, v2
    v_add_u32 v31, 65536, v2
    v_add_u32 v32, 131072, v2
    s_mul_i32 s30, s26, 2560
    s_add_u32 s30, s30, 152064
    v_add_u32 v8, 0, v1
    v_mul_u32_u24 v9, 6554, v8
    v_lshrrev_b32 v9, 16, v9
    v_mul_u32_u24 v9, 1120, v9
    v_lshl_add_u32 v36, v8, 4, v9
    v_add_u32 v8, 64, v1
    v_mul_u32_u24 v9, 6554, v8
    v_lshrrev_b32 v9, 16, v9
    v_mul_u32_u24 v9, 1120, v9
    v_lshl_add_u32 v37, v8, 4, v9
    v_add_u32 v8, 128, v1
    v_mul_u32_u24 v9, 6554, v8
    v_lshrrev_b32 v9, 16, v9
    v_mul_u32_u24 v9, 1120, v9
    v_lshl_add_u32 v62, v8, 4, v9
    v_add_u32 v35, s30, v2
    s_mov_b32 s43, s26
    s_lshl_b32 s30, s24, 9
    s_add_u32 s30, s30, 32563200
    s_mov_b32 s40, -1
    s_mov_b32 s41, 0
    s_mul_i32 s33, s43, 5120
    s_mul_i32 s32, s24, 81920
    s_add_u32 s32, s32, s33
    s_mov_b32 s58, 400000
    s_mov_b64 exec, s[40:41]
L_m_poll_x1_0:
    buffer_load_dword v17, v33, s[20:23], s30 offen sc1
    s_sub_u32 s58, s58, 1
    s_waitcnt vmcnt(0)
    v_cmp_gt_u32 vcc, 1, v17
    s_cmp_eq_u32 s58, 0
    s_cbranch_scc1 L_m_poll_x1_0_x
    s_cbranch_vccnz L_m_poll_x1_0
L_m_poll_x1_0_x:
    s_mov_b64 exec, -1
    s_lshl_b32 s31, s35, 10
    s_add_u32 s31, s31, 32210944
    buffer_load_dwordx4 v[54:57], v2, s[20:23], s31 offen sc1
    s_add_u32 m0, s33, 61440
    s_add_u32 s30, s32, 8912896
    buffer_load_dwordx4 v2, s[20:23], s30 offen offset:0 sc1 lds
    buffer_load_dwordx4 v2, s[20:23], s30 offen offset:1024 sc1 lds
    buffer_load_dwordx4 v2, s[20:23], s30 offen offset:2048 sc1 lds
    buffer_load_dwordx4 v2, s[20:23], s30 offen offset:3072 sc1 lds
    s_add_u32 m0, s33, 65536
    s_add_u32 s30, s32, 8916992
    buffer_load_dwordx4 v2, s[20:23], s30 offen offset:0 sc1 lds
    s_lshl_b32 s31, s43, 6
    s_add_u32 s31, s31, 163392
    v_lshl_add_u32 v8, v3, 4, s31
    ds_read_b128 v[12:15], v8 offset:0
    v_lshlrev_b32 v38, 4, v4
    v_add_u32 v38, 143360, v38
    s_mul_i32 s44, s24, 245760
    s_add_u32 s44, s44, 0
    s_mov_b32 s42, s44
    s_mul_i32 s31, s25, 6144
    s_add_u32 s42, s42, s31
    s_lshr_b32 s31, s43, 1
    s_lshl_b32 s31, s31, 10
    s_and_b32 s30, s43, 1
    s_lshl_b32 s30, s30, 3
    s_add_u32 s31, s31, s30
    s_add_u32 s31, s31, 4096
    s_add_u32 s42, s42, s31
    s_waitcnt vmcnt(5)
    v_add_f32 v54, v54, v56
    v_add_f32 v55, v55, v57
    v_mov_b32 v56, v54
    v_mov_b32 v57, v55
    s_nop 1
    v_permlane16_swap_b32 v54, v56
    v_permlane16_swap_b32 v55, v57
    v_add_f32 v54, v54, v56
    v_add_f32 v55, v55, v57
    v_mov_b32 v56, v54
    v_mov_b32 v57, v55
    s_nop 1
    v_permlane32_swap_b32 v54, v56
    v_permlane32_swap_b32 v55, v57
    v_add_f32 v54, v54, v56
    v_add_f32 v55, v55, v57
    v_mul_f32 v54, 0xbacccccd, v54
    v_mul_f32 v55, 0x3acccccd, v55
    v_fma_f32 v55, -v54, v54, v55
    v_max_f32 v55, 0, v55
    v_add_f32 v56, 0x3727c5ac, v55
    v_rsq_f32 v56, v56
    s_nop 0
    v_rcp_f32 v60, v56
    v_mul_f32 v58, 0xc0135761, v56
    v_mul_f32 v57, v56, v56
    v_mul_f32 v57, v57, v56
    v_mul_f32 v59, 0xbdd2d3e8, v57
    v_mov_b32 v61, v54
    s_lshl_b32 s31, s43, 8
    v_add_u32 v8, s31, v38
    ds_write_b128 v8, v[58:61]
    s_waitcnt vmcnt(0) lgkmcnt(0)
    s_barrier
    s_add_u32 s31, s64, 26169344
    buffer_load_dwordx4 v[208:211], v2, s[20:23], s31 offen offset:0 sc1
    buffer_load_dwordx4 v[212:215], v2, s[20:23], s31 offen offset:1024 sc1
    buffer_load_dwordx4 v[216:219], v2, s[20:23], s31 offen offset:2048 sc1
    buffer_load_dwordx4 v[220:223], v2, s[20:23], s31 offen offset:3072 sc1
    s_add_u32 s31, s64, 26173440
    buffer_load_dwordx4 v[224:227], v2, s[20:23], s31 offen offset:0 sc1
    buffer_load_dwordx4 v[228:231], v2, s[20:23], s31 offen offset:1024 sc1
    buffer_load_dwordx4 v[232:235], v2, s[20:23], s31 offen offset:2048 sc1
    buffer_load_dwordx4 v[236:239], v2, s[20:23], s31 offen offset:3072 sc1
    s_add_u32 s31, s64, 26177536
    buffer_load_dwordx4 v[240:243], v2, s[20:23], s31 offen offset:0 sc1
    buffer_load_dwordx4 v[244:247], v2, s[20:23], s31 offen offset:1024 sc1
    buffer_load_dwordx4 v[248:251], v2, s[20:23], s31 offen offset:2048 sc1
    buffer_load_dwordx4 v[252:255], v2, s[20:23], s31 offen offset:3072 sc1
    s_add_u32 m0, s33, 102400
    s_add_u32 s30, s32, 8953856
    buffer_load_dwordx4 v2, s[20:23], s30 offen offset:0 sc1 lds
    buffer_load_dwordx4 v2, s[20:23], s30 offen offset:1024 sc1 lds
    buffer_load_dwordx4 v2, s[20:23], s30 offen offset:2048 sc1 lds
    buffer_load_dwordx4 v2, s[20:23], s30 offen offset:3072 sc1 lds
    s_add_u32 m0, s33, 106496
    s_add_u32 s30, s32, 8957952
    buffer_load_dwordx4 v2, s[20:23], s30 offen offset:0 sc1 lds
    s_add_u32 m0, s33, 122880
    s_add_u32 s30, s32, 8974336
    buffer_load_dwordx4 v2, s[20:23], s30 offen offset:0 sc1 lds
    buffer_load_dwordx4 v2, s[20:23], s30 offen offset:1024 sc1 lds
    buffer_load_dwordx4 v2, s[20:23], s30 offen offset:2048 sc1 lds
    buffer_load_dwordx4 v2, s[20:23], s30 offen offset:3072 sc1 lds
    s_add_u32 m0, s33, 126976
    s_add_u32 s30, s32, 8978432
    buffer_load_dwordx4 v2, s[20:23], s30 offen offset:0 sc1 lds
    s_mul_i32 s30, s43, 1536
    s_mul_i32 s31, s25, 6144
    s_add_u32 s30, s30, s31
    s_mov_b32 m0, 147456
    s_add_u32 s30, s30, s44
    s_add_u32 s30, s30, 147456
    buffer_load_dwordx4 v2, s[20:23], s30 offen offset:0 sc1 lds
    buffer_load_dwordx4 v2, s[20:23], s30 offen offset:512 sc1 lds
    s_mul_i32 s32, s25, 798720
    s_add_u32 s32, s32, s33
    s_and_b32 s65, s24, 3
    s_mul_i32 s65, s65, 5120
    s_add_u32 s65, s65, s64
    s_waitcnt vmcnt(12)
    ds_read_b128 v[72:75], v30 offset:61440
    ds_read_b128 v[76:79], v30 offset:62464
    ds_read_b128 v[80:83], v30 offset:63488
    ds_read_b128 v[84:87], v30 offset:64512
    ds_read_b128 v[88:91], v31 offset:0
    s_waitcnt lgkmcnt(4)
    v_mfma_f32_16x16x32_bf16 v[64:67], v[176:179], v[72:75], 0
    ds_read_b128 v[92:95], v31 offset:1024
    s_waitcnt lgkmcnt(4)
    v_mfma_f32_16x16x32_bf16 v[64:67], v[180:183], v[76:79], v[64:67]
    ds_read_b128 v[72:75], v31 offset:2048
    s_waitcnt lgkmcnt(4)
    v_mfma_f32_16x16x32_bf16 v[64:67], v[184:187], v[80:83], v[64:67]
    ds_read_b128 v[76:79], v31 offset:3072
    s_waitcnt lgkmcnt(4)
    v_mfma_f32_16x16x32_bf16 v[64:67], v[188:191], v[84:87], v[64:67]
    ds_read_b128 v[80:83], v31 offset:4096
    s_waitcnt lgkmcnt(4)
    v_mfma_f32_16x16x32_bf16 v[64:67], v[192:195], v[88:91], v[64:67]
    ds_read_b128 v[84:87], v31 offset:5120
    s_waitcnt lgkmcnt(4)
    v_mfma_f32_16x16x32_bf16 v[64:67], v[196:199], v[92:95], v[64:67]
    ds_read_b128 v[88:91], v31 offset:6144
    s_waitcnt lgkmcnt(4)
    v_mfma_f32_16x16x32_bf16 v[64:67], v[200:203], v[72:75], v[64:67]
    ds_read_b128 v[92:95], v31 offset:7168
    s_waitcnt lgkmcnt(4)
    v_mfma_f32_16x16x32_bf16 v[64:67], v[204:207], v[76:79], v[64:67]
    ds_read_b128 v[72:75], v31 offset:8192
    s_waitcnt lgkmcnt(4)
    v_mfma_f32_16x16x32_bf16 v[64:67], v[208:211], v[80:83], v[64:67]
    ds_read_b128 v[76:79], v31 offset:9216
    s_waitcnt vmcnt(2) lgkmcnt(0)
    s_barrier
    s_waitcnt lgkmcnt(4)
    v_mfma_f32_16x16x32_bf16 v[64:67], v[212:215], v[84:87], v[64:67]
    ds_read_b128 v[80:83], v31 offset:10240
    s_add_u32 m0, s33, 20480
    s_add_u32 s30, s32, 26243072
    buffer_load_dwordx4 v2, s[20:23], s30 offen offset:0 sc1 lds
    s_waitcnt lgkmcnt(4)
    v_mfma_f32_16x16x32_bf16 v[64:67], v[216:219], v[88:91], v[64:67]
    ds_read_b128 v[84:87], v31 offset:11264
    buffer_load_dwordx4 v2, s[20:23], s30 offen offset:1024 sc1 lds
    s_waitcnt lgkmcnt(4)
    v_mfma_f32_16x16x32_bf16 v[64:67], v[220:223], v[92:95], v[64:67]
    ds_read_b128 v[88:91], v31 offset:12288
    s_waitcnt lgkmcnt(4)
    v_mfma_f32_16x16x32_bf16 v[64:67], v[224:227], v[72:75], v[64:67]
    ds_read_b128 v[92:95], v31 offset:13312
    ds_read_b128 v[54:57], v38 offset:0
    buffer_load_dwordx4 v2, s[20:23], s30 offen offset:2048 sc1 lds
    s_waitcnt lgkmcnt(5)
    v_mfma_f32_16x16x32_bf16 v[64:67], v[228:231], v[76:79], v[64:67]
    ds_read_b128 v[72:75], v31 offset:14336
    buffer_load_dwordx4 v2, s[20:23], s30 offen offset:3072 sc1 lds
    s_waitcnt lgkmcnt(5)
    v_mfma_f32_16x16x32_bf16 v[64:67], v[232:235], v[80:83], v[64:67]
    ds_read_b128 v[76:79], v31 offset:15360
    s_waitcnt lgkmcnt(5)
    v_mfma_f32_16x16x32_bf16 v[64:67], v[236:239], v[84:87], v[64:67]
    ds_read_b128 v[80:83], v31 offset:16384
    s_add_u32 m0, s33, 24576
    s_add_u32 s30, s32, 26247168
    buffer_load_dwordx4 v2, s[20:23], s30 offen offset:0 sc1 lds
    s_waitcnt lgkmcnt(5)
    v_mfma_f32_16x16x32_bf16 v[64:67], v[240:243], v[88:91], v[64:67]
    ds_read_b128 v[84:87], v31 offset:17408
    s_add_u32 m0, s33, 40960
    s_add_u32 s30, s32, 26263552
    buffer_load_dwordx4 v2, s[20:23], s30 offen offset:0 sc1 lds
    s_waitcnt lgkmcnt(5)
    v_mfma_f32_16x16x32_bf16 v[64:67], v[244:247], v[92:95], v[64:67]
    ds_read_b128 v[88:91], v31 offset:18432
    s_waitcnt lgkmcnt(4)
    v_mfma_f32_16x16x32_bf16 v[64:67], v[248:251], v[72:75], v[64:67]
    ds_read_b128 v[92:95], v31 offset:19456
    buffer_load_dwordx4 v2, s[20:23], s30 offen offset:1024 sc1 lds
    s_waitcnt lgkmcnt(4)
    v_mfma_f32_16x16x32_bf16 v[64:67], v[252:255], v[76:79], v[64:67]
    ds_read_b128 v[72:75], v31 offset:20480
    buffer_load_dwordx4 v2, s[20:23], s30 offen offset:2048 sc1 lds
    s_waitcnt lgkmcnt(4)
    v_mfma_f32_16x16x32_bf16 v[68:71], v[176:179], v[80:83], 0
    ds_read_b128 v[76:79], v31 offset:21504
    s_waitcnt lgkmcnt(4)
    v_mfma_f32_16x16x32_bf16 v[68:71], v[180:183], v[84:87], v[68:71]
    ds_read_b128 v[80:83], v31 offset:22528
    buffer_load_dwordx4 v2, s[20:23], s30 offen offset:3072 sc1 lds
    s_waitcnt lgkmcnt(4)
    v_mfma_f32_16x16x32_bf16 v[68:71], v[184:187], v[88:91], v[68:71]
    ds_read_b128 v[84:87], v31 offset:23552
    s_add_u32 m0, s33, 45056
    s_add_u32 s30, s32, 26267648
    buffer_load_dwordx4 v2, s[20:23], s30 offen offset:0 sc1 lds
    s_waitcnt lgkmcnt(4)
    v_mfma_f32_16x16x32_bf16 v[68:71], v[188:191], v[92:95], v[68:71]
    ds_read_b128 v[88:91], v31 offset:24576
    s_waitcnt lgkmcnt(4)
    v_mfma_f32_16x16x32_bf16 v[68:71], v[192:195], v[72:75], v[68:71]
    ds_read_b128 v[92:95], v31 offset:25600
    s_setprio 0
    v_fma_f32 v64, v12, v57, v64
    v_fma_f32 v65, v13, v57, v65
    v_fma_f32 v66, v14, v57, v66
    v_fma_f32 v67, v15, v57, v67
    v_mul_f32 v8, v64, v64
    v_mul_f32 v9, v65, v65
    v_mul_f32 v10, v66, v66
    v_mul_f32 v11, v67, v67
    v_fma_f32 v8, v8, v55, v54
    v_fma_f32 v9, v9, v55, v54
    v_fma_f32 v10, v10, v55, v54
    v_fma_f32 v11, v11, v55, v54
    v_mul_f32 v8, v8, v64
    v_mul_f32 v9, v9, v65
    v_mul_f32 v10, v10, v66
    v_mul_f32 v11, v11, v67
    v_exp_f32 v8, v8
    v_exp_f32 v9, v9
    v_exp_f32 v10, v10
    v_exp_f32 v11, v11
    v_fma_f32 v8, v8, v56, v56
    v_fma_f32 v9, v9, v56, v56
    v_fma_f32 v10, v10, v56, v56
    v_fma_f32 v11, v11, v56, v56
    v_rcp_f32 v8, v8
    v_rcp_f32 v9, v9
    v_rcp_f32 v10, v10
    v_rcp_f32 v11, v11
    v_mul_f32 v64, v64, v8
    v_mul_f32 v65, v65, v9
    v_mul_f32 v66, v66, v10
    v_mul_f32 v67, v67, v11
    v_cvt_pk_bf16_f32 v18, v64, v65
    v_cvt_pk_bf16_f32 v19, v66, v67
    s_cmp_lg_u32 s60, 0
    s_cbranch_scc1 L_m_pub_u0_0_s
    buffer_store_dwordx2 v[18:19], v2, s[20:23], s42 offen
L_m_pub_u0_0_d:
    s_add_u32 s42, s42, 49152
    s_setprio 2
    s_add_u32 m0, s33, 0
    s_add_u32 s30, s32, 26284032
    buffer_load_dwordx4 v2, s[20:23], s30 offen offset:0 sc1 lds
    s_waitcnt lgkmcnt(4)
    v_mfma_f32_16x16x32_bf16 v[68:71], v[196:199], v[76:79], v[68:71]
    ds_read_b128 v[72:75], v31 offset:26624
    buffer_load_dwordx4 v2, s[20:23], s30 offen offset:1024 sc1 lds
    s_waitcnt lgkmcnt(4)
    v_mfma_f32_16x16x32_bf16 v[68:71], v[200:203], v[80:83], v[68:71]
    ds_read_b128 v[76:79], v31 offset:27648
    s_waitcnt lgkmcnt(4)
    v_mfma_f32_16x16x32_bf16 v[68:71], v[204:207], v[84:87], v[68:71]
    ds_read_b128 v[80:83], v31 offset:28672
    buffer_load_dwordx4 v2, s[20:23], s30 offen offset:2048 sc1 lds
    s_waitcnt lgkmcnt(4)
    v_mfma_f32_16x16x32_bf16 v[68:71], v[208:211], v[88:91], v[68:71]
    ds_read_b128 v[84:87], v31 offset:29696
    buffer_load_dwordx4 v2, s[20:23], s30 offen offset:3072 sc1 lds
    s_waitcnt lgkmcnt(4)
    v_mfma_f32_16x16x32_bf16 v[68:71], v[212:215], v[92:95], v[68:71]
    ds_read_b128 v[88:91], v31 offset:30720
    s_waitcnt lgkmcnt(4)
    v_mfma_f32_16x16x32_bf16 v[68:71], v[216:219], v[72:75], v[68:71]
    ds_read_b128 v[92:95], v31 offset:31744
    s_add_u32 m0, s33, 4096
    s_add_u32 s30, s32, 26288128
    buffer_load_dwordx4 v2, s[20:23], s30 offen offset:0 sc1 lds
    s_waitcnt lgkmcnt(4)
    v_mfma_f32_16x16x32_bf16 v[68:71], v[220:223], v[76:79], v[68:71]
    ds_read_b128 v[72:75], v31 offset:32768
    s_add_u32 s30, s64, 26304512
    buffer_load_dwordx4 v[96:99], v2, s[20:23], s30 offen offset:0 sc1
    s_waitcnt lgkmcnt(4)
    v_mfma_f32_16x16x32_bf16 v[68:71], v[224:227], v[80:83], v[68:71]
    ds_read_b128 v[76:79], v31 offset:33792
    ds_read_b128 v[54:57], v38 offset:256
    s_waitcnt lgkmcnt(5)
    v_mfma_f32_16x16x32_bf16 v[68:71], v[228:231], v[84:87], v[68:71]
    ds_read_b128 v[80:83], v31 offset:34816
    buffer_load_dwordx4 v[100:103], v2, s[20:23], s30 offen offset:1024 sc1
    s_waitcnt lgkmcnt(5)
    v_mfma_f32_16x16x32_bf16 v[68:71], v[232:235], v[88:91], v[68:71]
    ds_read_b128 v[84:87], v31 offset:35840
    buffer_load_dwordx4 v[104:107], v2, s[20:23], s30 offen offset:2048 sc1
    s_waitcnt lgkmcnt(5)
    v_mfma_f32_16x16x32_bf16 v[68:71], v[236:239], v[92:95], v[68:71]
    ds_read_b128 v[88:91], v31 offset:36864
    s_waitcnt lgkmcnt(5)
    v_mfma_f32_16x16x32_bf16 v[68:71], v[240:243], v[72:75], v[68:71]
    ds_read_b128 v[92:95], v31 offset:37888
    buffer_load_dwordx4 v[108:111], v2, s[20:23], s30 offen offset:3072 sc1
    s_waitcnt lgkmcnt(5)
    v_mfma_f32_16x16x32_bf16 v[68:71], v[244:247], v[76:79], v[68:71]
    ds_read_b128 v[72:75], v31 offset:38912
    s_add_u32 s30, s64, 26308608
    buffer_load_dwordx4 v[112:115], v2, s[20:23], s30 offen offset:0 sc1
    s_waitcnt lgkmcnt(4)
    v_mfma_f32_16x16x32_bf16 v[68:71], v[248:251], v[80:83], v[68:71]
    ds_read_b128 v[76:79], v31 offset:39936
    s_waitcnt lgkmcnt(4)
    v_mfma_f32_16x16x32_bf16 v[68:71], v[252:255], v[84:87], v[68:71]
    ds_read_b128 v[80:83], v31 offset:40960
    buffer_load_dwordx4 v[116:119], v2, s[20:23], s30 offen offset:1024 sc1
    s_waitcnt lgkmcnt(4)
    v_mfma_f32_16x16x32_bf16 v[64:67], v[176:179], v[88:91], 0
    ds_read_b128 v[84:87], v31 offset:41984
    buffer_load_dwordx4 v[120:123], v2, s[20:23], s30 offen offset:2048 sc1
    s_waitcnt lgkmcnt(4)
    v_mfma_f32_16x16x32_bf16 v[64:67], v[180:183], v[92:95], v[64:67]
    ds_read_b128 v[88:91], v31 offset:43008
    s_waitcnt lgkmcnt(4)
    v_mfma_f32_16x16x32_bf16 v[64:67], v[184:187], v[72:75], v[64:67]
    ds_read_b128 v[92:95], v31 offset:44032
    buffer_load_dwordx4 v[124:127], v2, s[20:23], s30 offen offset:3072 sc1
    s_waitcnt lgkmcnt(4)
    v_mfma_f32_16x16x32_bf16 v[64:67], v[188:191], v[76:79], v[64:67]
    ds_read_b128 v[72:75], v31 offset:45056
    s_add_u32 s30, s64, 26312704
    buffer_load_dwordx4 v[128:131], v2, s[20:23], s30 offen offset:0 sc1
    s_waitcnt lgkmcnt(4)
    v_mfma_f32_16x16x32_bf16 v[64:67], v[192:195], v[80:83], v[64:67]
    ds_read_b128 v[76:79], v31 offset:46080
    s_setprio 0
    v_fma_f32 v68, v12, v57, v68
    v_fma_f32 v69, v13, v57, v69
    v_fma_f32 v70, v14, v57, v70
    v_fma_f32 v71, v15, v57, v71
    v_mul_f32 v8, v68, v68
    v_mul_f32 v9, v69, v69
    v_mul_f32 v10, v70, v70
    v_mul_f32 v11, v71, v71
    v_fma_f32 v8, v8, v55, v54
    v_fma_f32 v9, v9, v55, v54
    v_fma_f32 v10, v10, v55, v54
    v_fma_f32 v11, v11, v55, v54
    v_mul_f32 v8, v8, v68
    v_mul_f32 v9, v9, v69
    v_mul_f32 v10, v10, v70
    v_mul_f32 v11, v11, v71
    v_exp_f32 v8, v8
    v_exp_f32 v9, v9
    v_exp_f32 v10, v10
    v_exp_f32 v11, v11
    v_fma_f32 v8, v8, v56, v56
    v_fma_f32 v9, v9, v56, v56
    v_fma_f32 v10, v10, v56, v56
    v_fma_f32 v11, v11, v56, v56
    v_rcp_f32 v8, v8
    v_rcp_f32 v9, v9
    v_rcp_f32 v10, v10
    v_rcp_f32 v11, v11
    v_mul_f32 v68, v68, v8
    v_mul_f32 v69, v69, v9
    v_mul_f32 v70, v70, v10
    v_mul_f32 v71, v71, v11
    v_cvt_pk_bf16_f32 v18, v68, v69
    v_cvt_pk_bf16_f32 v19, v70, v71
    s_cmp_lg_u32 s60, 0
    s_cbranch_scc1 L_m_pub_u0_1_s
    buffer_store_dwordx2 v[18:19], v2, s[20:23], s42 offen
L_m_pub_u0_1_d:
    s_add_u32 s42, s42, 49152
    s_setprio 2
    s_waitcnt lgkmcnt(4)
    v_mfma_f32_16x16x32_bf16 v[64:67], v[196:199], v[84:87], v[64:67]
    ds_read_b128 v[80:83], v31 offset:47104
    buffer_load_dwordx4 v[132:135], v2, s[20:23], s30 offen offset:1024 sc1
    s_waitcnt lgkmcnt(4)
    v_mfma_f32_16x16x32_bf16 v[64:67], v[200:203], v[88:91], v[64:67]
    ds_read_b128 v[84:87], v31 offset:48128
    buffer_load_dwordx4 v[136:139], v2, s[20:23], s30 offen offset:2048 sc1
    s_waitcnt lgkmcnt(4)
    v_mfma_f32_16x16x32_bf16 v[64:67], v[204:207], v[92:95], v[64:67]
    ds_read_b128 v[88:91], v31 offset:49152
    s_waitcnt lgkmcnt(4)
    v_mfma_f32_16x16x32_bf16 v[64:67], v[208:211], v[72:75], v[64:67]
    ds_read_b128 v[92:95], v31 offset:50176
    buffer_load_dwordx4 v[140:143], v2, s[20:23], s30 offen offset:3072 sc1
    s_waitcnt lgkmcnt(4)
    v_mfma_f32_16x16x32_bf16 v[64:67], v[212:215], v[76:79], v[64:67]
    ds_read_b128 v[72:75], v31 offset:51200
    s_add_u32 s30, s64, 26316800
    buffer_load_dwordx4 v[144:147], v2, s[20:23], s30 offen offset:0 sc1
    s_waitcnt lgkmcnt(4)
    v_mfma_f32_16x16x32_bf16 v[64:67], v[216:219], v[80:83], v[64:67]
    ds_read_b128 v[76:79], v31 offset:52224
    s_waitcnt lgkmcnt(4)
    v_mfma_f32_16x16x32_bf16 v[64:67], v[220:223], v[84:87], v[64:67]
    ds_read_b128 v[80:83], v31 offset:53248
    buffer_load_dwordx4 v[148:151], v2, s[20:23], s30 offen offset:1024 sc1
    s_waitcnt lgkmcnt(4)
    v_mfma_f32_16x16x32_bf16 v[64:67], v[224:227], v[88:91], v[64:67]
    ds_read_b128 v[84:87], v31 offset:54272
    ds_read_b128 v[54:57], v38 offset:512
    buffer_load_dwordx4 v[152:155], v2, s[20:23], s30 offen offset:2048 sc1
    s_waitcnt lgkmcnt(5)
    v_mfma_f32_16x16x32_bf16 v[64:67], v[228:231], v[92:95], v[64:67]
    ds_read_b128 v[88:91], v31 offset:55296
    s_waitcnt lgkmcnt(5)
    v_mfma_f32_16x16x32_bf16 v[64:67], v[232:235], v[72:75], v[64:67]
    ds_read_b128 v[92:95], v31 offset:56320
    buffer_load_dwordx4 v[156:159], v2, s[20:23], s30 offen offset:3072 sc1
    s_waitcnt lgkmcnt(5)
    v_mfma_f32_16x16x32_bf16 v[64:67], v[236:239], v[76:79], v[64:67]
    ds_read_b128 v[72:75], v31 offset:57344
    s_add_u32 s30, s64, 26320896
    buffer_load_dwordx4 v[160:163], v2, s[20:23], s30 offen offset:0 sc1
    s_waitcnt lgkmcnt(5)
    v_mfma_f32_16x16x32_bf16 v[64:67], v[240:243], v[80:83], v[64:67]
    ds_read_b128 v[76:79], v31 offset:58368
    s_waitcnt lgkmcnt(5)
    v_mfma_f32_16x16x32_bf16 v[64:67], v[244:247], v[84:87], v[64:67]
    ds_read_b128 v[80:83], v31 offset:59392
    buffer_load_dwordx4 v[164:167], v2, s[20:23], s30 offen offset:1024 sc1
    s_waitcnt lgkmcnt(4)
    v_mfma_f32_16x16x32_bf16 v[64:67], v[248:251], v[88:91], v[64:67]
    ds_read_b128 v[84:87], v31 offset:60416
    buffer_load_dwordx4 v[168:171], v2, s[20:23], s30 offen offset:2048 sc1
    s_waitcnt lgkmcnt(4)
    v_mfma_f32_16x16x32_bf16 v[64:67], v[252:255], v[92:95], v[64:67]
    ds_read_b128 v[88:91], v31 offset:61440
    s_waitcnt lgkmcnt(4)
    v_mfma_f32_16x16x32_bf16 v[68:71], v[176:179], v[72:75], 0
    ds_read_b128 v[92:95], v31 offset:62464
    buffer_load_dwordx4 v[172:175], v2, s[20:23], s30 offen offset:3072 sc1
    s_waitcnt lgkmcnt(4)
    v_mfma_f32_16x16x32_bf16 v[68:71], v[180:183], v[76:79], v[68:71]
    ds_read_b128 v[72:75], v31 offset:63488
    s_waitcnt lgkmcnt(4)
    v_mfma_f32_16x16x32_bf16 v[68:71], v[184:187], v[80:83], v[68:71]
    ds_read_b128 v[76:79], v31 offset:64512
    s_waitcnt lgkmcnt(4)
    v_mfma_f32_16x16x32_bf16 v[68:71], v[188:191], v[84:87], v[68:71]
    ds_read_b128 v[80:83], v32 offset:0
    s_waitcnt lgkmcnt(4)
    v_mfma_f32_16x16x32_bf16 v[68:71], v[192:195], v[88:91], v[68:71]
    ds_read_b128 v[84:87], v32 offset:1024
    s_setprio 0
    v_fma_f32 v64, v12, v57, v64
    v_fma_f32 v65, v13, v57, v65
    v_fma_f32 v66, v14, v57, v66
    v_fma_f32 v67, v15, v57, v67
    v_mul_f32 v8, v64, v64
    v_mul_f32 v9, v65, v65
    v_mul_f32 v10, v66, v66
    v_mul_f32 v11, v67, v67
    v_fma_f32 v8, v8, v55, v54
    v_fma_f32 v9, v9, v55, v54
    v_fma_f32 v10, v10, v55, v54
    v_fma_f32 v11, v11, v55, v54
    v_mul_f32 v8, v8, v64
    v_mul_f32 v9, v9, v65
    v_mul_f32 v10, v10, v66
    v_mul_f32 v11, v11, v67
    v_exp_f32 v8, v8
    v_exp_f32 v9, v9
    v_exp_f32 v10, v10
    v_exp_f32 v11, v11
    v_fma_f32 v8, v8, v56, v56
    v_fma_f32 v9, v9, v56, v56
    v_fma_f32 v10, v10, v56, v56
    v_fma_f32 v11, v11, v56, v56
    v_rcp_f32 v8, v8
    v_rcp_f32 v9, v9
    v_rcp_f32 v10, v10
    v_rcp_f32 v11, v11
    v_mul_f32 v64, v64, v8
    v_mul_f32 v65, v65, v9
    v_mul_f32 v66, v66, v10
    v_mul_f32 v67, v67, v11
    v_cvt_pk_bf16_f32 v18, v64, v65
    v_cvt_pk_bf16_f32 v19, v66, v67
    s_cmp_lg_u32 s60, 0
    s_cbranch_scc1 L_m_pub_u0_2_s
    buffer_store_dwordx2 v[18:19], v2, s[20:23], s42 offen
L_m_pub_u0_2_d:
    s_add_u32 s42, s42, 49152
    s_setprio 2
    s_waitcnt lgkmcnt(4)
    v_mfma_f32_16x16x32_bf16 v[68:71], v[196:199], v[92:95], v[68:71]
    ds_read_b128 v[88:91], v32 offset:2048
    s_waitcnt lgkmcnt(4)
    v_mfma_f32_16x16x32_bf16 v[68:71], v[200:203], v[72:75], v[68:71]
    ds_read_b128 v[92:95], v32 offset:3072
    s_waitcnt lgkmcnt(4)
    v_mfma_f32_16x16x32_bf16 v[68:71], v[204:207], v[76:79], v[68:71]
    ds_read_b128 v[72:75], v32 offset:4096
    s_waitcnt lgkmcnt(4)
    v_mfma_f32_16x16x32_bf16 v[68:71], v[208:211], v[80:83], v[68:71]
    ds_read_b128 v[76:79], v32 offset:5120
    s_waitcnt lgkmcnt(4)
    v_mfma_f32_16x16x32_bf16 v[68:71], v[212:215], v[84:87], v[68:71]
    ds_read_b128 v[80:83], v32 offset:6144
    s_waitcnt lgkmcnt(4)
    v_mfma_f32_16x16x32_bf16 v[68:71], v[216:219], v[88:91], v[68:71]
    ds_read_b128 v[84:87], v32 offset:7168
    ds_read_b128 v[54:57], v38 offset:768
    s_waitcnt lgkmcnt(5)
    v_mfma_f32_16x16x32_bf16 v[68:71], v[220:223], v[92:95], v[68:71]
    ds_read_b128 v[88:91], v32 offset:8192
    s_waitcnt lgkmcnt(5)
    v_mfma_f32_16x16x32_bf16 v[68:71], v[224:227], v[72:75], v[68:71]
    ds_read_b128 v[92:95], v32 offset:9216
    s_waitcnt lgkmcnt(5)
    v_mfma_f32_16x16x32_bf16 v[68:71], v[228:231], v[76:79], v[68:71]
    ds_read_b128 v[72:75], v32 offset:10240
    s_waitcnt lgkmcnt(5)
    v_mfma_f32_16x16x32_bf16 v[68:71], v[232:235], v[80:83], v[68:71]
    ds_read_b128 v[76:79], v32 offset:11264
    s_waitcnt lgkmcnt(5)
    v_mfma_f32_16x16x32_bf16 v[68:71], v[236:239], v[84:87], v[68:71]
    s_waitcnt lgkmcnt(3)
    v_mfma_f32_16x16x32_bf16 v[68:71], v[240:243], v[88:91], v[68:71]
    s_waitcnt lgkmcnt(2)
    v_mfma_f32_16x16x32_bf16 v[68:71], v[244:247], v[92:95], v[68:71]
    s_waitcnt lgkmcnt(1)
    v_mfma_f32_16x16x32_bf16 v[68:71], v[248:251], v[72:75], v[68:71]
    s_waitcnt lgkmcnt(0)
    v_mfma_f32_16x16x32_bf16 v[68:71], v[252:255], v[76:79], v[68:71]
    s_waitcnt lgkmcnt(0)
    s_nop 6
    s_setprio 0
    v_fma_f32 v68, v12, v57, v68
    v_fma_f32 v69, v13, v57, v69
    v_fma_f32 v70, v14, v57, v70
    v_fma_f32 v71, v15, v57, v71
    v_mul_f32 v8, v68, v68
    v_mul_f32 v9, v69, v69
    v_mul_f32 v10, v70, v70
    v_mul_f32 v11, v71, v71
    v_fma_f32 v8, v8, v55, v54
    v_fma_f32 v9, v9, v55, v54
    v_fma_f32 v10, v10, v55, v54
    v_fma_f32 v11, v11, v55, v54
    v_mul_f32 v8, v8, v68
    v_mul_f32 v9, v9, v69
    v_mul_f32 v10, v10, v70
    v_mul_f32 v11, v11, v71
    v_exp_f32 v8, v8
    v_exp_f32 v9, v9
    v_exp_f32 v10, v10
    v_exp_f32 v11, v11
    v_fma_f32 v8, v8, v56, v56
    v_fma_f32 v9, v9, v56, v56
    v_fma_f32 v10, v10, v56, v56
    v_fma_f32 v11, v11, v56, v56
    v_rcp_f32 v8, v8
    v_rcp_f32 v9, v9
    v_rcp_f32 v10, v10
    v_rcp_f32 v11, v11
    v_mul_f32 v68, v68, v8
    v_mul_f32 v69, v69, v9
    v_mul_f32 v70, v70, v10
    v_mul_f32 v71, v71, v11
    v_cvt_pk_bf16_f32 v18, v68, v69
    v_cvt_pk_bf16_f32 v19, v70, v71
    s_cmp_lg_u32 s60, 0
    s_cbranch_scc1 L_m_pub_u0_3_s
    buffer_store_dwordx2 v[18:19], v2, s[20:23], s42 offen
L_m_pub_u0_3_d:
    s_add_u32 s42, s42, 49152
    s_setprio 2
    v_lshlrev_b32 v64, 16, v20
    v_and_b32 v65, 0xffff0000, v20
    v_lshlrev_b32 v66, 16, v21
    v_and_b32 v67, 0xffff0000, v21
    v_lshlrev_b32 v8, 16, v44
    v_and_b32 v9, 0xffff0000, v44
    v_lshlrev_b32 v10, 16, v45
    v_and_b32 v11, 0xffff0000, v45
    v_add_f32 v64, v64, v8
    v_add_f32 v65, v65, v9
    v_add_f32 v66, v66, v10
    v_add_f32 v67, v67, v11
    v_lshlrev_b32 v68, 16, v22
    v_and_b32 v69, 0xffff0000, v22
    v_lshlrev_b32 v70, 16, v23
    v_and_b32 v71, 0xffff0000, v23
    v_lshlrev_b32 v8, 16, v46
    v_and_b32 v9, 0xffff0000, v46
    v_lshlrev_b32 v10, 16, v47
    v_and_b32 v11, 0xffff0000, v47
    v_add_f32 v68, v68, v8
    v_add_f32 v69, v69, v9
    v_add_f32 v70, v70, v10
    v_add_f32 v71, v71, v11
    v_lshlrev_b32 v72, 16, v24
    v_and_b32 v73, 0xffff0000, v24
    v_lshlrev_b32 v74, 16, v25
    v_and_b32 v75, 0xffff0000, v25
    v_lshlrev_b32 v8, 16, v48
    v_and_b32 v9, 0xffff0000, v48
    v_lshlrev_b32 v10, 16, v49
    v_and_b32 v11, 0xffff0000, v49
    v_add_f32 v72, v72, v8
    v_add_f32 v73, v73, v9
    v_add_f32 v74, v74, v10
    v_add_f32 v75, v75, v11
    v_lshlrev_b32 v76, 16, v26
    v_and_b32 v77, 0xffff0000, v26
    v_lshlrev_b32 v78, 16, v27
    v_and_b32 v79, 0xffff0000, v27
    v_lshlrev_b32 v8, 16, v50
    v_and_b32 v9, 0xffff0000, v50
    v_lshlrev_b32 v10, 16, v51
    v_and_b32 v11, 0xffff0000, v51
    v_add_f32 v76, v76, v8
    v_add_f32 v77, v77, v9
    v_add_f32 v78, v78, v10
    v_add_f32 v79, v79, v11
    v_lshlrev_b32 v80, 16, v28
    v_and_b32 v81, 0xffff0000, v28
    v_lshlrev_b32 v82, 16, v29
    v_and_b32 v83, 0xffff0000, v29
    v_lshlrev_b32 v8, 16, v52
    v_and_b32 v9, 0xffff0000, v52
    v_lshlrev_b32 v10, 16, v53
    v_and_b32 v11, 0xffff0000, v53
    v_add_f32 v80, v80, v8
    v_add_f32 v81, v81, v9
    v_add_f32 v82, v82, v10
    v_add_f32 v83, v83, v11
    s_waitcnt vmcnt(0)
    s_barrier
    s_cmp_lg_u32 s26, 0
    s_cbranch_scc1 L_m_nouf
    v_lshlrev_b32 v8, 7, v1
    s_add_u32 s66, s63, 49152
    s_mov_b64 exec, 15
    s_cmp_lg_u32 s60, 0
    s_cbranch_scc1 L_m_pub_uf_s
    buffer_store_dword v6, v8, s[20:23], s66 offen
L_m_pub_uf_d:
    s_mov_b64 exec, -1
L_m_nouf:
    s_mul_i32 s30, s26, 20480
    s_add_u32 s30, s30, 61440
    v_add_u32 v9, s30, v2
    ds_write_b128 v9, v[96:99] offset:0
    ds_write_b128 v9, v[100:103] offset:1024
    ds_write_b128 v9, v[104:107] offset:2048
    ds_write_b128 v9, v[108:111] offset:3072
    ds_write_b128 v9, v[112:115] offset:4096
    ds_write_b128 v9, v[116:119] offset:5120
    ds_write_b128 v9, v[120:123] offset:6144
    ds_write_b128 v9, v[124:127] offset:7168
    ds_write_b128 v9, v[128:131] offset:8192
    ds_write_b128 v9, v[132:135] offset:9216
    ds_write_b128 v9, v[136:139] offset:10240
    ds_write_b128 v9, v[140:143] offset:11264
    ds_write_b128 v9, v[144:147] offset:12288
    ds_write_b128 v9, v[148:151] offset:13312
    ds_write_b128 v9, v[152:155] offset:14336
    ds_write_b128 v9, v[156:159] offset:15360
    ds_write_b128 v9, v[160:163] offset:16384
    ds_write_b128 v9, v[164:167] offset:17408
    ds_write_b128 v9, v[168:171] offset:18432
    ds_write_b128 v9, v[172:175] offset:19456
    s_mul_i32 s31, s35, 20480
    s_mul_i32 s32, s25, 160
    s_add_u32 s42, s31, s32
    s_setprio 2
    v_add_u32 v30, 0, v2
    v_add_u32 v31, 65536, v2
    v_add_u32 v32, 131072, v2
    s_lshl_b32 s35, s24, 2
    s_add_u32 s35, s35, s43
    s_mul_i32 s36, s43, 49152
    s_add_u32 s36, s36, s44
    s_mul_i32 s32, s25, 798720
    s_add_u32 s32, s32, s33
    s_lshl_b32 s30, s35, 7
    s_add_u32 s30, s30, 32579584
    s_mov_b32 s58, 400000
    s_mov_b64 exec, 0xff
L_m_poll_u_0:
    buffer_load_dword v17, v33, s[20:23], s30 offen sc1
    s_sub_u32 s58, s58, 1
    s_waitcnt vmcnt(0)
    v_cmp_gt_u32 vcc, 1, v17
    s_cmp_eq_u32 s58, 0
    s_cbranch_scc1 L_m_poll_u_0_x
    s_cbranch_vccnz L_m_poll_u_0
L_m_poll_u_0_x:
    s_mov_b64 exec, -1
    s_add_u32 s31, s36, 4096
    buffer_load_dwordx4 v[176:179], v2, s[20:23], s31 offen offset:0 sc1
    buffer_load_dwordx4 v[180:183], v2, s[20:23], s31 offen offset:1024 sc1
    s_add_u32 s31, s36, 8192
    buffer_load_dwordx4 v[184:187], v2, s[20:23], s31 offen offset:0 sc1
    buffer_load_dwordx4 v[188:191], v2, s[20:23], s31 offen offset:1024 sc1
    s_add_u32 s31, s36, 12288
    buffer_load_dwordx4 v[192:195], v2, s[20:23], s31 offen offset:0 sc1
    buffer_load_dwordx4 v[196:199], v2, s[20:23], s31 offen offset:1024 sc1
    s_add_u32 s31, s36, 16384
    buffer_load_dwordx4 v[200:203], v2, s[20:23], s31 offen offset:0 sc1
    buffer_load_dwordx4 v[204:207], v2, s[20:23], s31 offen offset:1024 sc1
    ds_read_b128 v[128:131], v30 offset:40960
    ds_read_b128 v[132:135], v30 offset:45056
    ds_read_b128 v[136:139], v30 offset:49152
    ds_read_b128 v[140:143], v30 offset:53248
    ds_read_b128 v[144:147], v30 offset:57344
    ds_read_b128 v[148:151], v30 offset:41984
    ds_read_b128 v[152:155], v30 offset:46080
    ds_read_b128 v[156:159], v30 offset:50176
    ds_read_b128 v[160:163], v30 offset:54272
    s_waitcnt vmcnt(7) lgkmcnt(4)
    v_mfma_f32_16x16x32_bf16 v[64:67], v[128:131], v[176:179], v[64:67]
    s_add_u32 s31, s36, 20480
    buffer_load_dwordx4 v[208:211], v2, s[20:23], s31 offen offset:0 sc1
    ds_read_b128 v[164:167], v30 offset:58368
    v_mfma_f32_16x16x32_bf16 v[68:71], v[132:135], v[176:179], v[68:71]
    ds_read_b128 v[128:131], v30 offset:0
    v_mfma_f32_16x16x32_bf16 v[72:75], v[136:139], v[176:179], v[72:75]
    ds_read_b128 v[132:135], v30 offset:4096
    v_mfma_f32_16x16x32_bf16 v[76:79], v[140:143], v[176:179], v[76:79]
    ds_read_b128 v[136:139], v30 offset:8192
    v_mfma_f32_16x16x32_bf16 v[80:83], v[144:147], v[176:179], v[80:83]
    ds_read_b128 v[140:143], v30 offset:12288
    s_waitcnt vmcnt(7) lgkmcnt(4)
    v_mfma_f32_16x16x32_bf16 v[64:67], v[148:151], v[180:183], v[64:67]
    buffer_load_dwordx4 v[212:215], v2, s[20:23], s31 offen offset:1024 sc1
    ds_read_b128 v[144:147], v30 offset:16384
    v_mfma_f32_16x16x32_bf16 v[68:71], v[152:155], v[180:183], v[68:71]
    ds_read_b128 v[148:151], v30 offset:1024
    v_mfma_f32_16x16x32_bf16 v[72:75], v[156:159], v[180:183], v[72:75]
    ds_read_b128 v[152:155], v30 offset:5120
    v_mfma_f32_16x16x32_bf16 v[76:79], v[160:163], v[180:183], v[76:79]
    ds_read_b128 v[156:159], v30 offset:9216
    v_mfma_f32_16x16x32_bf16 v[80:83], v[164:167], v[180:183], v[80:83]
    ds_read_b128 v[160:163], v30 offset:13312
    s_waitcnt vmcnt(7) lgkmcnt(4)
    v_mfma_f32_16x16x32_bf16 v[64:67], v[128:131], v[184:187], v[64:67]
    s_add_u32 s31, s36, 24576
    buffer_load_dwordx4 v[216:219], v2, s[20:23], s31 offen offset:0 sc1
    ds_read_b128 v[164:167], v30 offset:17408
    s_barrier
    s_add_u32 m0, s33, 20480
    s_add_u32 s30, s32, 26386432
    buffer_load_dwordx4 v2, s[20:23], s30 offen offset:0 sc1 lds
    buffer_load_dwordx4 v2, s[20:23], s30 offen offset:1024 sc1 lds
    buffer_load_dwordx4 v2, s[20:23], s30 offen offset:2048 sc1 lds
    buffer_load_dwordx4 v2, s[20:23], s30 offen offset:3072 sc1 lds
    s_add_u32 m0, s33, 24576
    s_add_u32 s30, s32, 26390528
    buffer_load_dwordx4 v2, s[20:23], s30 offen offset:0 sc1 lds
    v_mfma_f32_16x16x32_bf16 v[68:71], v[132:135], v[184:187], v[68:71]
    ds_read_b128 v[128:131], v30 offset:61440
    v_mfma_f32_16x16x32_bf16 v[72:75], v[136:139], v[184:187], v[72:75]
    ds_read_b128 v[132:135], v31 offset:0
    v_mfma_f32_16x16x32_bf16 v[76:79], v[140:143], v[184:187], v[76:79]
    ds_read_b128 v[136:139], v31 offset:4096
    v_mfma_f32_16x16x32_bf16 v[80:83], v[144:147], v[184:187], v[80:83]
    ds_read_b128 v[140:143], v31 offset:8192
    s_waitcnt vmcnt(12) lgkmcnt(4)
    v_mfma_f32_16x16x32_bf16 v[64:67], v[148:151], v[188:191], v[64:67]
    buffer_load_dwordx4 v[220:223], v2, s[20:23], s31 offen offset:1024 sc1
    ds_read_b128 v[144:147], v31 offset:12288
    v_mfma_f32_16x16x32_bf16 v[68:71], v[152:155], v[188:191], v[68:71]
    ds_read_b128 v[148:151], v30 offset:62464
    v_mfma_f32_16x16x32_bf16 v[72:75], v[156:159], v[188:191], v[72:75]
    ds_read_b128 v[152:155], v31 offset:1024
    v_mfma_f32_16x16x32_bf16 v[76:79], v[160:163], v[188:191], v[76:79]
    ds_read_b128 v[156:159], v31 offset:5120
    v_mfma_f32_16x16x32_bf16 v[80:83], v[164:167], v[188:191], v[80:83]
    ds_read_b128 v[160:163], v31 offset:9216
    s_waitcnt vmcnt(12) lgkmcnt(4)
    v_mfma_f32_16x16x32_bf16 v[64:67], v[128:131], v[192:195], v[64:67]
    s_add_u32 s31, s36, 28672
    buffer_load_dwordx4 v[224:227], v2, s[20:23], s31 offen offset:0 sc1
    ds_read_b128 v[164:167], v31 offset:13312
    v_mfma_f32_16x16x32_bf16 v[68:71], v[132:135], v[192:195], v[68:71]
    ds_read_b128 v[128:131], v31 offset:16384
    v_mfma_f32_16x16x32_bf16 v[72:75], v[136:139], v[192:195], v[72:75]
    ds_read_b128 v[132:135], v31 offset:20480
    v_mfma_f32_16x16x32_bf16 v[76:79], v[140:143], v[192:195], v[76:79]
    ds_read_b128 v[136:139], v31 offset:24576
    v_mfma_f32_16x16x32_bf16 v[80:83], v[144:147], v[192:195], v[80:83]
    ds_read_b128 v[140:143], v31 offset:28672
    s_waitcnt vmcnt(12) lgkmcnt(4)
    v_mfma_f32_16x16x32_bf16 v[64:67], v[148:151], v[196:199], v[64:67]
    buffer_load_dwordx4 v[228:231], v2, s[20:23], s31 offen offset:1024 sc1
    ds_read_b128 v[144:147], v31 offset:32768
    v_mfma_f32_16x16x32_bf16 v[68:71], v[152:155], v[196:199], v[68:71]
    ds_read_b128 v[148:151], v31 offset:17408
    v_mfma_f32_16x16x32_bf16 v[72:75], v[156:159], v[196:199], v[72:75]
    ds_read_b128 v[152:155], v31 offset:21504
    v_mfma_f32_16x16x32_bf16 v[76:79], v[160:163], v[196:199], v[76:79]
    ds_read_b128 v[156:159], v31 offset:25600
    v_mfma_f32_16x16x32_bf16 v[80:83], v[164:167], v[196:199], v[80:83]
    ds_read_b128 v[160:163], v31 offset:29696
    s_waitcnt vmcnt(12) lgkmcnt(4)
    v_mfma_f32_16x16x32_bf16 v[64:67], v[128:131], v[200:203], v[64:67]
    s_add_u32 s31, s36, 32768
    buffer_load_dwordx4 v[232:235], v2, s[20:23], s31 offen offset:0 sc1
    ds_read_b128 v[164:167], v31 offset:33792
    s_barrier
    s_add_u32 m0, s33, 0
    s_add_u32 s30, s32, 26427392
    buffer_load_dwordx4 v2, s[20:23], s30 offen offset:0 sc1 lds
    buffer_load_dwordx4 v2, s[20:23], s30 offen offset:1024 sc1 lds
    buffer_load_dwordx4 v2, s[20:23], s30 offen offset:2048 sc1 lds
    buffer_load_dwordx4 v2, s[20:23], s30 offen offset:3072 sc1 lds
    s_add_u32 m0, s33, 4096
    s_add_u32 s30, s32, 26431488
    buffer_load_dwordx4 v2, s[20:23], s30 offen offset:0 sc1 lds
    v_mfma_f32_16x16x32_bf16 v[68:71], v[132:135], v[200:203], v[68:71]
    ds_read_b128 v[128:131], v31 offset:36864
    v_mfma_f32_16x16x32_bf16 v[72:75], v[136:139], v[200:203], v[72:75]
    ds_read_b128 v[132:135], v31 offset:40960
    v_mfma_f32_16x16x32_bf16 v[76:79], v[140:143], v[200:203], v[76:79]
    ds_read_b128 v[136:139], v31 offset:45056
    v_mfma_f32_16x16x32_bf16 v[80:83], v[144:147], v[200:203], v[80:83]
    ds_read_b128 v[140:143], v31 offset:49152
    s_waitcnt vmcnt(17) lgkmcnt(4)
    v_mfma_f32_16x16x32_bf16 v[64:67], v[148:151], v[204:207], v[64:67]
    buffer_load_dwordx4 v[236:239], v2, s[20:23], s31 offen offset:1024 sc1
    ds_read_b128 v[144:147], v31 offset:53248
    v_mfma_f32_16x16x32_bf16 v[68:71], v[152:155], v[204:207], v[68:71]
    ds_read_b128 v[148:151], v31 offset:37888
    v_mfma_f32_16x16x32_bf16 v[72:75], v[156:159], v[204:207], v[72:75]
    ds_read_b128 v[152:155], v31 offset:41984
    v_mfma_f32_16x16x32_bf16 v[76:79], v[160:163], v[204:207], v[76:79]
    ds_read_b128 v[156:159], v31 offset:46080
    v_mfma_f32_16x16x32_bf16 v[80:83], v[164:167], v[204:207], v[80:83]
    ds_read_b128 v[160:163], v31 offset:50176
    s_waitcnt vmcnt(17) lgkmcnt(4)
    v_mfma_f32_16x16x32_bf16 v[64:67], v[128:131], v[208:211], v[64:67]
    s_add_u32 s31, s36, 36864
    buffer_load_dwordx4 v[240:243], v2, s[20:23], s31 offen offset:0 sc1
    ds_read_b128 v[164:167], v31 offset:54272
    v_mfma_f32_16x16x32_bf16 v[68:71], v[132:135], v[208:211], v[68:71]
    ds_read_b128 v[128:131], v31 offset:57344
    v_mfma_f32_16x16x32_bf16 v[72:75], v[136:139], v[208:211], v[72:75]
    ds_read_b128 v[132:135], v31 offset:61440
    v_mfma_f32_16x16x32_bf16 v[76:79], v[140:143], v[208:211], v[76:79]
    ds_read_b128 v[136:139], v32 offset:0
    v_mfma_f32_16x16x32_bf16 v[80:83], v[144:147], v[208:211], v[80:83]
    ds_read_b128 v[140:143], v32 offset:4096
    s_waitcnt vmcnt(17) lgkmcnt(4)
    v_mfma_f32_16x16x32_bf16 v[64:67], v[148:151], v[212:215], v[64:67]
    buffer_load_dwordx4 v[244:247], v2, s[20:23], s31 offen offset:1024 sc1
    ds_read_b128 v[144:147], v32 offset:8192
    v_mfma_f32_16x16x32_bf16 v[68:71], v[152:155], v[212:215], v[68:71]
    ds_read_b128 v[148:151], v31 offset:58368
    v_mfma_f32_16x16x32_bf16 v[72:75], v[156:159], v[212:215], v[72:75]
    ds_read_b128 v[152:155], v31 offset:62464
    v_mfma_f32_16x16x32_bf16 v[76:79], v[160:163], v[212:215], v[76:79]
    ds_read_b128 v[156:159], v32 offset:1024
    v_mfma_f32_16x16x32_bf16 v[80:83], v[164:167], v[212:215], v[80:83]
    ds_read_b128 v[160:163], v32 offset:5120
    s_waitcnt vmcnt(17) lgkmcnt(4)
    v_mfma_f32_16x16x32_bf16 v[64:67], v[128:131], v[216:219], v[64:67]
    s_add_u32 s31, s36, 40960
    buffer_load_dwordx4 v[248:251], v2, s[20:23], s31 offen offset:0 sc1
    ds_read_b128 v[164:167], v32 offset:9216
    s_waitcnt vmcnt(13)
    s_barrier
    v_mfma_f32_16x16x32_bf16 v[68:71], v[132:135], v[216:219], v[68:71]
    ds_read_b128 v[128:131], v30 offset:20480
    v_mfma_f32_16x16x32_bf16 v[72:75], v[136:139], v[216:219], v[72:75]
    ds_read_b128 v[132:135], v30 offset:24576
    v_mfma_f32_16x16x32_bf16 v[76:79], v[140:143], v[216:219], v[76:79]
    ds_read_b128 v[136:139], v30 offset:28672
    v_mfma_f32_16x16x32_bf16 v[80:83], v[144:147], v[216:219], v[80:83]
    ds_read_b128 v[140:143], v30 offset:32768
    s_waitcnt vmcnt(12) lgkmcnt(4)
    v_mfma_f32_16x16x32_bf16 v[64:67], v[148:151], v[220:223], v[64:67]
    buffer_load_dwordx4 v[252:255], v2, s[20:23], s31 offen offset:1024 sc1
    ds_read_b128 v[144:147], v30 offset:36864
    v_mfma_f32_16x16x32_bf16 v[68:71], v[152:155], v[220:223], v[68:71]
    ds_read_b128 v[148:151], v30 offset:21504
    v_mfma_f32_16x16x32_bf16 v[72:75], v[156:159], v[220:223], v[72:75]
    ds_read_b128 v[152:155], v30 offset:25600
    v_mfma_f32_16x16x32_bf16 v[76:79], v[160:163], v[220:223], v[76:79]
    ds_read_b128 v[156:159], v30 offset:29696
    v_mfma_f32_16x16x32_bf16 v[80:83], v[164:167], v[220:223], v[80:83]
    ds_read_b128 v[160:163], v30 offset:33792
    s_waitcnt vmcnt(12) lgkmcnt(4)
    v_mfma_f32_16x16x32_bf16 v[64:67], v[128:131], v[224:227], v[64:67]
    s_add_u32 s31, s36, 45056
    buffer_load_dwordx4 v[176:179], v2, s[20:23], s31 offen offset:0 sc1
    ds_read_b128 v[164:167], v30 offset:37888
    v_mfma_f32_16x16x32_bf16 v[68:71], v[132:135], v[224:227], v[68:71]
    ds_read_b128 v[128:131], v30 offset:40960
    v_mfma_f32_16x16x32_bf16 v[72:75], v[136:139], v[224:227], v[72:75]
    ds_read_b128 v[132:135], v30 offset:45056
    v_mfma_f32_16x16x32_bf16 v[76:79], v[140:143], v[224:227], v[76:79]
    ds_read_b128 v[136:139], v30 offset:49152
    v_mfma_f32_16x16x32_bf16 v[80:83], v[144:147], v[224:227], v[80:83]
    ds_read_b128 v[140:143], v30 offset:53248
    s_waitcnt vmcnt(12) lgkmcnt(4)
    v_mfma_f32_16x16x32_bf16 v[64:67], v[148:151], v[228:231], v[64:67]
    buffer_load_dwordx4 v[180:183], v2, s[20:23], s31 offen offset:1024 sc1
    ds_read_b128 v[144:147], v30 offset:57344
    v_mfma_f32_16x16x32_bf16 v[68:71], v[152:155], v[228:231], v[68:71]
    ds_read_b128 v[148:151], v30 offset:41984
    v_mfma_f32_16x16x32_bf16 v[72:75], v[156:159], v[228:231], v[72:75]
    ds_read_b128 v[152:155], v30 offset:46080
    v_mfma_f32_16x16x32_bf16 v[76:79], v[160:163], v[228:231], v[76:79]
    ds_read_b128 v[156:159], v30 offset:50176
    v_mfma_f32_16x16x32_bf16 v[80:83], v[164:167], v[228:231], v[80:83]
    ds_read_b128 v[160:163], v30 offset:54272
    s_waitcnt vmcnt(12) lgkmcnt(4)
    v_mfma_f32_16x16x32_bf16 v[64:67], v[128:131], v[232:235], v[64:67]
    ds_read_b128 v[164:167], v30 offset:58368
    s_waitcnt vmcnt(7)
    s_barrier
    v_mfma_f32_16x16x32_bf16 v[68:71], v[132:135], v[232:235], v[68:71]
    ds_read_b128 v[128:131], v30 offset:0
    v_mfma_f32_16x16x32_bf16 v[72:75], v[136:139], v[232:235], v[72:75]
    ds_read_b128 v[132:135], v30 offset:4096
    v_mfma_f32_16x16x32_bf16 v[76:79], v[140:143], v[232:235], v[76:79]
    ds_read_b128 v[136:139], v30 offset:8192
    v_mfma_f32_16x16x32_bf16 v[80:83], v[144:147], v[232:235], v[80:83]
    ds_read_b128 v[140:143], v30 offset:12288
    s_waitcnt vmcnt(6) lgkmcnt(4)
    v_mfma_f32_16x16x32_bf16 v[64:67], v[148:151], v[236:239], v[64:67]
    ds_read_b128 v[144:147], v30 offset:16384
    v_mfma_f32_16x16x32_bf16 v[68:71], v[152:155], v[236:239], v[68:71]
    ds_read_b128 v[148:151], v30 offset:1024
    v_mfma_f32_16x16x32_bf16 v[72:75], v[156:159], v[236:239], v[72:75]
    ds_read_b128 v[152:155], v30 offset:5120
    v_mfma_f32_16x16x32_bf16 v[76:79], v[160:163], v[236:239], v[76:79]
    ds_read_b128 v[156:159], v30 offset:9216
    v_mfma_f32_16x16x32_bf16 v[80:83], v[164:167], v[236:239], v[80:83]
    ds_read_b128 v[160:163], v30 offset:13312
    s_waitcnt vmcnt(5) lgkmcnt(4)
    v_mfma_f32_16x16x32_bf16 v[64:67], v[128:131], v[240:243], v[64:67]
    ds_read_b128 v[164:167], v30 offset:17408
    v_mfma_f32_16x16x32_bf16 v[68:71], v[132:135], v[240:243], v[68:71]
    ds_read_b128 v[128:131], v30 offset:61440
    v_mfma_f32_16x16x32_bf16 v[72:75], v[136:139], v[240:243], v[72:75]
    ds_read_b128 v[132:135], v31 offset:0
    v_mfma_f32_16x16x32_bf16 v[76:79], v[140:143], v[240:243], v[76:79]
    ds_read_b128 v[136:139], v31 offset:4096
    v_mfma_f32_16x16x32_bf16 v[80:83], v[144:147], v[240:243], v[80:83]
    ds_read_b128 v[140:143], v31 offset:8192
    s_waitcnt vmcnt(4) lgkmcnt(4)
    v_mfma_f32_16x16x32_bf16 v[64:67], v[148:151], v[244:247], v[64:67]
    ds_read_b128 v[144:147], v31 offset:12288
    v_mfma_f32_16x16x32_bf16 v[68:71], v[152:155], v[244:247], v[68:71]
    ds_read_b128 v[148:151], v30 offset:62464
    v_mfma_f32_16x16x32_bf16 v[72:75], v[156:159], v[244:247], v[72:75]
    ds_read_b128 v[152:155], v31 offset:1024
    v_mfma_f32_16x16x32_bf16 v[76:79], v[160:163], v[244:247], v[76:79]
    ds_read_b128 v[156:159], v31 offset:5120
    v_mfma_f32_16x16x32_bf16 v[80:83], v[164:167], v[244:247], v[80:83]
    ds_read_b128 v[160:163], v31 offset:9216
    s_waitcnt vmcnt(3) lgkmcnt(4)
    v_mfma_f32_16x16x32_bf16 v[64:67], v[128:131], v[248:251], v[64:67]
    ds_read_b128 v[164:167], v31 offset:13312
    s_waitcnt vmcnt(7)
    s_barrier
    v_mfma_f32_16x16x32_bf16 v[68:71], v[132:135], v[248:251], v[68:71]
    ds_read_b128 v[128:131], v31 offset:16384
    v_mfma_f32_16x16x32_bf16 v[72:75], v[136:139], v[248:251], v[72:75]
    ds_read_b128 v[132:135], v31 offset:20480
    v_mfma_f32_16x16x32_bf16 v[76:79], v[140:143], v[248:251], v[76:79]
    ds_read_b128 v[136:139], v31 offset:24576
    v_mfma_f32_16x16x32_bf16 v[80:83], v[144:147], v[248:251], v[80:83]
    ds_read_b128 v[140:143], v31 offset:28672
    s_waitcnt vmcnt(2) lgkmcnt(4)
    v_mfma_f32_16x16x32_bf16 v[64:67], v[148:151], v[252:255], v[64:67]
    ds_read_b128 v[144:147], v31 offset:32768
    v_mfma_f32_16x16x32_bf16 v[68:71], v[152:155], v[252:255], v[68:71]
    ds_read_b128 v[148:151], v31 offset:17408
    v_mfma_f32_16x16x32_bf16 v[72:75], v[156:159], v[252:255], v[72:75]
    ds_read_b128 v[152:155], v31 offset:21504
    v_mfma_f32_16x16x32_bf16 v[76:79], v[160:163], v[252:255], v[76:79]
    ds_read_b128 v[156:159], v31 offset:25600
    v_mfma_f32_16x16x32_bf16 v[80:83], v[164:167], v[252:255], v[80:83]
    ds_read_b128 v[160:163], v31 offset:29696
    s_waitcnt vmcnt(1) lgkmcnt(4)
    v_mfma_f32_16x16x32_bf16 v[64:67], v[128:131], v[176:179], v[64:67]
    ds_read_b128 v[164:167], v31 offset:33792
    v_mfma_f32_16x16x32_bf16 v[68:71], v[132:135], v[176:179], v[68:71]
    v_mfma_f32_16x16x32_bf16 v[72:75], v[136:139], v[176:179], v[72:75]
    v_mfma_f32_16x16x32_bf16 v[76:79], v[140:143], v[176:179], v[76:79]
    v_mfma_f32_16x16x32_bf16 v[80:83], v[144:147], v[176:179], v[80:83]
    s_waitcnt vmcnt(0) lgkmcnt(0)
    v_mfma_f32_16x16x32_bf16 v[64:67], v[148:151], v[180:183], v[64:67]
    v_mfma_f32_16x16x32_bf16 v[68:71], v[152:155], v[180:183], v[68:71]
    v_mfma_f32_16x16x32_bf16 v[72:75], v[156:159], v[180:183], v[72:75]
    v_mfma_f32_16x16x32_bf16 v[76:79], v[160:163], v[180:183], v[76:79]
    v_mfma_f32_16x16x32_bf16 v[80:83], v[164:167], v[180:183], v[80:83]
    s_add_u32 s30, s33, 102400
    v_add_u32 v9, s30, v2
    s_barrier
    ds_read_b128 v[84:87], v9 offset:0
    ds_read_b128 v[88:91], v9 offset:1024
    ds_read_b128 v[92:95], v9 offset:2048
    ds_read_b128 v[96:99], v9 offset:3072
    ds_read_b128 v[100:103], v9 offset:4096
    s_waitcnt lgkmcnt(4)
    v_pk_add_f32 v[64:65], v[64:65], v[84:85]
    v_pk_add_f32 v[66:67], v[66:67], v[86:87]
    v_cvt_pk_bf16_f32 v64, v64, v65
    v_cvt_pk_bf16_f32 v65, v66, v67
    ds_write_b64 v34, v[64:65] offset:0
    s_waitcnt lgkmcnt(4)
    v_pk_add_f32 v[68:69], v[68:69], v[88:89]
    v_pk_add_f32 v[70:71], v[70:71], v[90:91]
    v_cvt_pk_bf16_f32 v68, v68, v69
    v_cvt_pk_bf16_f32 v69, v70, v71
    ds_write_b64 v34, v[68:69] offset:32
    s_waitcnt lgkmcnt(4)
    v_pk_add_f32 v[72:73], v[72:73], v[92:93]
    v_pk_add_f32 v[74:75], v[74:75], v[94:95]
    v_cvt_pk_bf16_f32 v72, v72, v73
    v_cvt_pk_bf16_f32 v73, v74, v75
    ds_write_b64 v34, v[72:73] offset:64
    s_waitcnt lgkmcnt(4)
    v_pk_add_f32 v[76:77], v[76:77], v[96:97]
    v_pk_add_f32 v[78:79], v[78:79], v[98:99]
    v_cvt_pk_bf16_f32 v76, v76, v77
    v_cvt_pk_bf16_f32 v77, v78, v79
    ds_write_b64 v34, v[76:77] offset:96
    s_waitcnt lgkmcnt(4)
    v_pk_add_f32 v[80:81], v[80:81], v[100:101]
    v_pk_add_f32 v[82:83], v[82:83], v[102:103]
    v_cvt_pk_bf16_f32 v80, v80, v81
    v_cvt_pk_bf16_f32 v81, v82, v83
    ds_write_b64 v34, v[80:81] offset:128
    ds_read_b128 v[104:107], v35 offset:0
    ds_read_b128 v[108:111], v35 offset:1024
    ds_read_b128 v[112:115], v35 offset:2048
    s_waitcnt lgkmcnt(2)
    buffer_store_dwordx4 v[104:107], v36, s[16:19], s42 offen
    s_waitcnt lgkmcnt(1)
    buffer_store_dwordx4 v[108:111], v37, s[16:19], s42 offen
    s_waitcnt lgkmcnt(0)
    s_mov_b32 exec_hi, 0
    buffer_store_dwordx4 v[112:115], v62, s[16:19], s42 offen
    s_mov_b64 exec, -1
    s_endpgm
L_m_Credo:
    v_mov_b32 v11, 0
    ds_write_b32 v5, v11
    ds_write_b32 v37, v11
    s_waitcnt lgkmcnt(0)
    s_barrier
    s_branch L_m_att
L_m_own:
    s_mov_b32 s58, 400000
    s_mov_b64 exec, s[56:57]
L_m_poll_o2:
    buffer_load_dword v17, v54, s[20:23], s67 offen sc1
    s_sub_u32 s58, s58, 1
    s_waitcnt vmcnt(0)
    v_cmp_gt_u32 vcc, 1, v17
    s_cmp_eq_u32 s58, 0
    s_cbranch_scc1 L_m_poll_o2_x
    s_cbranch_vccnz L_m_poll_o2
L_m_poll_o2_x:
    s_mov_b64 exec, -1
    s_branch L_m_ownb
L_m_pub_h_s:
    s_mul_i32 s30, s25, 10240
    s_add_u32 s30, s30, s44
    buffer_store_dwordx4 v[20:23], v2, s[20:23], s30 offen sc1
    buffer_store_dwordx4 v[24:27], v2, s[20:23], s30 offen offset:1024 sc1
    buffer_store_dwordx2 v[28:29], v38, s[20:23], s30 offen offset:2048 sc1
    v_pk_add_f32 v[12:13], v[64:65], v[66:67]
    v_pk_mul_f32 v[14:15], v[64:65], v[64:65]
    v_pk_fma_f32 v[14:15], v[66:67], v[66:67], v[14:15]
    v_pk_add_f32 v[12:13], v[12:13], v[68:69]
    v_pk_fma_f32 v[14:15], v[68:69], v[68:69], v[14:15]
    v_pk_add_f32 v[12:13], v[12:13], v[70:71]
    v_pk_fma_f32 v[14:15], v[70:71], v[70:71], v[14:15]
    v_pk_add_f32 v[12:13], v[12:13], v[72:73]
    v_pk_fma_f32 v[14:15], v[72:73], v[72:73], v[14:15]
    v_pk_add_f32 v[12:13], v[12:13], v[74:75]
    v_pk_fma_f32 v[14:15], v[74:75], v[74:75], v[14:15]
    v_pk_add_f32 v[12:13], v[12:13], v[76:77]
    v_pk_fma_f32 v[14:15], v[76:77], v[76:77], v[14:15]
    v_pk_add_f32 v[12:13], v[12:13], v[78:79]
    v_pk_fma_f32 v[14:15], v[78:79], v[78:79], v[14:15]
    v_pk_add_f32 v[12:13], v[12:13], v[80:81]
    v_pk_fma_f32 v[14:15], v[80:81], v[80:81], v[14:15]
    v_pk_add_f32 v[12:13], v[12:13], v[82:83]
    v_pk_fma_f32 v[14:15], v[82:83], v[82:83], v[14:15]
    v_add_f32 v12, v12, v13
    v_add_f32 v13, v14, v15
    v_mov_b32 v8, v12
    v_mov_b32 v9, v13
    s_nop 1
    v_permlane16_swap_b32 v12, v8
    v_permlane16_swap_b32 v13, v9
    s_nop 1
    v_add_f32 v12, v12, v8
    v_add_f32 v13, v13, v9
    v_mov_b32 v8, v12
    v_mov_b32 v9, v13
    s_nop 1
    v_permlane32_swap_b32 v12, v8
    v_permlane32_swap_b32 v13, v9
    s_nop 1
    v_add_f32 v12, v12, v8
    v_add_f32 v13, v13, v9
    s_add_u32 s32, s39, 32079872
    s_mov_b64 exec, 0xffff
    buffer_store_dwordx2 v[12:13], v2, s[20:23], s32 offen sc1
    s_mov_b64 exec, -1
    s_add_u32 s66, s63, 0
    s_mov_b64 exec, 1
    s_waitcnt vmcnt(0)
    buffer_store_dword v6, off, s[20:23], s66 sc1
    s_mov_b64 exec, -1
    s_branch L_m_pub_h_d
L_m_pub_g_s:
    buffer_store_dwordx4 v[84:87], v36, s[20:23], s37 offen sc1
    buffer_store_dwordx4 v[88:91], v36, s[20:23], s37 offen offset:1024 sc1
    buffer_store_dwordx2 v[92:93], v36, s[20:23], s38 offen offset:0 sc1
    s_mov_b64 exec, -1
    s_add_u32 s66, s63, 16384
    s_mov_b64 exec, 1
    s_waitcnt vmcnt(0)
    buffer_store_dword v6, off, s[20:23], s66 sc1
    s_mov_b64 exec, -1
    s_branch L_m_pub_g_d
L_m_pub_gl_s:
    buffer_store_dwordx4 v[84:87], v36, s[20:23], s37 offen sc1
    buffer_store_dwordx4 v[88:91], v36, s[20:23], s37 offen offset:1024 sc1
    buffer_store_dwordx2 v[92:93], v36, s[20:23], s38 offen offset:0 sc1
    s_branch L_m_pub_gl_d
L_m_pub_gh_s:
    buffer_store_dwordx4 v[84:87], v36, s[20:23], s37 offen sc1
    buffer_store_dwordx4 v[88:91], v36, s[20:23], s37 offen offset:1024 sc1
    buffer_store_dwordx2 v[92:93], v36, s[20:23], s38 offen offset:0 sc1
    s_branch L_m_pub_gh_d
L_m_pub_gf0_s:
    buffer_store_dword v6, off, s[20:23], s66 sc1
    s_branch L_m_pub_gf0_d
L_m_pub_gf1_s:
    buffer_store_dword v6, off, s[20:23], s48 sc1
    s_branch L_m_pub_gf1_d
L_m_gz:
    s_not_b64 exec, s[68:69]
    s_cmp_lg_u32 s60, 0
    s_cbranch_scc1 L_m_pub_gl_s
    buffer_store_dwordx4 v[84:87], v36, s[20:23], s37 offen
    buffer_store_dwordx4 v[88:91], v36, s[20:23], s37 offen offset:1024
    buffer_store_dwordx2 v[92:93], v36, s[20:23], s38 offen offset:0
L_m_pub_gl_d:
    s_mov_b64 exec, s[68:69]
    s_cmp_eq_u32 s49, 0
    s_cbranch_scc1 L_m_gz1
    s_nop 1
    v_mov_b32 v84, 0
    v_mov_b32 v85, 0
    v_mov_b32 v86, 0
    v_mov_b32 v87, 0
    v_mov_b32 v88, 0
    v_mov_b32 v89, 0
    v_mov_b32 v90, 0
    v_mov_b32 v91, 0
    v_mov_b32 v92, 0
    v_mov_b32 v93, 0
L_m_gz1:
    s_cmp_lg_u32 s61, 0
    s_cbranch_scc1 L_m_pub_gh_s
    buffer_store_dwordx4 v[84:87], v36, s[20:23], s37 offen
    buffer_store_dwordx4 v[88:91], v36, s[20:23], s37 offen offset:1024
    buffer_store_dwordx2 v[92:93], v36, s[20:23], s38 offen offset:0
L_m_pub_gh_d:
    s_add_u32 s66, s63, 16384
    s_mov_b64 exec, 1
    s_waitcnt vmcnt(3)
    s_cmp_lg_u32 s60, 0
    s_cbranch_scc1 L_m_pub_gf0_s
    buffer_store_dword v6, off, s[20:23], s66
L_m_pub_gf0_d:
    s_waitcnt vmcnt(1)
    s_cmp_lg_u32 s61, 0
    s_cbranch_scc1 L_m_pub_gf1_s
    buffer_store_dword v6, off, s[20:23], s48
L_m_pub_gf1_d:
    s_mov_b64 exec, -1
    s_branch L_m_gzb
L_m_halo:
    s_mov_b32 s40, 0xcc
    s_cmp_eq_u32 s26, 0
    s_cselect_b32 s40, 0x33, s40
    s_mov_b32 s58, 400000
    s_mov_b64 exec, s[40:41]
L_m_poll_hal:
    buffer_load_dword v17, v33, s[20:23], s65 offen sc1
    s_sub_u32 s58, s58, 1
    s_waitcnt vmcnt(0)
    v_cmp_gt_u32 vcc, 1, v17
    s_cmp_eq_u32 s58, 0
    s_cbranch_scc1 L_m_poll_hal_x
    s_cbranch_vccnz L_m_poll_hal
L_m_poll_hal_x:
    s_mov_b64 exec, -1
    s_branch L_m_halob
L_m_pub_x1_s:
    s_add_u32 s31, s36, 8912896
    s_add_u32 s30, s31, s37
    s_add_u32 s31, s31, s38
    buffer_store_dwordx4 v[44:47], v2, s[20:23], s30 offen sc1
    buffer_store_dwordx4 v[48:51], v2, s[20:23], s30 offen offset:1024 sc1
    buffer_store_dwordx2 v[52:53], v2, s[20:23], s31 offen offset:0 sc1
    v_pk_add_f32 v[12:13], v[64:65], v[66:67]
    v_pk_mul_f32 v[14:15], v[64:65], v[64:65]
    v_pk_fma_f32 v[14:15], v[66:67], v[66:67], v[14:15]
    v_pk_add_f32 v[12:13], v[12:13], v[68:69]
    v_pk_fma_f32 v[14:15], v[68:69], v[68:69], v[14:15]
    v_pk_add_f32 v[12:13], v[12:13], v[70:71]
    v_pk_fma_f32 v[14:15], v[70:71], v[70:71], v[14:15]
    v_pk_add_f32 v[12:13], v[12:13], v[72:73]
    v_pk_fma_f32 v[14:15], v[72:73], v[72:73], v[14:15]
    v_pk_add_f32 v[12:13], v[12:13], v[74:75]
    v_pk_fma_f32 v[14:15], v[74:75], v[74:75], v[14:15]
    v_pk_add_f32 v[12:13], v[12:13], v[76:77]
    v_pk_fma_f32 v[14:15], v[76:77], v[76:77], v[14:15]
    v_pk_add_f32 v[12:13], v[12:13], v[78:79]
    v_pk_fma_f32 v[14:15], v[78:79], v[78:79], v[14:15]
    v_pk_add_f32 v[12:13], v[12:13], v[80:81]
    v_pk_fma_f32 v[14:15], v[80:81], v[80:81], v[14:15]
    v_pk_add_f32 v[12:13], v[12:13], v[82:83]
    v_pk_fma_f32 v[14:15], v[82:83], v[82:83], v[14:15]
    v_add_f32 v12, v12, v13
    v_add_f32 v13, v14, v15
    v_mov_b32 v8, v12
    v_mov_b32 v9, v13
    s_nop 1
    v_permlane16_swap_b32 v12, v8
    v_permlane16_swap_b32 v13, v9
    s_nop 1
    v_add_f32 v12, v12, v8
    v_add_f32 v13, v13, v9
    v_mov_b32 v8, v12
    v_mov_b32 v9, v13
    s_nop 1
    v_permlane32_swap_b32 v12, v8
    v_permlane32_swap_b32 v13, v9
    s_nop 1
    v_add_f32 v12, v12, v8
    v_add_f32 v13, v13, v9
    s_add_u32 s32, s39, 32210944
    s_mov_b64 exec, 0xffff
    buffer_store_dwordx2 v[12:13], v2, s[20:23], s32 offen sc1
    s_mov_b64 exec, -1
    s_add_u32 s66, s63, 32768
    s_mov_b64 exec, 1
    s_waitcnt vmcnt(0)
    buffer_store_dword v6, off, s[20:23], s66 sc1
    s_mov_b64 exec, -1
    s_branch L_m_pub_x1_d
L_m_pub_u0_0_s:
    buffer_store_dwordx2 v[18:19], v2, s[20:23], s42 offen sc1
    s_branch L_m_pub_u0_0_d
L_m_pub_u0_1_s:
    buffer_store_dwordx2 v[18:19], v2, s[20:23], s42 offen sc1
    s_branch L_m_pub_u0_1_d
L_m_pub_u0_2_s:
    buffer_store_dwordx2 v[18:19], v2, s[20:23], s42 offen sc1
    s_branch L_m_pub_u0_2_d
L_m_pub_u0_3_s:
    buffer_store_dwordx2 v[18:19], v2, s[20:23], s42 offen sc1
    s_branch L_m_pub_u0_3_d
L_m_pub_uf_s:
    buffer_store_dword v6, v8, s[20:23], s66 offen sc1
    s_branch L_m_pub_uf_d
L_m_scanmore:
    s_add_u32 s30, s30, 1
    s_cmp_ge_u32 s30, 64
    s_cbranch_scc1 L_m_scanfin
    s_lshr_b32 s31, s30, 2
    s_mul_i32 s31, s31, 10240
    s_and_b32 s32, s30, 3
    s_lshl_b32 s32, s32, 8
    s_add_u32 s31, s31, s32
    buffer_load_dwordx2 v[76:77], v32, s[12:15], s31 offen sc1
    buffer_load_dwordx2 v[78:79], v32, s[12:15], s31 offen offset:1024 sc1
    buffer_load_dword v82, v31, s[12:15], s31 offen sc1
    s_waitcnt vmcnt(0)
    s_branch L_m_scan
L_m_scanfin:
    v_mov_b32 v8, v40
    v_mov_b32 v9, v41
    v_mov_b32 v10, v42
    v_mov_b32 v11, v43
    s_nop 1
    v_permlane32_swap_b32 v40, v8
    v_permlane32_swap_b32 v41, v9
    v_permlane32_swap_b32 v42, v10
    v_permlane32_swap_b32 v43, v11
    v_cmp_gt_u32 vcc, 32, v1
    v_max_f32 v40, v40, v8
    v_sub_f32 v40, 0, v40
    v_and_b32 v13, 0xffff0000, v40
    v_sub_f32 v14, v40, v13
    v_and_b32 v15, 0xffff0000, v14
    v_sub_f32 v14, v14, v15
    v_lshrrev_b32 v14, 16, v14
    v_lshrrev_b32 v13, 16, v13
    v_or_b32 v13, v13, v15
    v_cndmask_b32 v65, v14, v13, vcc
    v_max_f32 v41, v41, v9
    v_sub_f32 v41, 0, v41
    v_and_b32 v13, 0xffff0000, v41
    v_sub_f32 v14, v41, v13
    v_and_b32 v15, 0xffff0000, v14
    v_sub_f32 v14, v14, v15
    v_lshrrev_b32 v14, 16, v14
    v_lshrrev_b32 v13, 16, v13
    v_or_b32 v13, v13, v15
    v_cndmask_b32 v67, v14, v13, vcc
    v_max_f32 v42, v42, v10
    v_sub_f32 v42, 0, v42
    v_and_b32 v13, 0xffff0000, v42
    v_sub_f32 v14, v42, v13
    v_and_b32 v15, 0xffff0000, v14
    v_sub_f32 v14, v14, v15
    v_lshrrev_b32 v14, 16, v14
    v_lshrrev_b32 v13, 16, v13
    v_or_b32 v13, v13, v15
    v_cndmask_b32 v69, v14, v13, vcc
    v_max_f32 v43, v43, v11
    v_sub_f32 v43, 0, v43
    v_and_b32 v13, 0xffff0000, v43
    v_sub_f32 v14, v43, v13
    v_and_b32 v15, 0xffff0000, v14
    v_sub_f32 v14, v14, v15
    v_lshrrev_b32 v14, 16, v14
    v_lshrrev_b32 v13, 16, v13
    v_or_b32 v13, v13, v15
    v_cndmask_b32 v71, v14, v13, vcc
    s_branch L_m_scandone
L_m_rw_g0:
    v_cmp_le_u32 vcc, 8, v39
    s_cbranch_vccnz L_m_rb_g0
    s_sleep 1
    ds_read_b32 v38, v37
    s_waitcnt lgkmcnt(0)
    v_cmp_le_u32 vcc, v38, v39
    s_cbranch_vccnz L_m_rw_g0
    s_branch L_m_rb_g0
L_m_rw_g1:
    v_cmp_le_u32 vcc, 8, v39
    s_cbranch_vccnz L_m_rb_g1
    s_sleep 1
    ds_read_b32 v38, v37
    s_waitcnt lgkmcnt(0)
    v_cmp_le_u32 vcc, v38, v39
    s_cbranch_vccnz L_m_rw_g1
    s_branch L_m_rb_g1
L_m_rw_g2:
    v_cmp_le_u32 vcc, 8, v39
    s_cbranch_vccnz L_m_rb_g2
    s_sleep 1
    ds_read_b32 v38, v37
    s_waitcnt lgkmcnt(0)
    v_cmp_le_u32 vcc, v38, v39
    s_cbranch_vccnz L_m_rw_g2
    s_branch L_m_rb_g2
L_m_rw_g3:
    v_cmp_le_u32 vcc, 8, v39
    s_cbranch_vccnz L_m_rb_g3
    s_sleep 1
    ds_read_b32 v38, v37
    s_waitcnt lgkmcnt(0)
    v_cmp_le_u32 vcc, v38, v39
    s_cbranch_vccnz L_m_rw_g3
    s_branch L_m_rb_g3
L_m_H:
    s_sub_u32 s27, s26, 4
    s_setprio 3
    s_waitcnt lgkmcnt(0)
    s_add_u32 s12, s8, s30
    s_addc_u32 s13, s9, 0
    s_mov_b32 s20, s8
    s_mov_b32 s21, s9
    s_lshl_b32 s30, s27, 2
    s_add_u32 s30, s30, 162352
    v_mov_b32 v7, s30
    v_mov_b32 v5, 162320
L_m_H0:
    s_cmp_ge_u32 s27, 2
    s_cbranch_scc1 L_m_Hkv
L_m_hp:
    s_sleep 3
    ds_read_b32 v8, v5 offset:100
    s_waitcnt lgkmcnt(0)
    v_cmp_gt_u32 vcc, 2, v8
    s_cbranch_vccnz L_m_hp
    s_cmp_lg_u32 s29, 0
    s_cbranch_scc1 L_m_HB1
    s_cmp_lg_u32 s27, 0
    s_cbranch_scc1 L_m_Hnx
    s_getreg_b32 s30, hwreg(HW_REG_XCC_ID)
    s_and_b32 s30, s30, 15
    s_add_u32 s30, s30, 1
    v_mov_b32 v8, s30
    s_lshl_b32 s30, s2, 2
    s_add_u32 s30, s30, 32595968
    s_mov_b64 exec, 1
    buffer_store_dword v8, off, s[20:23], s30 sc1
    s_mov_b64 exec, -1
L_m_Hnx:
    s_lshl_b32 s52, s27, 8
    s_add_u32 s52, s52, s2
    s_cmp_ge_u32 s52, 336
    s_cbranch_scc1 L_m_Hwait
    s_mov_b32 s56, s6
    s_mov_b32 s57, s7
    s_mov_b32 s53, 0
    s_mov_b32 s54, s52
    s_mov_b32 s55, -1
    s_mov_b32 s58, 819200
    s_sub_u32 s30, s52, 40
    s_cmp_ge_u32 s52, 40
    s_cselect_b32 s56, s44, s56
    s_cselect_b32 s57, s45, s57
    s_cselect_b32 s53, 102400, s53
    s_cselect_b32 s54, s30, s54
    s_cselect_b32 s55, 0, s55
    s_cselect_b32 s58, 819200, s58
    s_sub_u32 s30, s52, 80
    s_cmp_ge_u32 s52, 80
    s_cselect_b32 s56, s46, s56
    s_cselect_b32 s57, s47, s57
    s_cselect_b32 s53, 204800, s53
    s_cselect_b32 s54, s30, s54
    s_cselect_b32 s55, -1, s55
    s_cselect_b32 s58, 819200, s58
    s_sub_u32 s30, s52, 120
    s_cmp_ge_u32 s52, 120
    s_cselect_b32 s56, s48, s56
    s_cselect_b32 s57, s49, s57
    s_cselect_b32 s53, 307200, s53
    s_cselect_b32 s54, s30, s54
    s_cselect_b32 s55, 640, s55
    s_cselect_b32 s58, 1966080, s58
    s_sub_u32 s30, s52, 216
    s_cmp_ge_u32 s52, 216
    s_cselect_b32 s56, s50, s56
    s_cselect_b32 s57, s51, s57
    s_cselect_b32 s53, 552960, s53
    s_cselect_b32 s54, s30, s54
    s_cselect_b32 s55, -1, s55
    s_cselect_b32 s58, 1966080, s58
    s_mov_b32 s59, 0x20000
    s_mov_b32 s60, 1280
    s_mov_b32 s61, 6554
    s_cmp_eq_u32 s55, 640
    s_cselect_b32 s60, 3072, s60
    s_cselect_b32 s61, 2731, s61
    s_cselect_b32 s62, 24, 10
    s_mul_i32 s38, s54, s61
    s_lshr_b32 s38, s38, 16
    s_mul_i32 s31, s38, s62
    s_sub_u32 s39, s54, s31
    s_cmp_ge_u32 s52, 216
    s_cselect_b32 s63, 1, 0
    s_cselect_b32 s32, 4, 5
    s_mov_b32 s33, 5120
    s_mov_b32 s35, 20480
    s_cselect_b32 s33, 20480, s33
    s_cselect_b32 s35, 4096, s35
    s_mul_i32 s34, s38, s32
    s_lshl_b32 s30, s34, 5
    s_mul_i32 s30, s30, s60
    s_lshl_b32 s31, s39, 7
    s_add_u32 s61, s30, s31
    s_mul_i32 s33, s33, s38
    s_add_u32 s53, s53, s33
    s_add_u32 s53, s53, 25690112
    s_lshr_b32 s62, s62, 1
    s_mov_b32 s33, 13108
    s_cmp_eq_u32 s62, 12
    s_cselect_b32 s33, 5462, s33
    s_lshl_b32 s30, s39, 2
    s_add_u32 s30, s30, 0
    s_mul_i32 s31, s30, s33
    s_lshr_b32 s31, s31, 16
    s_mul_i32 s34, s31, s62
    s_sub_u32 s30, s30, s34
    s_mul_i32 s30, s30, s35
    s_mul_i32 s31, s31, 798720
    s_add_u32 s30, s30, s31
    s_add_u32 s64, s30, s53
    s_lshl_b32 s30, s39, 2
    s_add_u32 s30, s30, 1
    s_mul_i32 s31, s30, s33
    s_lshr_b32 s31, s31, 16
    s_mul_i32 s34, s31, s62
    s_sub_u32 s30, s30, s34
    s_mul_i32 s30, s30, s35
    s_mul_i32 s31, s31, 798720
    s_add_u32 s30, s30, s31
    s_add_u32 s65, s30, s53
    s_lshl_b32 s30, s39, 2
    s_add_u32 s30, s30, 2
    s_mul_i32 s31, s30, s33
    s_lshr_b32 s31, s31, 16
    s_mul_i32 s34, s31, s62
    s_sub_u32 s30, s30, s34
    s_mul_i32 s30, s30, s35
    s_mul_i32 s31, s31, 798720
    s_add_u32 s30, s30, s31
    s_add_u32 s66, s30, s53
    s_lshl_b32 s30, s39, 2
    s_add_u32 s30, s30, 3
    s_mul_i32 s31, s30, s33
    s_lshr_b32 s31, s31, 16
    s_mul_i32 s34, s31, s62
    s_sub_u32 s30, s30, s34
    s_mul_i32 s30, s30, s35
    s_mul_i32 s31, s31, 798720
    s_add_u32 s30, s30, s31
    s_add_u32 s67, s30, s53
    v_lshrrev_b32 v8, 3, v1
    v_mul_lo_u32 v30, v8, s60
    v_and_b32 v9, 7, v1
    v_lshl_add_u32 v30, v9, 4, v30
    s_mul_i32 s36, s27, 20480
    s_add_u32 s36, s36, 81920
    s_lshl_b32 s37, s60, 3
    s_mov_b32 s30, s61
    s_add_u32 m0, s36, 0
    s_nop 0
    buffer_load_dwordx4 v30, s[56:59], s30 offen lds
    s_add_u32 s30, s30, s37
    s_add_u32 m0, s36, 1024
    s_nop 0
    buffer_load_dwordx4 v30, s[56:59], s30 offen lds
    s_add_u32 s30, s30, s37
    s_add_u32 m0, s36, 2048
    s_nop 0
    buffer_load_dwordx4 v30, s[56:59], s30 offen lds
    s_add_u32 s30, s30, s37
    s_add_u32 m0, s36, 3072
    s_nop 0
    buffer_load_dwordx4 v30, s[56:59], s30 offen lds
    s_add_u32 s30, s30, s37
    s_add_u32 m0, s36, 4096
    s_nop 0
    buffer_load_dwordx4 v30, s[56:59], s30 offen lds
    s_add_u32 s30, s30, s37
    s_add_u32 m0, s36, 5120
    s_nop 0
    buffer_load_dwordx4 v30, s[56:59], s30 offen lds
    s_add_u32 s30, s30, s37
    s_add_u32 m0, s36, 6144
    s_nop 0
    buffer_load_dwordx4 v30, s[56:59], s30 offen lds
    s_add_u32 s30, s30, s37
    s_add_u32 m0, s36, 7168
    s_nop 0
    buffer_load_dwordx4 v30, s[56:59], s30 offen lds
    s_add_u32 s30, s30, s37
    s_add_u32 m0, s36, 8192
    s_nop 0
    buffer_load_dwordx4 v30, s[56:59], s30 offen lds
    s_add_u32 s30, s30, s37
    s_add_u32 m0, s36, 9216
    s_nop 0
    buffer_load_dwordx4 v30, s[56:59], s30 offen lds
    s_add_u32 s30, s30, s37
    s_add_u32 m0, s36, 10240
    s_nop 0
    buffer_load_dwordx4 v30, s[56:59], s30 offen lds
    s_add_u32 s30, s30, s37
    s_add_u32 m0, s36, 11264
    s_nop 0
    buffer_load_dwordx4 v30, s[56:59], s30 offen lds
    s_add_u32 s30, s30, s37
    s_add_u32 m0, s36, 12288
    s_nop 0
    buffer_load_dwordx4 v30, s[56:59], s30 offen lds
    s_add_u32 s30, s30, s37
    s_add_u32 m0, s36, 13312
    s_nop 0
    buffer_load_dwordx4 v30, s[56:59], s30 offen lds
    s_add_u32 s30, s30, s37
    s_add_u32 m0, s36, 14336
    s_nop 0
    buffer_load_dwordx4 v30, s[56:59], s30 offen lds
    s_add_u32 s30, s30, s37
    s_add_u32 m0, s36, 15360
    s_nop 0
    buffer_load_dwordx4 v30, s[56:59], s30 offen lds
    s_add_u32 s30, s30, s37
    s_cmp_lg_u32 s63, 0
    s_cbranch_scc1 L_m_Hld
    s_add_u32 m0, s36, 16384
    s_nop 0
    buffer_load_dwordx4 v30, s[56:59], s30 offen lds
    s_add_u32 s30, s30, s37
    s_add_u32 m0, s36, 17408
    s_nop 0
    buffer_load_dwordx4 v30, s[56:59], s30 offen lds
    s_add_u32 s30, s30, s37
    s_add_u32 m0, s36, 18432
    s_nop 0
    buffer_load_dwordx4 v30, s[56:59], s30 offen lds
    s_add_u32 s30, s30, s37
    s_add_u32 m0, s36, 19456
    s_nop 0
    buffer_load_dwordx4 v30, s[56:59], s30 offen lds
    s_add_u32 s30, s30, s37
L_m_Hld:
    v_lshrrev_b32 v8, 2, v4
    v_lshlrev_b32 v8, 7, v8
    v_and_b32 v9, 3, v4
    v_lshl_add_u32 v8, v9, 3, v8
    v_add_u32 v8, s36, v8
    v_lshl_add_u32 v31, v3, 9, v8
    v_lshrrev_b32 v9, 1, v3
    v_mul_u32_u24 v9, 2560, v9
    v_and_b32 v10, 1, v3
    v_lshl_add_u32 v9, v10, 9, v9
    v_add_u32 v32, v8, v9
    v_mul_u32_u24 v9, 5120, v3
    v_add_u32 v33, v8, v9
    v_mov_b32 v36, 0x3f803f80
    v_mov_b32 v37, 0x3f803f80
    v_mov_b32 v38, 0x3f803f80
    v_mov_b32 v39, 0x3f803f80
    s_waitcnt vmcnt(0)
    s_cmp_lg_u32 s63, 0
    s_cbranch_scc1 L_m_Hr4
    s_cmp_lt_u32 s52, 40
    s_cbranch_scc1 L_m_Hro
    ds_read_b64_tr_b16 v[56:57], v31 offset:0
    ds_read_b64_tr_b16 v[58:59], v31 offset:2048
    ds_read_b64_tr_b16 v[60:61], v31 offset:32
    ds_read_b64_tr_b16 v[62:63], v31 offset:2080
    ds_read_b64_tr_b16 v[64:65], v31 offset:64
    ds_read_b64_tr_b16 v[66:67], v31 offset:2112
    ds_read_b64_tr_b16 v[68:69], v31 offset:96
    ds_read_b64_tr_b16 v[70:71], v31 offset:2144
    s_waitcnt lgkmcnt(0)
    ds_read_b64_tr_b16 v[72:73], v31 offset:4096
    ds_read_b64_tr_b16 v[74:75], v31 offset:6144
    ds_read_b64_tr_b16 v[76:77], v31 offset:4128
    ds_read_b64_tr_b16 v[78:79], v31 offset:6176
    ds_read_b64_tr_b16 v[80:81], v31 offset:4160
    ds_read_b64_tr_b16 v[82:83], v31 offset:6208
    ds_read_b64_tr_b16 v[84:85], v31 offset:4192
    ds_read_b64_tr_b16 v[86:87], v31 offset:6240
    s_waitcnt lgkmcnt(0)
    ds_read_b64_tr_b16 v[88:89], v31 offset:10240
    ds_read_b64_tr_b16 v[90:91], v31 offset:12288
    ds_read_b64_tr_b16 v[92:93], v31 offset:10272
    ds_read_b64_tr_b16 v[94:95], v31 offset:12320
    ds_read_b64_tr_b16 v[96:97], v31 offset:10304
    ds_read_b64_tr_b16 v[98:99], v31 offset:12352
    ds_read_b64_tr_b16 v[100:101], v31 offset:10336
    ds_read_b64_tr_b16 v[102:103], v31 offset:12384
    s_waitcnt lgkmcnt(0)
    ds_read_b64_tr_b16 v[104:105], v31 offset:14336
    ds_read_b64_tr_b16 v[106:107], v31 offset:16384
    ds_read_b64_tr_b16 v[108:109], v31 offset:14368
    ds_read_b64_tr_b16 v[110:111], v31 offset:16416
    ds_read_b64_tr_b16 v[112:113], v31 offset:14400
    ds_read_b64_tr_b16 v[114:115], v31 offset:16448
    ds_read_b64_tr_b16 v[116:117], v31 offset:14432
    ds_read_b64_tr_b16 v[118:119], v31 offset:16480
    s_waitcnt lgkmcnt(0)
    ds_read_b64_tr_b16 v[120:121], v31 offset:8192
    ds_read_b64_tr_b16 v[122:123], v31 offset:18432
    ds_read_b64_tr_b16 v[124:125], v31 offset:8224
    ds_read_b64_tr_b16 v[126:127], v31 offset:18464
    ds_read_b64_tr_b16 v[128:129], v31 offset:8256
    ds_read_b64_tr_b16 v[130:131], v31 offset:18496
    ds_read_b64_tr_b16 v[132:133], v31 offset:8288
    ds_read_b64_tr_b16 v[134:135], v31 offset:18528
    s_waitcnt lgkmcnt(0)
    s_branch L_m_Hrd
L_m_Hro:
    ds_read_b64_tr_b16 v[56:57], v32 offset:0
    ds_read_b64_tr_b16 v[58:59], v32 offset:1024
    ds_read_b64_tr_b16 v[60:61], v32 offset:32
    ds_read_b64_tr_b16 v[62:63], v32 offset:1056
    ds_read_b64_tr_b16 v[64:65], v32 offset:64
    ds_read_b64_tr_b16 v[66:67], v32 offset:1088
    ds_read_b64_tr_b16 v[68:69], v32 offset:96
    ds_read_b64_tr_b16 v[70:71], v32 offset:1120
    s_waitcnt lgkmcnt(0)
    ds_read_b64_tr_b16 v[72:73], v32 offset:5120
    ds_read_b64_tr_b16 v[74:75], v32 offset:6144
    ds_read_b64_tr_b16 v[76:77], v32 offset:5152
    ds_read_b64_tr_b16 v[78:79], v32 offset:6176
    ds_read_b64_tr_b16 v[80:81], v32 offset:5184
    ds_read_b64_tr_b16 v[82:83], v32 offset:6208
    ds_read_b64_tr_b16 v[84:85], v32 offset:5216
    ds_read_b64_tr_b16 v[86:87], v32 offset:6240
    s_waitcnt lgkmcnt(0)
    ds_read_b64_tr_b16 v[88:89], v32 offset:10240
    ds_read_b64_tr_b16 v[90:91], v32 offset:11264
    ds_read_b64_tr_b16 v[92:93], v32 offset:10272
    ds_read_b64_tr_b16 v[94:95], v32 offset:11296
    ds_read_b64_tr_b16 v[96:97], v32 offset:10304
    ds_read_b64_tr_b16 v[98:99], v32 offset:11328
    ds_read_b64_tr_b16 v[100:101], v32 offset:10336
    ds_read_b64_tr_b16 v[102:103], v32 offset:11360
    s_waitcnt lgkmcnt(0)
    ds_read_b64_tr_b16 v[104:105], v32 offset:15360
    ds_read_b64_tr_b16 v[106:107], v32 offset:16384
    ds_read_b64_tr_b16 v[108:109], v32 offset:15392
    ds_read_b64_tr_b16 v[110:111], v32 offset:16416
    ds_read_b64_tr_b16 v[112:113], v32 offset:15424
    ds_read_b64_tr_b16 v[114:115], v32 offset:16448
    ds_read_b64_tr_b16 v[116:117], v32 offset:15456
    ds_read_b64_tr_b16 v[118:119], v32 offset:16480
    s_waitcnt lgkmcnt(0)
    ds_read_b64_tr_b16 v[120:121], v33 offset:2048
    ds_read_b64_tr_b16 v[122:123], v33 offset:4608
    ds_read_b64_tr_b16 v[124:125], v33 offset:2080
    ds_read_b64_tr_b16 v[126:127], v33 offset:4640
    ds_read_b64_tr_b16 v[128:129], v33 offset:2112
    ds_read_b64_tr_b16 v[130:131], v33 offset:4672
    ds_read_b64_tr_b16 v[132:133], v33 offset:2144
    ds_read_b64_tr_b16 v[134:135], v33 offset:4704
    s_waitcnt lgkmcnt(0)
    s_branch L_m_Hrd
L_m_Hr4:
    ds_read_b64_tr_b16 v[56:57], v31 offset:0
    ds_read_b64_tr_b16 v[58:59], v31 offset:2048
    ds_read_b64_tr_b16 v[60:61], v31 offset:32
    ds_read_b64_tr_b16 v[62:63], v31 offset:2080
    ds_read_b64_tr_b16 v[64:65], v31 offset:64
    ds_read_b64_tr_b16 v[66:67], v31 offset:2112
    ds_read_b64_tr_b16 v[68:69], v31 offset:96
    ds_read_b64_tr_b16 v[70:71], v31 offset:2144
    s_waitcnt lgkmcnt(0)
    ds_read_b64_tr_b16 v[72:73], v31 offset:4096
    ds_read_b64_tr_b16 v[74:75], v31 offset:6144
    ds_read_b64_tr_b16 v[76:77], v31 offset:4128
    ds_read_b64_tr_b16 v[78:79], v31 offset:6176
    ds_read_b64_tr_b16 v[80:81], v31 offset:4160
    ds_read_b64_tr_b16 v[82:83], v31 offset:6208
    ds_read_b64_tr_b16 v[84:85], v31 offset:4192
    ds_read_b64_tr_b16 v[86:87], v31 offset:6240
    s_waitcnt lgkmcnt(0)
    ds_read_b64_tr_b16 v[88:89], v31 offset:8192
    ds_read_b64_tr_b16 v[90:91], v31 offset:10240
    ds_read_b64_tr_b16 v[92:93], v31 offset:8224
    ds_read_b64_tr_b16 v[94:95], v31 offset:10272
    ds_read_b64_tr_b16 v[96:97], v31 offset:8256
    ds_read_b64_tr_b16 v[98:99], v31 offset:10304
    ds_read_b64_tr_b16 v[100:101], v31 offset:8288
    ds_read_b64_tr_b16 v[102:103], v31 offset:10336
    s_waitcnt lgkmcnt(0)
    ds_read_b64_tr_b16 v[104:105], v31 offset:12288
    ds_read_b64_tr_b16 v[106:107], v31 offset:14336
    ds_read_b64_tr_b16 v[108:109], v31 offset:12320
    ds_read_b64_tr_b16 v[110:111], v31 offset:14368
    ds_read_b64_tr_b16 v[112:113], v31 offset:12352
    ds_read_b64_tr_b16 v[114:115], v31 offset:14400
    ds_read_b64_tr_b16 v[116:117], v31 offset:12384
    ds_read_b64_tr_b16 v[118:119], v31 offset:14432
    s_waitcnt lgkmcnt(0)
L_m_Hrd:
    buffer_store_dwordx4 v[56:59], v2, s[20:23], s64 offen offset:0 sc1
    buffer_store_dwordx4 v[60:63], v2, s[20:23], s65 offen offset:0 sc1
    buffer_store_dwordx4 v[64:67], v2, s[20:23], s66 offen offset:0 sc1
    buffer_store_dwordx4 v[68:71], v2, s[20:23], s67 offen offset:0 sc1
    buffer_store_dwordx4 v[72:75], v2, s[20:23], s64 offen offset:1024 sc1
    buffer_store_dwordx4 v[76:79], v2, s[20:23], s65 offen offset:1024 sc1
    buffer_store_dwordx4 v[80:83], v2, s[20:23], s66 offen offset:1024 sc1
    buffer_store_dwordx4 v[84:87], v2, s[20:23], s67 offen offset:1024 sc1
    buffer_store_dwordx4 v[88:91], v2, s[20:23], s64 offen offset:2048 sc1
    buffer_store_dwordx4 v[92:95], v2, s[20:23], s65 offen offset:2048 sc1
    buffer_store_dwordx4 v[96:99], v2, s[20:23], s66 offen offset:2048 sc1
    buffer_store_dwordx4 v[100:103], v2, s[20:23], s67 offen offset:2048 sc1
    buffer_store_dwordx4 v[104:107], v2, s[20:23], s64 offen offset:3072 sc1
    buffer_store_dwordx4 v[108:111], v2, s[20:23], s65 offen offset:3072 sc1
    buffer_store_dwordx4 v[112:115], v2, s[20:23], s66 offen offset:3072 sc1
    buffer_store_dwordx4 v[116:119], v2, s[20:23], s67 offen offset:3072 sc1
    s_cmp_lg_u32 s63, 0
    s_cbranch_scc1 L_m_Hst
    s_add_u32 s64, s64, 4096
    buffer_store_dwordx4 v[120:123], v2, s[20:23], s64 offen offset:0 sc1
    s_add_u32 s65, s65, 4096
    buffer_store_dwordx4 v[124:127], v2, s[20:23], s65 offen offset:0 sc1
    s_add_u32 s66, s66, 4096
    buffer_store_dwordx4 v[128:131], v2, s[20:23], s66 offen offset:0 sc1
    s_add_u32 s67, s67, 4096
    buffer_store_dwordx4 v[132:135], v2, s[20:23], s67 offen offset:0 sc1
    s_cmp_eq_u32 s55, -1
    s_cbranch_scc1 L_m_Hst
    v_mfma_f32_16x16x32_bf16 v[40:43], v[56:59], v[36:39], 0
    v_mfma_f32_16x16x32_bf16 v[44:47], v[60:63], v[36:39], 0
    v_mfma_f32_16x16x32_bf16 v[48:51], v[64:67], v[36:39], 0
    v_mfma_f32_16x16x32_bf16 v[52:55], v[68:71], v[36:39], 0
    v_mfma_f32_16x16x32_bf16 v[40:43], v[72:75], v[36:39], v[40:43]
    v_mfma_f32_16x16x32_bf16 v[44:47], v[76:79], v[36:39], v[44:47]
    v_mfma_f32_16x16x32_bf16 v[48:51], v[80:83], v[36:39], v[48:51]
    v_mfma_f32_16x16x32_bf16 v[52:55], v[84:87], v[36:39], v[52:55]
    v_mfma_f32_16x16x32_bf16 v[40:43], v[88:91], v[36:39], v[40:43]
    v_mfma_f32_16x16x32_bf16 v[44:47], v[92:95], v[36:39], v[44:47]
    v_mfma_f32_16x16x32_bf16 v[48:51], v[96:99], v[36:39], v[48:51]
    v_mfma_f32_16x16x32_bf16 v[52:55], v[100:103], v[36:39], v[52:55]
    v_mfma_f32_16x16x32_bf16 v[40:43], v[104:107], v[36:39], v[40:43]
    v_mfma_f32_16x16x32_bf16 v[44:47], v[108:111], v[36:39], v[44:47]
    v_mfma_f32_16x16x32_bf16 v[48:51], v[112:115], v[36:39], v[48:51]
    v_mfma_f32_16x16x32_bf16 v[52:55], v[116:119], v[36:39], v[52:55]
    v_mfma_f32_16x16x32_bf16 v[40:43], v[120:123], v[36:39], v[40:43]
    v_mfma_f32_16x16x32_bf16 v[44:47], v[124:127], v[36:39], v[44:47]
    v_mfma_f32_16x16x32_bf16 v[48:51], v[128:131], v[36:39], v[48:51]
    v_mfma_f32_16x16x32_bf16 v[52:55], v[132:135], v[36:39], v[52:55]
    s_mul_i32 s30, s38, 2176
    s_add_u32 s30, s30, s55
    s_lshl_b32 s31, s39, 6
    s_add_u32 s30, s30, s31
    s_lshl_b32 s30, s30, 2
    s_add_u32 s30, s30, 32342016
    v_lshlrev_b32 v8, 4, v3
    s_mov_b32 s40, 0x00010001
    s_mov_b32 s41, 0x00010001
    s_nop 3
    s_mov_b64 exec, s[40:41]
    buffer_store_dwordx4 v[40:43], v8, s[20:23], s30 offen offset:0 sc1
    buffer_store_dwordx4 v[44:47], v8, s[20:23], s30 offen offset:64 sc1
    buffer_store_dwordx4 v[48:51], v8, s[20:23], s30 offen offset:128 sc1
    buffer_store_dwordx4 v[52:55], v8, s[20:23], s30 offen offset:192 sc1
    s_mov_b64 exec, -1
L_m_Hst:
    s_waitcnt vmcnt(0)
    s_lshl_b32 s30, s52, 7
    s_add_u32 s30, s30, 32676992
    s_mov_b64 exec, 1
    buffer_store_dword v6, off, s[20:23], s30 sc1
L_m_Hsig:
    s_mov_b64 exec, -1
L_m_Hwait:
    s_mul_i32 s30, s25, 80
    s_lshr_b32 s30, s30, 6
    v_lshrrev_b32 v8, 1, v1
    v_mul_u32_u24 v8, 10, v8
    v_and_b32 v9, 1, v1
    v_add3_u32 v8, v8, v9, s30
    v_cmp_le_u32 vcc, 24, v1
    v_add_u32 v9, 96, v8
    v_and_b32 v10, 3, v1
    v_cndmask_b32 v8, v8, v9, vcc
    v_mul_u32_u24 v10, 24, v10
    v_bfe_u32 v9, v1, 2, 2
    s_mul_i32 s30, s25, 3
    s_add_u32 s30, s30, 120
    v_cmp_le_u32 vcc, 48, v1
    v_add3_u32 v9, v9, v10, s30
    s_mov_b32 s30, 32676992
    v_cndmask_b32 v8, v8, v9, vcc
    v_lshlrev_b32 v14, 7, v8
    s_mov_b32 s40, -1
    s_mov_b32 s41, 0x0fffffff
    s_mov_b32 s58, 400000
    s_mov_b64 exec, s[40:41]
L_m_poll_uf:
    s_sleep 16
    buffer_load_dword v15, v14, s[20:23], s30 offen sc1
    s_sub_u32 s58, s58, 1
    s_waitcnt vmcnt(0)
    v_cmp_gt_u32 vcc, 1, v15
    s_cmp_eq_u32 s58, 0
    s_cbranch_scc1 L_m_poll_uf_x
    s_cbranch_vccnz L_m_poll_uf
L_m_poll_uf_x:
    s_mov_b64 exec, -1
L_m_Hpkx:
    s_cmp_ge_u32 s27, 2
    s_cbranch_scc1 L_m_Hfill
    s_cmp_eq_u32 s27, 1
    s_cbranch_scc1 L_m_H5
    s_mul_i32 s30, s25, 80
    s_mul_i32 s31, s25, 192
    s_add_u32 s31, s31, 560
    v_add_u32 v8, 0, v1
    v_cmp_gt_u32 vcc, 80, v8
    v_add_u32 v9, s30, v8
    v_add_u32 v10, s31, v8
    v_cndmask_b32 v9, v10, v9, vcc
    v_min_u32 v9, 2175, v9
    v_lshlrev_b32 v9, 2, v9
    s_mov_b32 s33, 32342016
    buffer_load_dword v176, v9, s[20:23], s33 offen sc1
    s_mov_b32 s33, 32350720
    buffer_load_dword v177, v9, s[20:23], s33 offen sc1
    s_mov_b32 s33, 32359424
    buffer_load_dword v178, v9, s[20:23], s33 offen sc1
    s_mov_b32 s33, 32368128
    buffer_load_dword v179, v9, s[20:23], s33 offen sc1
    v_add_u32 v8, 64, v1
    v_cmp_gt_u32 vcc, 80, v8
    v_add_u32 v9, s30, v8
    v_add_u32 v10, s31, v8
    v_cndmask_b32 v9, v10, v9, vcc
    v_min_u32 v9, 2175, v9
    v_lshlrev_b32 v9, 2, v9
    s_mov_b32 s33, 32342016
    buffer_load_dword v180, v9, s[20:23], s33 offen sc1
    s_mov_b32 s33, 32350720
    buffer_load_dword v181, v9, s[20:23], s33 offen sc1
    s_mov_b32 s33, 32359424
    buffer_load_dword v182, v9, s[20:23], s33 offen sc1
    s_mov_b32 s33, 32368128
    buffer_load_dword v183, v9, s[20:23], s33 offen sc1
    v_add_u32 v8, 128, v1
    v_cmp_gt_u32 vcc, 80, v8
    v_add_u32 v9, s30, v8
    v_add_u32 v10, s31, v8
    v_cndmask_b32 v9, v10, v9, vcc
    v_min_u32 v9, 2175, v9
    v_lshlrev_b32 v9, 2, v9
    s_mov_b32 s33, 32342016
    buffer_load_dword v184, v9, s[20:23], s33 offen sc1
    s_mov_b32 s33, 32350720
    buffer_load_dword v185, v9, s[20:23], s33 offen sc1
    s_mov_b32 s33, 32359424
    buffer_load_dword v186, v9, s[20:23], s33 offen sc1
    s_mov_b32 s33, 32368128
    buffer_load_dword v187, v9, s[20:23], s33 offen sc1
    v_add_u32 v8, 192, v1
    v_cmp_gt_u32 vcc, 80, v8
    v_add_u32 v9, s30, v8
    v_add_u32 v10, s31, v8
    v_cndmask_b32 v9, v10, v9, vcc
    v_min_u32 v9, 2175, v9
    v_lshlrev_b32 v9, 2, v9
    s_mov_b32 s33, 32342016
    buffer_load_dword v188, v9, s[20:23], s33 offen sc1
    s_mov_b32 s33, 32350720
    buffer_load_dword v189, v9, s[20:23], s33 offen sc1
    s_mov_b32 s33, 32359424
    buffer_load_dword v190, v9, s[20:23], s33 offen sc1
    s_mov_b32 s33, 32368128
    buffer_load_dword v191, v9, s[20:23], s33 offen sc1
    v_add_u32 v8, 256, v1
    v_cmp_gt_u32 vcc, 80, v8
    v_add_u32 v9, s30, v8
    v_add_u32 v10, s31, v8
    v_cndmask_b32 v9, v10, v9, vcc
    v_min_u32 v9, 2175, v9
    v_lshlrev_b32 v9, 2, v9
    s_mov_b32 s33, 32342016
    buffer_load_dword v192, v9, s[20:23], s33 offen sc1
    s_mov_b32 s33, 32350720
    buffer_load_dword v193, v9, s[20:23], s33 offen sc1
    s_mov_b32 s33, 32359424
    buffer_load_dword v194, v9, s[20:23], s33 offen sc1
    s_mov_b32 s33, 32368128
    buffer_load_dword v195, v9, s[20:23], s33 offen sc1
    s_branch L_m_Hfill
L_m_H5:
    v_lshrrev_b32 v8, 3, v1
    v_cmp_eq_u32 vcc, 1, v8
    v_lshrrev_b32 v9, 1, v8
    v_mov_b32 v10, -1
    v_cndmask_b32 v9, v9, v10, vcc
    v_add_u32 v9, s24, v9
    v_and_b32 v9, 31, v9
    v_lshrrev_b32 v10, 2, v9
    v_and_b32 v9, 3, v9
    v_lshl_add_u32 v9, v9, 3, v10
    v_and_b32 v10, 7, v1
    v_lshl_add_u32 v9, v10, 5, v9
    v_lshlrev_b32 v11, 2, v9
    s_mov_b32 s30, 32595968
    s_mov_b32 s58, 400000
    s_mov_b64 exec, 0xffffff
L_m_poll_xt:
    s_sleep 4
    buffer_load_dword v176, v11, s[20:23], s30 offen sc1
    s_sub_u32 s58, s58, 1
    s_waitcnt vmcnt(0)
    v_cmp_gt_u32 vcc, 1, v176
    s_cmp_eq_u32 s58, 0
    s_cbranch_scc1 L_m_poll_xt_x
    s_cbranch_vccnz L_m_poll_xt
L_m_poll_xt_x:
    s_mov_b64 exec, -1
    s_mov_b32 s52, s4
    s_mov_b32 s53, s5
    s_mov_b32 s54, 2621440
    s_mov_b32 s55, 0x20000
    s_mul_i32 s30, s24, 81920
    s_mul_i32 s31, s25, 160
    s_add_u32 s33, s30, s31
    v_add_u32 v8, 0, v1
    v_mul_u32_u24 v9, 6554, v8
    v_lshrrev_b32 v9, 16, v9
    v_mul_u32_u24 v9, 1120, v9
    s_mov_b32 m0, 152064
    v_lshl_add_u32 v9, v8, 4, v9
    buffer_load_dwordx4 v9, s[52:55], s33 offen lds
    v_add_u32 v8, 64, v1
    v_mul_u32_u24 v9, 6554, v8
    v_lshrrev_b32 v9, 16, v9
    v_mul_u32_u24 v9, 1120, v9
    s_mov_b32 m0, 153088
    v_lshl_add_u32 v9, v8, 4, v9
    buffer_load_dwordx4 v9, s[52:55], s33 offen lds
    v_add_u32 v8, 128, v1
    v_mul_u32_u24 v9, 6554, v8
    v_lshrrev_b32 v9, 16, v9
    v_mul_u32_u24 v9, 1120, v9
    s_mov_b32 m0, 154112
    v_lshl_add_u32 v9, v8, 4, v9
    buffer_load_dwordx4 v9, s[52:55], s33 offen lds
    v_add_u32 v8, 192, v1
    v_mul_u32_u24 v9, 6554, v8
    v_lshrrev_b32 v9, 16, v9
    v_mul_u32_u24 v9, 1120, v9
    s_mov_b32 m0, 155136
    v_lshl_add_u32 v9, v8, 4, v9
    buffer_load_dwordx4 v9, s[52:55], s33 offen lds
    v_add_u32 v8, 256, v1
    v_mul_u32_u24 v9, 6554, v8
    v_lshrrev_b32 v9, 16, v9
    v_mul_u32_u24 v9, 1120, v9
    s_mov_b32 m0, 156160
    v_lshl_add_u32 v9, v8, 4, v9
    buffer_load_dwordx4 v9, s[52:55], s33 offen lds
    v_add_u32 v8, 320, v1
    v_mul_u32_u24 v9, 6554, v8
    v_lshrrev_b32 v9, 16, v9
    v_mul_u32_u24 v9, 1120, v9
    s_mov_b32 m0, 157184
    v_lshl_add_u32 v9, v8, 4, v9
    buffer_load_dwordx4 v9, s[52:55], s33 offen lds
    v_add_u32 v8, 384, v1
    v_mul_u32_u24 v9, 6554, v8
    v_lshrrev_b32 v9, 16, v9
    v_mul_u32_u24 v9, 1120, v9
    s_mov_b32 m0, 158208
    v_lshl_add_u32 v9, v8, 4, v9
    buffer_load_dwordx4 v9, s[52:55], s33 offen lds
    v_add_u32 v8, 448, v1
    v_mul_u32_u24 v9, 6554, v8
    v_lshrrev_b32 v9, 16, v9
    v_mul_u32_u24 v9, 1120, v9
    s_mov_b32 m0, 159232
    v_lshl_add_u32 v9, v8, 4, v9
    buffer_load_dwordx4 v9, s[52:55], s33 offen lds
    v_add_u32 v8, 512, v1
    v_mul_u32_u24 v9, 6554, v8
    v_lshrrev_b32 v9, 16, v9
    v_mul_u32_u24 v9, 1120, v9
    s_mov_b32 m0, 160256
    v_lshl_add_u32 v9, v8, 4, v9
    buffer_load_dwordx4 v9, s[52:55], s33 offen lds
    v_add_u32 v8, 576, v1
    v_mul_u32_u24 v9, 6554, v8
    v_lshrrev_b32 v9, 16, v9
    v_mul_u32_u24 v9, 1120, v9
    s_mov_b32 m0, 161280
    v_lshl_add_u32 v9, v8, 4, v9
    buffer_load_dwordx4 v9, s[52:55], s33 offen lds
    s_branch L_m_Hfill
L_m_Hkv:
    s_sub_u32 s28, s27, 2
    s_mul_i32 s32, s28, 81920
    s_mul_i32 s64, s28, 40960
    s_lshl_b32 s30, s28, 2
    s_add_u32 s30, s30, 162304
    v_mov_b32 v12, s30
    s_lshl_b32 s30, s28, 3
    s_add_u32 s30, s30, 162320
    v_mov_b32 v13, s30
    s_mul_i32 s30, s24, 20
    v_bfe_u32 v8, v1, 3, 1
    v_mul_u32_u24 v8, 19, v8
    v_add_u32 v8, s30, v8
    v_lshrrev_b32 v8, 7, v8
    v_lshlrev_b32 v8, 11, v8
    v_and_b32 v9, 7, v1
    s_lshl_b32 s30, s28, 3
    v_add_u32 v9, s30, v9
    v_lshl_add_u32 v9, v9, 7, v8
    v_bfe_u32 v10, v1, 4, 1
    v_mul_u32_u24 v10, 10240, v10
    v_add_u32 v9, v9, v10
    v_add_u32 v9, 10240, v9
    s_lshl_b32 s33, s25, 1
    s_add_u32 s33, s33, s28
    s_lshl_b32 s30, s33, 7
    v_add_u32 v8, s30, v8
    v_cmp_gt_u32 vcc, 32, v1
    s_mov_b32 s34, 32611456
    s_nop 0
    v_cndmask_b32 v14, v8, v9, vcc
    s_mov_b32 s40, 0x01010101
    s_mov_b32 s41, 0x0101
L_m_hg:
    s_sleep 1
    ds_read_b32 v8, v5 offset:104
    s_waitcnt lgkmcnt(0)
    v_cmp_gt_u32 vcc, 4, v8
    s_cbranch_vccnz L_m_hg
    s_mov_b32 s58, 400000
    s_mov_b64 exec, s[40:41]
L_m_poll_k0:
    s_sleep 2
    buffer_load_dword v15, v14, s[20:23], s34 offen sc1
    s_sub_u32 s58, s58, 1
    s_waitcnt vmcnt(0)
    v_cmp_gt_u32 vcc, 1, v15
    s_cmp_eq_u32 s58, 0
    s_cbranch_scc1 L_m_poll_k0_x
    s_cbranch_vccnz L_m_poll_k0
L_m_poll_k0_x:
    s_mov_b64 exec, -1
    s_mul_i32 s31, s24, 245760
    s_add_u32 s16, s8, s31
    s_addc_u32 s17, s9, 0
    s_mul_i32 s33, s33, 5120
    s_mul_i32 s35, s28, 6144
    s_add_u32 m0, s35, 122880
    s_add_u32 s30, s33, 0
    buffer_load_dwordx4 v2, s[16:19], s30 offen offset:0 sc1 lds
    buffer_load_dwordx4 v2, s[16:19], s30 offen offset:1024 sc1 lds
    buffer_load_dwordx4 v2, s[16:19], s30 offen offset:2048 sc1 lds
    buffer_load_dwordx4 v2, s[16:19], s30 offen offset:3072 sc1 lds
    s_add_u32 m0, s35, 126976
    s_add_u32 s30, s33, 4096
    buffer_load_dwordx4 v2, s[16:19], s30 offen offset:0 sc1 lds
    s_add_u32 m0, s64, 0
    s_add_u32 s30, s32, 0
    buffer_load_dwordx4 v2, s[12:15], s30 offen offset:0 sc1 lds
    buffer_load_dwordx4 v2, s[12:15], s30 offen offset:1024 sc1 lds
    buffer_load_dwordx4 v2, s[12:15], s30 offen offset:2048 sc1 lds
    buffer_load_dwordx4 v2, s[12:15], s30 offen offset:3072 sc1 lds
    s_add_u32 m0, s64, 4096
    s_add_u32 s30, s32, 4096
    buffer_load_dwordx4 v2, s[12:15], s30 offen offset:0 sc1 lds
    buffer_load_dwordx4 v2, s[12:15], s30 offen offset:1024 sc1 lds
    buffer_load_dwordx4 v2, s[12:15], s30 offen offset:2048 sc1 lds
    buffer_load_dwordx4 v2, s[12:15], s30 offen offset:3072 sc1 lds
    s_add_u32 m0, s64, 8192
    s_add_u32 s30, s32, 8192
    buffer_load_dwordx4 v2, s[12:15], s30 offen offset:0 sc1 lds
    buffer_load_dwordx4 v2, s[12:15], s30 offen offset:1024 sc1 lds
    s_mov_b64 exec, 1
    s_waitcnt vmcnt(0)
    ds_add_u32 v5, v6 offset:100
    s_mov_b32 s40, -1
    s_mov_b32 s41, 0
    s_mov_b32 s58, 400000
    s_mov_b64 exec, s[40:41]
L_m_poll_k1:
    s_sleep 2
    buffer_load_dword v15, v14, s[20:23], s34 offen sc1
    s_sub_u32 s58, s58, 1
    s_waitcnt vmcnt(0)
    v_cmp_gt_u32 vcc, 1, v15
    s_cmp_eq_u32 s58, 0
    s_cbranch_scc1 L_m_poll_k1_x
    s_cbranch_vccnz L_m_poll_k1
L_m_poll_k1_x:
    s_mov_b64 exec, -1
    s_add_u32 m0, s64, 10240
    s_add_u32 s30, s32, 10240
    buffer_load_dwordx4 v2, s[12:15], s30 offen offset:0 sc1 lds
    buffer_load_dwordx4 v2, s[12:15], s30 offen offset:1024 sc1 lds
    buffer_load_dwordx4 v2, s[12:15], s30 offen offset:2048 sc1 lds
    buffer_load_dwordx4 v2, s[12:15], s30 offen offset:3072 sc1 lds
    s_add_u32 m0, s64, 14336
    s_add_u32 s30, s32, 14336
    buffer_load_dwordx4 v2, s[12:15], s30 offen offset:0 sc1 lds
    buffer_load_dwordx4 v2, s[12:15], s30 offen offset:1024 sc1 lds
    buffer_load_dwordx4 v2, s[12:15], s30 offen offset:2048 sc1 lds
    buffer_load_dwordx4 v2, s[12:15], s30 offen offset:3072 sc1 lds
    s_add_u32 m0, s64, 18432
    s_add_u32 s30, s32, 18432
    buffer_load_dwordx4 v2, s[12:15], s30 offen offset:0 sc1 lds
    buffer_load_dwordx4 v2, s[12:15], s30 offen offset:1024 sc1 lds
    s_add_u32 m0, s64, 20480
    s_add_u32 s30, s32, 20480
    buffer_load_dwordx4 v2, s[12:15], s30 offen offset:0 sc1 lds
    buffer_load_dwordx4 v2, s[12:15], s30 offen offset:1024 sc1 lds
    buffer_load_dwordx4 v2, s[12:15], s30 offen offset:2048 sc1 lds
    buffer_load_dwordx4 v2, s[12:15], s30 offen offset:3072 sc1 lds
    s_add_u32 m0, s64, 24576
    s_add_u32 s30, s32, 24576
    buffer_load_dwordx4 v2, s[12:15], s30 offen offset:0 sc1 lds
    buffer_load_dwordx4 v2, s[12:15], s30 offen offset:1024 sc1 lds
    buffer_load_dwordx4 v2, s[12:15], s30 offen offset:2048 sc1 lds
    buffer_load_dwordx4 v2, s[12:15], s30 offen offset:3072 sc1 lds
    s_add_u32 m0, s64, 28672
    s_add_u32 s30, s32, 28672
    buffer_load_dwordx4 v2, s[12:15], s30 offen offset:0 sc1 lds
    buffer_load_dwordx4 v2, s[12:15], s30 offen offset:1024 sc1 lds
    s_add_u32 m0, s64, 30720
    s_add_u32 s30, s32, 30720
    buffer_load_dwordx4 v2, s[12:15], s30 offen offset:0 sc1 lds
    buffer_load_dwordx4 v2, s[12:15], s30 offen offset:1024 sc1 lds
    buffer_load_dwordx4 v2, s[12:15], s30 offen offset:2048 sc1 lds
    buffer_load_dwordx4 v2, s[12:15], s30 offen offset:3072 sc1 lds
    s_add_u32 m0, s64, 34816
    s_add_u32 s30, s32, 34816
    buffer_load_dwordx4 v2, s[12:15], s30 offen offset:0 sc1 lds
    buffer_load_dwordx4 v2, s[12:15], s30 offen offset:1024 sc1 lds
    buffer_load_dwordx4 v2, s[12:15], s30 offen offset:2048 sc1 lds
    buffer_load_dwordx4 v2, s[12:15], s30 offen offset:3072 sc1 lds
    s_add_u32 m0, s64, 38912
    s_add_u32 s30, s32, 38912
    buffer_load_dwordx4 v2, s[12:15], s30 offen offset:0 sc1 lds
    buffer_load_dwordx4 v2, s[12:15], s30 offen offset:1024 sc1 lds
    v_mov_b32 v8, 2
    s_waitcnt vmcnt(20)
    ds_write_b32 v12, v8
    v_mov_b32 v8, 3
    s_waitcnt vmcnt(10)
    ds_write_b32 v12, v8
    v_mov_b32 v8, 4
    s_waitcnt vmcnt(0)
    ds_write_b32 v12, v8
L_m_Hd4:
    s_sleep 4
    ds_read_b128 v[8:11], v5
    s_waitcnt lgkmcnt(0)
    v_min3_u32 v10, v8, v9, v10
    v_min_u32 v10, v10, v11
    s_nop 0
    v_readfirstlane_b32 s66, v10
    s_cmp_lt_u32 s66, 1
    s_cbranch_scc1 L_m_Hd4
    s_add_u32 m0, s64, 0
    s_add_u32 s30, s32, 40960
    buffer_load_dwordx4 v2, s[12:15], s30 offen offset:0 sc1 lds
    buffer_load_dwordx4 v2, s[12:15], s30 offen offset:1024 sc1 lds
    buffer_load_dwordx4 v2, s[12:15], s30 offen offset:2048 sc1 lds
    buffer_load_dwordx4 v2, s[12:15], s30 offen offset:3072 sc1 lds
    s_add_u32 m0, s64, 4096
    s_add_u32 s30, s32, 45056
    buffer_load_dwordx4 v2, s[12:15], s30 offen offset:0 sc1 lds
    buffer_load_dwordx4 v2, s[12:15], s30 offen offset:1024 sc1 lds
    buffer_load_dwordx4 v2, s[12:15], s30 offen offset:2048 sc1 lds
    buffer_load_dwordx4 v2, s[12:15], s30 offen offset:3072 sc1 lds
    s_add_u32 m0, s64, 8192
    s_add_u32 s30, s32, 49152
    buffer_load_dwordx4 v2, s[12:15], s30 offen offset:0 sc1 lds
    buffer_load_dwordx4 v2, s[12:15], s30 offen offset:1024 sc1 lds
    v_mov_b32 v8, 5
    s_waitcnt vmcnt(0)
    ds_write_b32 v12, v8
L_m_Hd5:
    s_sleep 4
    ds_read_b64 v[10:11], v13
    s_waitcnt lgkmcnt(0)
    v_min_u32 v10, v10, v11
    s_nop 0
    v_readfirstlane_b32 s66, v10
    s_cmp_lt_u32 s66, 2
    s_cbranch_scc1 L_m_Hd5
    s_add_u32 m0, s64, 10240
    s_add_u32 s30, s32, 51200
    buffer_load_dwordx4 v2, s[12:15], s30 offen offset:0 sc1 lds
    buffer_load_dwordx4 v2, s[12:15], s30 offen offset:1024 sc1 lds
    buffer_load_dwordx4 v2, s[12:15], s30 offen offset:2048 sc1 lds
    buffer_load_dwordx4 v2, s[12:15], s30 offen offset:3072 sc1 lds
    s_add_u32 m0, s64, 14336
    s_add_u32 s30, s32, 55296
    buffer_load_dwordx4 v2, s[12:15], s30 offen offset:0 sc1 lds
    buffer_load_dwordx4 v2, s[12:15], s30 offen offset:1024 sc1 lds
    buffer_load_dwordx4 v2, s[12:15], s30 offen offset:2048 sc1 lds
    buffer_load_dwordx4 v2, s[12:15], s30 offen offset:3072 sc1 lds
    s_add_u32 m0, s64, 18432
    s_add_u32 s30, s32, 59392
    buffer_load_dwordx4 v2, s[12:15], s30 offen offset:0 sc1 lds
    buffer_load_dwordx4 v2, s[12:15], s30 offen offset:1024 sc1 lds
    v_mov_b32 v8, 6
    s_waitcnt vmcnt(0)
    ds_write_b32 v12, v8
L_m_Hd6:
    s_sleep 4
    ds_read_b64 v[10:11], v13
    s_waitcnt lgkmcnt(0)
    v_min_u32 v10, v10, v11
    s_nop 0
    v_readfirstlane_b32 s66, v10
    s_cmp_lt_u32 s66, 3
    s_cbranch_scc1 L_m_Hd6
    s_add_u32 m0, s64, 20480
    s_add_u32 s30, s32, 61440
    buffer_load_dwordx4 v2, s[12:15], s30 offen offset:0 sc1 lds
    buffer_load_dwordx4 v2, s[12:15], s30 offen offset:1024 sc1 lds
    buffer_load_dwordx4 v2, s[12:15], s30 offen offset:2048 sc1 lds
    buffer_load_dwordx4 v2, s[12:15], s30 offen offset:3072 sc1 lds
    s_add_u32 m0, s64, 24576
    s_add_u32 s30, s32, 65536
    buffer_load_dwordx4 v2, s[12:15], s30 offen offset:0 sc1 lds
    buffer_load_dwordx4 v2, s[12:15], s30 offen offset:1024 sc1 lds
    buffer_load_dwordx4 v2, s[12:15], s30 offen offset:2048 sc1 lds
    buffer_load_dwordx4 v2, s[12:15], s30 offen offset:3072 sc1 lds
    s_add_u32 m0, s64, 28672
    s_add_u32 s30, s32, 69632
    buffer_load_dwordx4 v2, s[12:15], s30 offen offset:0 sc1 lds
    buffer_load_dwordx4 v2, s[12:15], s30 offen offset:1024 sc1 lds
    v_mov_b32 v8, 7
    s_waitcnt vmcnt(0)
    ds_write_b32 v12, v8
L_m_Hd7:
    s_sleep 4
    ds_read_b64 v[10:11], v13
    s_waitcnt lgkmcnt(0)
    v_min_u32 v10, v10, v11
    s_nop 0
    v_readfirstlane_b32 s66, v10
    s_cmp_lt_u32 s66, 4
    s_cbranch_scc1 L_m_Hd7
    s_add_u32 m0, s64, 30720
    s_add_u32 s30, s32, 71680
    buffer_load_dwordx4 v2, s[12:15], s30 offen offset:0 sc1 lds
    buffer_load_dwordx4 v2, s[12:15], s30 offen offset:1024 sc1 lds
    buffer_load_dwordx4 v2, s[12:15], s30 offen offset:2048 sc1 lds
    buffer_load_dwordx4 v2, s[12:15], s30 offen offset:3072 sc1 lds
    s_add_u32 m0, s64, 34816
    s_add_u32 s30, s32, 75776
    buffer_load_dwordx4 v2, s[12:15], s30 offen offset:0 sc1 lds
    buffer_load_dwordx4 v2, s[12:15], s30 offen offset:1024 sc1 lds
    buffer_load_dwordx4 v2, s[12:15], s30 offen offset:2048 sc1 lds
    buffer_load_dwordx4 v2, s[12:15], s30 offen offset:3072 sc1 lds
    s_add_u32 m0, s64, 38912
    s_add_u32 s30, s32, 79872
    buffer_load_dwordx4 v2, s[12:15], s30 offen offset:0 sc1 lds
    buffer_load_dwordx4 v2, s[12:15], s30 offen offset:1024 sc1 lds
    v_mov_b32 v8, 9
    s_waitcnt vmcnt(0)
    ds_write_b32 v12, v8
    s_cmp_eq_u32 s29, 0
    s_cbranch_scc1 L_m_Hwait
    s_branch L_m_Hlate
L_m_Hfill:
    s_mul_i32 s35, s25, 798720
    s_mul_i32 s30, s27, 20480
    s_add_u32 s35, s35, s30
    s_add_u32 s34, s35, 25833472
    s_add_u32 s30, s34, 0
    buffer_load_dwordx4 v[96:99], v2, s[20:23], s30 offen offset:0 sc1
    buffer_load_dwordx4 v[100:103], v2, s[20:23], s30 offen offset:1024 sc1
    buffer_load_dwordx4 v[104:107], v2, s[20:23], s30 offen offset:2048 sc1
    buffer_load_dwordx4 v[108:111], v2, s[20:23], s30 offen offset:3072 sc1
    s_add_u32 s30, s34, 4096
    buffer_load_dwordx4 v[112:115], v2, s[20:23], s30 offen offset:0 sc1
    buffer_load_dwordx4 v[116:119], v2, s[20:23], s30 offen offset:1024 sc1
    buffer_load_dwordx4 v[120:123], v2, s[20:23], s30 offen offset:2048 sc1
    buffer_load_dwordx4 v[124:127], v2, s[20:23], s30 offen offset:3072 sc1
    s_add_u32 s30, s34, 8192
    buffer_load_dwordx4 v[128:131], v2, s[20:23], s30 offen offset:0 sc1
    buffer_load_dwordx4 v[132:135], v2, s[20:23], s30 offen offset:1024 sc1
    buffer_load_dwordx4 v[136:139], v2, s[20:23], s30 offen offset:2048 sc1
    buffer_load_dwordx4 v[140:143], v2, s[20:23], s30 offen offset:3072 sc1
    s_add_u32 s30, s34, 12288
    buffer_load_dwordx4 v[144:147], v2, s[20:23], s30 offen offset:0 sc1
    buffer_load_dwordx4 v[148:151], v2, s[20:23], s30 offen offset:1024 sc1
    buffer_load_dwordx4 v[152:155], v2, s[20:23], s30 offen offset:2048 sc1
    buffer_load_dwordx4 v[156:159], v2, s[20:23], s30 offen offset:3072 sc1
    s_add_u32 s30, s34, 16384
    buffer_load_dwordx4 v[160:163], v2, s[20:23], s30 offen offset:0 sc1
    buffer_load_dwordx4 v[164:167], v2, s[20:23], s30 offen offset:1024 sc1
    buffer_load_dwordx4 v[168:171], v2, s[20:23], s30 offen offset:2048 sc1
    buffer_load_dwordx4 v[172:175], v2, s[20:23], s30 offen offset:3072 sc1
    s_add_u32 s34, s35, 25915392
    s_add_u32 s30, s34, 0
    buffer_load_dwordx4 v[16:19], v2, s[20:23], s30 offen offset:0 sc1
    buffer_load_dwordx4 v[20:23], v2, s[20:23], s30 offen offset:1024 sc1
    buffer_load_dwordx4 v[24:27], v2, s[20:23], s30 offen offset:2048 sc1
    buffer_load_dwordx4 v[28:31], v2, s[20:23], s30 offen offset:3072 sc1
    s_add_u32 s30, s34, 4096
    buffer_load_dwordx4 v[32:35], v2, s[20:23], s30 offen offset:0 sc1
    buffer_load_dwordx4 v[36:39], v2, s[20:23], s30 offen offset:1024 sc1
    buffer_load_dwordx4 v[40:43], v2, s[20:23], s30 offen offset:2048 sc1
    buffer_load_dwordx4 v[44:47], v2, s[20:23], s30 offen offset:3072 sc1
    s_add_u32 s30, s34, 8192
    buffer_load_dwordx4 v[48:51], v2, s[20:23], s30 offen offset:0 sc1
    buffer_load_dwordx4 v[52:55], v2, s[20:23], s30 offen offset:1024 sc1
    buffer_load_dwordx4 v[56:59], v2, s[20:23], s30 offen offset:2048 sc1
    buffer_load_dwordx4 v[60:63], v2, s[20:23], s30 offen offset:3072 sc1
    s_add_u32 s30, s34, 12288
    buffer_load_dwordx4 v[64:67], v2, s[20:23], s30 offen offset:0 sc1
    buffer_load_dwordx4 v[68:71], v2, s[20:23], s30 offen offset:1024 sc1
    buffer_load_dwordx4 v[72:75], v2, s[20:23], s30 offen offset:2048 sc1
    buffer_load_dwordx4 v[76:79], v2, s[20:23], s30 offen offset:3072 sc1
    s_add_u32 s30, s34, 16384
    buffer_load_dwordx4 v[80:83], v2, s[20:23], s30 offen offset:0 sc1
    buffer_load_dwordx4 v[84:87], v2, s[20:23], s30 offen offset:1024 sc1
    buffer_load_dwordx4 v[88:91], v2, s[20:23], s30 offen offset:2048 sc1
    buffer_load_dwordx4 v[92:95], v2, s[20:23], s30 offen offset:3072 sc1
    s_mul_i32 s30, s27, 20480
    s_add_u32 s35, s35, s30
    s_waitcnt vmcnt(40)
    s_cmp_ge_u32 s27, 2
    s_cbranch_scc1 L_m_Hf2
    s_cmp_eq_u32 s27, 1
    s_cbranch_scc1 L_m_Hf1
    v_lshlrev_b32 v8, 2, v1
    v_add_u32 v8, 162560, v8
    v_add_f32 v176, v176, v177
    v_add_f32 v178, v178, v179
    v_add_f32 v176, v176, v178
    ds_write_b32 v8, v176 offset:0
    v_add_f32 v180, v180, v181
    v_add_f32 v182, v182, v183
    v_add_f32 v180, v180, v182
    ds_write_b32 v8, v180 offset:256
    v_add_f32 v184, v184, v185
    v_add_f32 v186, v186, v187
    v_add_f32 v184, v184, v186
    ds_write_b32 v8, v184 offset:512
    v_add_f32 v188, v188, v189
    v_add_f32 v190, v190, v191
    v_add_f32 v188, v188, v190
    ds_write_b32 v8, v188 offset:768
    v_add_f32 v192, v192, v193
    v_add_f32 v194, v194, v195
    v_add_f32 v192, v192, v194
    ds_write_b32 v8, v192 offset:1024
    s_waitcnt lgkmcnt(0)
    s_branch L_m_Hf2
L_m_Hf1:
    s_getreg_b32 s30, hwreg(HW_REG_XCC_ID)
    s_and_b32 s30, s30, 15
    s_add_u32 s30, s30, 1
    v_cmp_ne_u32 vcc, s30, v176
    v_mov_b32 v9, 162368
    s_nop 0
    v_mov_b32 v8, vcc_lo
    ds_write_b32 v9, v8
L_m_Hf2:
    s_add_u32 s34, s35, 26017792
    s_add_u32 s30, s34, 0
    buffer_load_dwordx4 v[176:179], v2, s[20:23], s30 offen offset:0 sc1
    buffer_load_dwordx4 v[180:183], v2, s[20:23], s30 offen offset:1024 sc1
    buffer_load_dwordx4 v[184:187], v2, s[20:23], s30 offen offset:2048 sc1
    buffer_load_dwordx4 v[188:191], v2, s[20:23], s30 offen offset:3072 sc1
    s_add_u32 s30, s34, 4096
    buffer_load_dwordx4 v[192:195], v2, s[20:23], s30 offen offset:0 sc1
    buffer_load_dwordx4 v[196:199], v2, s[20:23], s30 offen offset:1024 sc1
    buffer_load_dwordx4 v[200:203], v2, s[20:23], s30 offen offset:2048 sc1
    buffer_load_dwordx4 v[204:207], v2, s[20:23], s30 offen offset:3072 sc1
    s_add_u32 s30, s34, 8192
    buffer_load_dwordx4 v[208:211], v2, s[20:23], s30 offen offset:0 sc1
    buffer_load_dwordx4 v[212:215], v2, s[20:23], s30 offen offset:1024 sc1
    buffer_load_dwordx4 v[216:219], v2, s[20:23], s30 offen offset:2048 sc1
    buffer_load_dwordx4 v[220:223], v2, s[20:23], s30 offen offset:3072 sc1
    s_add_u32 s30, s34, 12288
    buffer_load_dwordx4 v[224:227], v2, s[20:23], s30 offen offset:0 sc1
    buffer_load_dwordx4 v[228:231], v2, s[20:23], s30 offen offset:1024 sc1
    buffer_load_dwordx4 v[232:235], v2, s[20:23], s30 offen offset:2048 sc1
    buffer_load_dwordx4 v[236:239], v2, s[20:23], s30 offen offset:3072 sc1
    s_add_u32 s30, s34, 16384
    buffer_load_dwordx4 v[240:243], v2, s[20:23], s30 offen offset:0 sc1
    buffer_load_dwordx4 v[244:247], v2, s[20:23], s30 offen offset:1024 sc1
    buffer_load_dwordx4 v[248:251], v2, s[20:23], s30 offen offset:2048 sc1
    buffer_load_dwordx4 v[252:255], v2, s[20:23], s30 offen offset:3072 sc1
    s_cmp_ge_u32 s27, 2
    s_cbranch_scc1 L_m_Hf23
    s_mul_i32 s36, s27, 20480
    s_add_u32 s36, s36, 81920
    s_mul_i32 s33, s25, 798720
    s_mul_i32 s30, s27, 20480
    s_add_u32 s33, s33, s30
    s_waitcnt vmcnt(40)
    s_lshr_b32 s31, s24, 3
    s_mov_b32 s31, 0
    s_and_b32 s31, s31, 3
    s_mul_i32 s31, s31, 5120
    s_add_u32 s31, s31, s33
    s_add_u32 m0, s36, 0
    s_add_u32 s30, s31, 25690112
    buffer_load_dwordx4 v2, s[20:23], s30 offen offset:0 sc1 lds
    buffer_load_dwordx4 v2, s[20:23], s30 offen offset:1024 sc1 lds
    buffer_load_dwordx4 v2, s[20:23], s30 offen offset:2048 sc1 lds
    buffer_load_dwordx4 v2, s[20:23], s30 offen offset:3072 sc1 lds
    s_add_u32 m0, s36, 4096
    s_add_u32 s30, s31, 25694208
    buffer_load_dwordx4 v2, s[20:23], s30 offen offset:0 sc1 lds
    s_lshr_b32 s31, s24, 3
    s_mov_b32 s31, 1
    s_and_b32 s31, s31, 3
    s_mul_i32 s31, s31, 5120
    s_add_u32 s31, s31, s33
    s_add_u32 m0, s36, 5120
    s_add_u32 s30, s31, 25690112
    buffer_load_dwordx4 v2, s[20:23], s30 offen offset:0 sc1 lds
    buffer_load_dwordx4 v2, s[20:23], s30 offen offset:1024 sc1 lds
    buffer_load_dwordx4 v2, s[20:23], s30 offen offset:2048 sc1 lds
    buffer_load_dwordx4 v2, s[20:23], s30 offen offset:3072 sc1 lds
    s_add_u32 m0, s36, 9216
    s_add_u32 s30, s31, 25694208
    buffer_load_dwordx4 v2, s[20:23], s30 offen offset:0 sc1 lds
    s_lshr_b32 s31, s24, 3
    s_mov_b32 s31, 2
    s_and_b32 s31, s31, 3
    s_mul_i32 s31, s31, 5120
    s_add_u32 s31, s31, s33
    s_add_u32 m0, s36, 10240
    s_add_u32 s30, s31, 25690112
    buffer_load_dwordx4 v2, s[20:23], s30 offen offset:0 sc1 lds
    buffer_load_dwordx4 v2, s[20:23], s30 offen offset:1024 sc1 lds
    buffer_load_dwordx4 v2, s[20:23], s30 offen offset:2048 sc1 lds
    buffer_load_dwordx4 v2, s[20:23], s30 offen offset:3072 sc1 lds
    s_add_u32 m0, s36, 14336
    s_add_u32 s30, s31, 25694208
    buffer_load_dwordx4 v2, s[20:23], s30 offen offset:0 sc1 lds
    s_lshr_b32 s31, s24, 3
    s_mov_b32 s31, 3
    s_and_b32 s31, s31, 3
    s_mul_i32 s31, s31, 5120
    s_add_u32 s31, s31, s33
    s_add_u32 m0, s36, 15360
    s_add_u32 s30, s31, 25690112
    buffer_load_dwordx4 v2, s[20:23], s30 offen offset:0 sc1 lds
    buffer_load_dwordx4 v2, s[20:23], s30 offen offset:1024 sc1 lds
    buffer_load_dwordx4 v2, s[20:23], s30 offen offset:2048 sc1 lds
    buffer_load_dwordx4 v2, s[20:23], s30 offen offset:3072 sc1 lds
    s_add_u32 m0, s36, 19456
    s_add_u32 s30, s31, 25694208
    buffer_load_dwordx4 v2, s[20:23], s30 offen offset:0 sc1 lds
    s_waitcnt vmcnt(0)
    s_branch L_m_HB1
L_m_Hf23:
    s_cmp_eq_u32 s27, 3
    s_cbranch_scc1 L_m_Ht7
    s_getpc_b64 s[52:53]
L_m_pc:
    s_sub_u32 s52, s52, L_m_pc-L_m_attok
    s_subb_u32 s53, s53, 0
    s_mov_b32 s54, L_m_last-L_m_attok
    s_mov_b32 s55, 0x20000
    s_lshr_b32 s30, s2, 3
    s_lshl_b32 s30, s30, 10
    s_mov_b32 m0, 147456
    s_waitcnt vmcnt(30)
    buffer_load_dwordx4 v2, s[52:55], s30 offen lds
    s_add_u32 s30, s30, 32768
    buffer_load_dwordx4 v2, s[52:55], s30 offen lds
    s_branch L_m_Hlate
L_m_Ht7:
    s_waitcnt vmcnt(30)
    s_mov_b32 m0, 147456
    s_mul_i32 s30, s24, 245760
    s_mul_i32 s31, s25, 10240
    s_add_u32 s30, s30, s31
    s_add_u32 s31, s30, 0
    buffer_load_dwordx4 v2, s[20:23], s31 offen offset:0 sc1 lds
    buffer_load_dwordx4 v2, s[20:23], s31 offen offset:1024 sc1 lds
    buffer_load_dwordx4 v2, s[20:23], s31 offen offset:2048 sc1 lds
    buffer_load_dwordx4 v2, s[20:23], s31 offen offset:3072 sc1 lds
    s_add_u32 s31, s30, 4096
    buffer_load_dwordx4 v2, s[20:23], s31 offen offset:0 sc1 lds
    buffer_load_dwordx4 v2, s[20:23], s31 offen offset:1024 sc1 lds
    buffer_load_dwordx4 v2, s[20:23], s31 offen offset:2048 sc1 lds
    buffer_load_dwordx4 v2, s[20:23], s31 offen offset:3072 sc1 lds
    s_add_u32 s31, s30, 8192
    buffer_load_dwordx4 v2, s[20:23], s31 offen offset:0 sc1 lds
    buffer_load_dwordx4 v2, s[20:23], s31 offen offset:1024 sc1 lds
    s_mul_i32 s30, s24, 245760
    s_mul_i32 s31, s25, 10240
    s_add_u32 s30, s30, s31
    s_add_u32 s31, s30, 81920
    buffer_load_dwordx4 v2, s[20:23], s31 offen offset:0 sc1 lds
    buffer_load_dwordx4 v2, s[20:23], s31 offen offset:1024 sc1 lds
    buffer_load_dwordx4 v2, s[20:23], s31 offen offset:2048 sc1 lds
    buffer_load_dwordx4 v2, s[20:23], s31 offen offset:3072 sc1 lds
    s_add_u32 s31, s30, 86016
    buffer_load_dwordx4 v2, s[20:23], s31 offen offset:0 sc1 lds
    buffer_load_dwordx4 v2, s[20:23], s31 offen offset:1024 sc1 lds
    buffer_load_dwordx4 v2, s[20:23], s31 offen offset:2048 sc1 lds
    buffer_load_dwordx4 v2, s[20:23], s31 offen offset:3072 sc1 lds
    s_add_u32 s31, s30, 90112
    buffer_load_dwordx4 v2, s[20:23], s31 offen offset:0 sc1 lds
    buffer_load_dwordx4 v2, s[20:23], s31 offen offset:1024 sc1 lds
    s_lshr_b32 s30, s24, 2
    s_mul_i32 s30, s30, 20480
    s_and_b32 s31, s24, 3
    s_lshl_b32 s31, s31, 3
    s_add_u32 s31, s31, s25
    s_min_u32 s31, s31, 19
    s_lshl_b32 s31, s31, 10
    s_add_u32 s30, s30, s31
    s_add_u32 s30, s30, 33071104
    buffer_load_dwordx4 v2, s[20:23], s30 offen sc1 lds
    s_lshl_b32 s30, s24, 8
    s_add_u32 s30, s30, 32603264
    v_lshlrev_b32 v8, 2, v1
    buffer_load_dword v14, v8, s[20:23], s30 offen sc1
    s_lshl_b32 s30, s24, 12
    s_and_b32 s31, s25, 3
    s_lshl_b32 s31, s31, 10
    s_add_u32 s30, s30, s31
    s_lshr_b32 s31, s25, 2
    s_mul_i32 s31, s31, 131072
    s_add_u32 s30, s30, s31
    s_add_u32 s30, s30, 32079872
    buffer_load_dwordx4 v2, s[20:23], s30 offen sc1 lds
    s_lshl_b32 s30, s24, 9
    s_add_u32 s30, s30, 32530432
    v_lshlrev_b32 v8, 14, v3
    v_lshl_add_u32 v8, v4, 5, v8
    buffer_load_dword v9, v8, s[20:23], s30 offen sc1
L_m_Hlate:
    s_sleep 4
    ds_read_b64 v[10:11], v13
    s_waitcnt lgkmcnt(0)
    v_min_u32 v10, v10, v11
    s_nop 0
    v_readfirstlane_b32 s30, v10
    s_cmp_lt_u32 s30, 6
    s_cbranch_scc1 L_m_Hlate
    s_mul_i32 s33, s25, 798720
    s_mul_i32 s30, s27, 20480
    s_add_u32 s33, s33, s30
    s_waitcnt vmcnt(40)
    s_lshr_b32 s31, s24, 3
    s_mov_b32 s31, 0
    s_and_b32 s31, s31, 3
    s_mul_i32 s31, s31, 5120
    s_add_u32 s31, s31, s33
    s_add_u32 m0, s64, 0
    s_add_u32 s30, s31, 25690112
    buffer_load_dwordx4 v2, s[20:23], s30 offen offset:0 sc1 lds
    buffer_load_dwordx4 v2, s[20:23], s30 offen offset:1024 sc1 lds
    buffer_load_dwordx4 v2, s[20:23], s30 offen offset:2048 sc1 lds
    buffer_load_dwordx4 v2, s[20:23], s30 offen offset:3072 sc1 lds
    s_add_u32 m0, s64, 4096
    s_add_u32 s30, s31, 25694208
    buffer_load_dwordx4 v2, s[20:23], s30 offen offset:0 sc1 lds
    s_lshr_b32 s31, s24, 3
    s_mov_b32 s31, 1
    s_and_b32 s31, s31, 3
    s_mul_i32 s31, s31, 5120
    s_add_u32 s31, s31, s33
    s_add_u32 m0, s64, 5120
    s_add_u32 s30, s31, 25690112
    buffer_load_dwordx4 v2, s[20:23], s30 offen offset:0 sc1 lds
    buffer_load_dwordx4 v2, s[20:23], s30 offen offset:1024 sc1 lds
    buffer_load_dwordx4 v2, s[20:23], s30 offen offset:2048 sc1 lds
    buffer_load_dwordx4 v2, s[20:23], s30 offen offset:3072 sc1 lds
    s_add_u32 m0, s64, 9216
    s_add_u32 s30, s31, 25694208
    buffer_load_dwordx4 v2, s[20:23], s30 offen offset:0 sc1 lds
    s_lshr_b32 s31, s24, 3
    s_mov_b32 s31, 2
    s_and_b32 s31, s31, 3
    s_mul_i32 s31, s31, 5120
    s_add_u32 s31, s31, s33
    s_add_u32 m0, s64, 10240
    s_add_u32 s30, s31, 25690112
    buffer_load_dwordx4 v2, s[20:23], s30 offen offset:0 sc1 lds
    buffer_load_dwordx4 v2, s[20:23], s30 offen offset:1024 sc1 lds
    buffer_load_dwordx4 v2, s[20:23], s30 offen offset:2048 sc1 lds
    buffer_load_dwordx4 v2, s[20:23], s30 offen offset:3072 sc1 lds
    s_add_u32 m0, s64, 14336
    s_add_u32 s30, s31, 25694208
    buffer_load_dwordx4 v2, s[20:23], s30 offen offset:0 sc1 lds
    s_lshr_b32 s31, s24, 3
    s_mov_b32 s31, 3
    s_and_b32 s31, s31, 3
    s_mul_i32 s31, s31, 5120
    s_add_u32 s31, s31, s33
    s_add_u32 m0, s64, 15360
    s_add_u32 s30, s31, 25690112
    buffer_load_dwordx4 v2, s[20:23], s30 offen offset:0 sc1 lds
    buffer_load_dwordx4 v2, s[20:23], s30 offen offset:1024 sc1 lds
    buffer_load_dwordx4 v2, s[20:23], s30 offen offset:2048 sc1 lds
    buffer_load_dwordx4 v2, s[20:23], s30 offen offset:3072 sc1 lds
    s_add_u32 m0, s64, 19456
    s_add_u32 s30, s31, 25694208
    buffer_load_dwordx4 v2, s[20:23], s30 offen offset:0 sc1 lds
    s_waitcnt vmcnt(0)
L_m_HB1:
    s_setprio 0
    s_mul_i32 s32, s25, 798720
    s_mul_i32 s33, s27, 5120
    s_add_u32 s32, s32, s33
    s_waitcnt lgkmcnt(0)
    s_barrier
    s_mov_b32 s37, s32
    s_add_u32 m0, s33, 20480
    s_add_u32 s30, s32, 25772032
    buffer_load_dwordx4 v2, s[20:23], s30 offen offset:0 sc1 lds
    buffer_load_dwordx4 v2, s[20:23], s30 offen offset:1024 sc1 lds
    buffer_load_dwordx4 v2, s[20:23], s30 offen offset:2048 sc1 lds
    buffer_load_dwordx4 v2, s[20:23], s30 offen offset:3072 sc1 lds
    s_add_u32 m0, s33, 24576
    s_add_u32 s30, s32, 25776128
    buffer_load_dwordx4 v2, s[20:23], s30 offen offset:0 sc1 lds
    s_mov_b32 s32, s37
    s_barrier
    v_and_b32 v15, 3, v1
    v_lshlrev_b32 v15, 2, v15
    v_add_u32 v15, 162336, v15
    ds_read_b32 v14, v15
    s_waitcnt lgkmcnt(0)
    v_cmp_ne_u32 vcc, 0, v14
    s_nop 1
    s_cmp_eq_u64 vcc, 0
    s_cbranch_scc1 L_m_Hok
    s_mov_b32 s29, 1
    s_waitcnt vmcnt(0)
    s_branch L_m_Hredo
L_m_Hok:
    s_waitcnt vmcnt(0)
    v_mov_b32 v8, 1
    ds_write_b32 v7, v8
    s_add_u32 m0, s33, 61440
    s_add_u32 s30, s32, 25792512
    buffer_load_dwordx4 v2, s[20:23], s30 offen offset:0 sc1 lds
    buffer_load_dwordx4 v2, s[20:23], s30 offen offset:1024 sc1 lds
    buffer_load_dwordx4 v2, s[20:23], s30 offen offset:2048 sc1 lds
    buffer_load_dwordx4 v2, s[20:23], s30 offen offset:3072 sc1 lds
    s_add_u32 m0, s33, 65536
    s_add_u32 s30, s32, 25796608
    buffer_load_dwordx4 v2, s[20:23], s30 offen offset:0 sc1 lds
    s_add_u32 m0, s33, 122880
    s_add_u32 s30, s32, 25812992
    buffer_load_dwordx4 v2, s[20:23], s30 offen offset:0 sc1 lds
    buffer_load_dwordx4 v2, s[20:23], s30 offen offset:1024 sc1 lds
    buffer_load_dwordx4 v2, s[20:23], s30 offen offset:2048 sc1 lds
    buffer_load_dwordx4 v2, s[20:23], s30 offen offset:3072 sc1 lds
    s_add_u32 m0, s33, 126976
    s_add_u32 s30, s32, 25817088
    buffer_load_dwordx4 v2, s[20:23], s30 offen offset:0 sc1 lds
    s_mul_i32 s36, s27, 20480
    s_mul_i32 s34, s25, 798720
    s_add_u32 s34, s34, s36
    s_add_u32 s34, s34, s36
    s_add_u32 s34, s34, 25997312
L_m_Hw1:
    ds_read_b128 v[12:15], v5 offset:0
    s_waitcnt lgkmcnt(0)
    v_min3_u32 v12, v12, v13, v14
    v_min_u32 v12, v12, v15
    s_nop 0
    v_readfirstlane_b32 s66, v12
    s_cmp_ge_u32 s66, 20
    s_cbranch_scc1 L_m_Hw1_go
    s_sleep 1
    s_branch L_m_Hw1
L_m_Hw1_go:
    s_lshl_b32 s31, s27, 3
    s_lshr_b32 s30, 67240192, s31
    s_and_b32 s30, s30, 7
    s_mul_i32 s30, s30, 20480
    v_add_u32 v9, s30, v2
    ds_write_b128 v9, v[96:99] offset:0
    ds_write_b128 v9, v[100:103] offset:1024
    ds_write_b128 v9, v[104:107] offset:2048
    ds_write_b128 v9, v[108:111] offset:3072
    ds_write_b128 v9, v[112:115] offset:4096
    ds_write_b128 v9, v[116:119] offset:5120
    ds_write_b128 v9, v[120:123] offset:6144
    ds_write_b128 v9, v[124:127] offset:7168
    ds_write_b128 v9, v[128:131] offset:8192
    ds_write_b128 v9, v[132:135] offset:9216
    ds_write_b128 v9, v[136:139] offset:10240
    ds_write_b128 v9, v[140:143] offset:11264
    ds_write_b128 v9, v[144:147] offset:12288
    ds_write_b128 v9, v[148:151] offset:13312
    ds_write_b128 v9, v[152:155] offset:14336
    ds_write_b128 v9, v[156:159] offset:15360
    ds_write_b128 v9, v[160:163] offset:16384
    ds_write_b128 v9, v[164:167] offset:17408
    ds_write_b128 v9, v[168:171] offset:18432
    ds_write_b128 v9, v[172:175] offset:19456
    s_waitcnt vmcnt(0)
    v_mov_b32 v8, 2
    ds_write_b32 v7, v8
L_m_Hw2:
    ds_read_b128 v[12:15], v5 offset:80
    s_waitcnt lgkmcnt(0)
    v_min3_u32 v12, v12, v13, v14
    v_min_u32 v12, v12, v15
    s_nop 0
    v_readfirstlane_b32 s66, v12
    s_cmp_ge_u32 s66, 2
    s_cbranch_scc1 L_m_Hw2_go
    s_sleep 1
    s_branch L_m_Hw2
L_m_Hw2_go:
    s_add_u32 s30, s34, 0
    buffer_load_dwordx4 v[96:99], v2, s[20:23], s30 offen offset:0 sc1
    buffer_load_dwordx4 v[100:103], v2, s[20:23], s30 offen offset:1024 sc1
    buffer_load_dwordx4 v[104:107], v2, s[20:23], s30 offen offset:2048 sc1
    buffer_load_dwordx4 v[108:111], v2, s[20:23], s30 offen offset:3072 sc1
    s_add_u32 s30, s34, 4096
    buffer_load_dwordx4 v[112:115], v2, s[20:23], s30 offen offset:0 sc1
    buffer_load_dwordx4 v[116:119], v2, s[20:23], s30 offen offset:1024 sc1
    buffer_load_dwordx4 v[120:123], v2, s[20:23], s30 offen offset:2048 sc1
    buffer_load_dwordx4 v[124:127], v2, s[20:23], s30 offen offset:3072 sc1
    s_add_u32 s30, s34, 8192
    buffer_load_dwordx4 v[128:131], v2, s[20:23], s30 offen offset:0 sc1
    buffer_load_dwordx4 v[132:135], v2, s[20:23], s30 offen offset:1024 sc1
    buffer_load_dwordx4 v[136:139], v2, s[20:23], s30 offen offset:2048 sc1
    buffer_load_dwordx4 v[140:143], v2, s[20:23], s30 offen offset:3072 sc1
L_m_Hw3:
    ds_read_b128 v[12:15], v5 offset:0
    s_waitcnt lgkmcnt(0)
    v_min3_u32 v12, v12, v13, v14
    v_min_u32 v12, v12, v15
    s_nop 0
    v_readfirstlane_b32 s66, v12
    s_cmp_ge_u32 s66, 25
    s_cbranch_scc1 L_m_Hw3_go
    s_sleep 1
    s_branch L_m_Hw3
L_m_Hw3_go:
    s_lshl_b32 s31, s27, 3
    s_lshr_b32 s30, 198149, s31
    s_and_b32 s30, s30, 7
    s_mul_i32 s30, s30, 20480
    v_add_u32 v9, s30, v2
    ds_write_b128 v9, v[16:19] offset:0
    ds_write_b128 v9, v[20:23] offset:1024
    ds_write_b128 v9, v[24:27] offset:2048
    ds_write_b128 v9, v[28:31] offset:3072
    ds_write_b128 v9, v[32:35] offset:4096
    ds_write_b128 v9, v[36:39] offset:5120
    ds_write_b128 v9, v[40:43] offset:6144
    ds_write_b128 v9, v[44:47] offset:7168
    ds_write_b128 v9, v[48:51] offset:8192
    ds_write_b128 v9, v[52:55] offset:9216
    ds_write_b128 v9, v[56:59] offset:10240
    ds_write_b128 v9, v[60:63] offset:11264
    ds_write_b128 v9, v[64:67] offset:12288
    ds_write_b128 v9, v[68:71] offset:13312
    ds_write_b128 v9, v[72:75] offset:14336
    ds_write_b128 v9, v[76:79] offset:15360
    ds_write_b128 v9, v[80:83] offset:16384
    ds_write_b128 v9, v[84:87] offset:17408
    ds_write_b128 v9, v[88:91] offset:18432
    ds_write_b128 v9, v[92:95] offset:19456
    v_mov_b32 v8, 3
    ds_write_b32 v7, v8
L_m_Hw4:
    ds_read_b128 v[12:15], v5 offset:80
    s_waitcnt lgkmcnt(0)
    v_min3_u32 v12, v12, v13, v14
    v_min_u32 v12, v12, v15
    s_nop 0
    v_readfirstlane_b32 s66, v12
    s_cmp_ge_u32 s66, 3
    s_cbranch_scc1 L_m_Hw4_go
    s_sleep 1
    s_branch L_m_Hw4
L_m_Hw4_go:
    s_add_u32 s30, s34, 12288
    buffer_load_dwordx4 v[144:147], v2, s[20:23], s30 offen offset:0 sc1
    buffer_load_dwordx4 v[148:151], v2, s[20:23], s30 offen offset:1024 sc1
    buffer_load_dwordx4 v[152:155], v2, s[20:23], s30 offen offset:2048 sc1
    buffer_load_dwordx4 v[156:159], v2, s[20:23], s30 offen offset:3072 sc1
    s_add_u32 s30, s34, 16384
    buffer_load_dwordx4 v[160:163], v2, s[20:23], s30 offen offset:0 sc1
    buffer_load_dwordx4 v[164:167], v2, s[20:23], s30 offen offset:1024 sc1
    buffer_load_dwordx4 v[168:171], v2, s[20:23], s30 offen offset:2048 sc1
    buffer_load_dwordx4 v[172:175], v2, s[20:23], s30 offen offset:3072 sc1
    v_add_u32 v16, 0, v2
    v_add_u32 v17, 65536, v2
    v_add_u32 v18, 131072, v2
    v_and_b32 v9, 7, v1
    v_lshlrev_b32 v9, 2, v9
    v_lshrrev_b32 v8, 3, v1
    v_lshl_add_u32 v20, v8, 7, v9
    v_mov_b32 v9, 162368
    ds_read_b32 v10, v9
    s_mov_b32 s43, s27
L_m_Hw5:
    ds_read_b128 v[12:15], v5 offset:0
    s_waitcnt lgkmcnt(0)
    v_min3_u32 v12, v12, v13, v14
    v_min_u32 v12, v12, v15
    s_nop 0
    v_readfirstlane_b32 s66, v12
    s_cmp_ge_u32 s66, 30
    s_cbranch_scc1 L_m_Hw5_go
    s_sleep 1
    s_branch L_m_Hw5
L_m_Hw5_go:
    v_readfirstlane_b32 s60, v10
    s_and_b32 s60, s60, 0xff
    s_setprio 3
    s_mov_b32 s65, s32
    v_add_u32 v21, 0, v2
    v_add_u32 v22, 65536, v2
    v_add_u32 v23, 131072, v2
    s_lshl_b32 s30, s24, 9
    s_add_u32 s30, s30, 32563200
    s_mov_b32 s40, -1
    s_mov_b32 s41, 0
    s_mul_i32 s33, s43, 5120
    s_mul_i32 s32, s24, 81920
    s_add_u32 s32, s32, s33
    s_mov_b32 s58, 400000
    s_mov_b64 exec, s[40:41]
L_m_poll_x1_1:
    buffer_load_dword v17, v20, s[20:23], s30 offen sc1
    s_sub_u32 s58, s58, 1
    s_waitcnt vmcnt(0)
    v_cmp_gt_u32 vcc, 1, v17
    s_cmp_eq_u32 s58, 0
    s_cbranch_scc1 L_m_poll_x1_1_x
    s_cbranch_vccnz L_m_poll_x1_1
L_m_poll_x1_1_x:
    s_mov_b64 exec, -1
    s_add_u32 m0, s33, 81920
    s_add_u32 s30, s32, 8933376
    buffer_load_dwordx4 v2, s[20:23], s30 offen offset:0 sc1 lds
    buffer_load_dwordx4 v2, s[20:23], s30 offen offset:1024 sc1 lds
    buffer_load_dwordx4 v2, s[20:23], s30 offen offset:2048 sc1 lds
    buffer_load_dwordx4 v2, s[20:23], s30 offen offset:3072 sc1 lds
    s_add_u32 m0, s33, 86016
    s_add_u32 s30, s32, 8937472
    buffer_load_dwordx4 v2, s[20:23], s30 offen offset:0 sc1 lds
    s_lshl_b32 s31, s43, 7
    s_add_u32 s31, s31, 162880
    v_lshl_add_u32 v56, v3, 4, s31
    ds_read_b128 v[44:47], v56 offset:0
    ds_read_b128 v[48:51], v56 offset:64
    v_lshlrev_b32 v24, 4, v4
    v_add_u32 v24, 143360, v24
    s_mul_i32 s44, s24, 245760
    s_add_u32 s44, s44, 0
    s_mov_b32 s42, s44
    s_mul_i32 s31, s25, 6144
    s_add_u32 s42, s42, s31
    s_lshl_b32 s31, s43, 10
    s_add_u32 s42, s42, s31
    s_waitcnt vmcnt(0) lgkmcnt(0)
    s_barrier
    ds_read_b128 v[68:71], v21 offset:61440
    ds_read_b128 v[72:75], v21 offset:62464
    ds_read_b128 v[76:79], v21 offset:63488
    ds_read_b128 v[80:83], v21 offset:64512
    ds_read_b128 v[84:87], v22 offset:0
    ds_read_b128 v[88:91], v22 offset:1024
    s_waitcnt lgkmcnt(5)
    v_mfma_f32_16x16x32_bf16 v[28:31], v[96:99], v[68:71], 0
    v_mfma_f32_16x16x32_bf16 v[32:35], v[176:179], v[68:71], 0
    ds_read_b128 v[92:95], v22 offset:2048
    s_waitcnt lgkmcnt(5)
    v_mfma_f32_16x16x32_bf16 v[28:31], v[100:103], v[72:75], v[28:31]
    v_mfma_f32_16x16x32_bf16 v[32:35], v[180:183], v[72:75], v[32:35]
    ds_read_b128 v[68:71], v22 offset:3072
    s_waitcnt lgkmcnt(5)
    v_mfma_f32_16x16x32_bf16 v[28:31], v[104:107], v[76:79], v[28:31]
    v_mfma_f32_16x16x32_bf16 v[32:35], v[184:187], v[76:79], v[32:35]
    ds_read_b128 v[72:75], v22 offset:4096
    s_waitcnt lgkmcnt(5)
    v_mfma_f32_16x16x32_bf16 v[28:31], v[108:111], v[80:83], v[28:31]
    v_mfma_f32_16x16x32_bf16 v[32:35], v[188:191], v[80:83], v[32:35]
    ds_read_b128 v[76:79], v22 offset:5120
    s_waitcnt lgkmcnt(5)
    v_mfma_f32_16x16x32_bf16 v[28:31], v[112:115], v[84:87], v[28:31]
    v_mfma_f32_16x16x32_bf16 v[32:35], v[192:195], v[84:87], v[32:35]
    ds_read_b128 v[80:83], v22 offset:6144
    s_waitcnt lgkmcnt(5)
    v_mfma_f32_16x16x32_bf16 v[28:31], v[116:119], v[88:91], v[28:31]
    v_mfma_f32_16x16x32_bf16 v[32:35], v[196:199], v[88:91], v[32:35]
    ds_read_b128 v[84:87], v22 offset:7168
    s_waitcnt lgkmcnt(5)
    v_mfma_f32_16x16x32_bf16 v[28:31], v[120:123], v[92:95], v[28:31]
    v_mfma_f32_16x16x32_bf16 v[32:35], v[200:203], v[92:95], v[32:35]
    ds_read_b128 v[88:91], v22 offset:8192
    s_waitcnt lgkmcnt(5)
    v_mfma_f32_16x16x32_bf16 v[28:31], v[124:127], v[68:71], v[28:31]
    v_mfma_f32_16x16x32_bf16 v[32:35], v[204:207], v[68:71], v[32:35]
    ds_read_b128 v[92:95], v22 offset:9216
    s_waitcnt lgkmcnt(5)
    v_mfma_f32_16x16x32_bf16 v[28:31], v[128:131], v[72:75], v[28:31]
    v_mfma_f32_16x16x32_bf16 v[32:35], v[208:211], v[72:75], v[32:35]
    ds_read_b128 v[68:71], v22 offset:10240
    s_waitcnt lgkmcnt(5)
    v_mfma_f32_16x16x32_bf16 v[28:31], v[132:135], v[76:79], v[28:31]
    v_mfma_f32_16x16x32_bf16 v[32:35], v[212:215], v[76:79], v[32:35]
    ds_read_b128 v[72:75], v22 offset:11264
    s_waitcnt lgkmcnt(5)
    v_mfma_f32_16x16x32_bf16 v[28:31], v[136:139], v[80:83], v[28:31]
    v_mfma_f32_16x16x32_bf16 v[32:35], v[216:219], v[80:83], v[32:35]
    ds_read_b128 v[76:79], v22 offset:12288
    s_waitcnt lgkmcnt(5)
    v_mfma_f32_16x16x32_bf16 v[28:31], v[140:143], v[84:87], v[28:31]
    v_mfma_f32_16x16x32_bf16 v[32:35], v[220:223], v[84:87], v[32:35]
    ds_read_b128 v[80:83], v22 offset:13312
    ds_read_b128 v[52:55], v24 offset:0
    s_waitcnt lgkmcnt(6)
    v_mfma_f32_16x16x32_bf16 v[28:31], v[144:147], v[88:91], v[28:31]
    v_mfma_f32_16x16x32_bf16 v[32:35], v[224:227], v[88:91], v[32:35]
    ds_read_b128 v[84:87], v22 offset:14336
    s_waitcnt lgkmcnt(6)
    v_mfma_f32_16x16x32_bf16 v[28:31], v[148:151], v[92:95], v[28:31]
    v_mfma_f32_16x16x32_bf16 v[32:35], v[228:231], v[92:95], v[32:35]
    ds_read_b128 v[88:91], v22 offset:15360
    s_waitcnt lgkmcnt(6)
    v_mfma_f32_16x16x32_bf16 v[28:31], v[152:155], v[68:71], v[28:31]
    v_mfma_f32_16x16x32_bf16 v[32:35], v[232:235], v[68:71], v[32:35]
    ds_read_b128 v[92:95], v22 offset:16384
    s_waitcnt lgkmcnt(6)
    v_mfma_f32_16x16x32_bf16 v[28:31], v[156:159], v[72:75], v[28:31]
    v_mfma_f32_16x16x32_bf16 v[32:35], v[236:239], v[72:75], v[32:35]
    ds_read_b128 v[68:71], v22 offset:17408
    s_waitcnt lgkmcnt(6)
    v_mfma_f32_16x16x32_bf16 v[28:31], v[160:163], v[76:79], v[28:31]
    v_mfma_f32_16x16x32_bf16 v[32:35], v[240:243], v[76:79], v[32:35]
    ds_read_b128 v[72:75], v22 offset:18432
    s_waitcnt lgkmcnt(6)
    v_mfma_f32_16x16x32_bf16 v[28:31], v[164:167], v[80:83], v[28:31]
    v_mfma_f32_16x16x32_bf16 v[32:35], v[244:247], v[80:83], v[32:35]
    ds_read_b128 v[76:79], v22 offset:19456
    s_waitcnt lgkmcnt(5)
    v_mfma_f32_16x16x32_bf16 v[28:31], v[168:171], v[84:87], v[28:31]
    v_mfma_f32_16x16x32_bf16 v[32:35], v[248:251], v[84:87], v[32:35]
    ds_read_b128 v[80:83], v22 offset:20480
    s_waitcnt lgkmcnt(5)
    v_mfma_f32_16x16x32_bf16 v[28:31], v[172:175], v[88:91], v[28:31]
    v_mfma_f32_16x16x32_bf16 v[32:35], v[252:255], v[88:91], v[32:35]
    ds_read_b128 v[84:87], v22 offset:21504
    s_waitcnt lgkmcnt(5)
    v_mfma_f32_16x16x32_bf16 v[36:39], v[96:99], v[92:95], 0
    v_mfma_f32_16x16x32_bf16 v[40:43], v[176:179], v[92:95], 0
    ds_read_b128 v[88:91], v22 offset:22528
    s_waitcnt lgkmcnt(5)
    v_mfma_f32_16x16x32_bf16 v[36:39], v[100:103], v[68:71], v[36:39]
    v_mfma_f32_16x16x32_bf16 v[40:43], v[180:183], v[68:71], v[40:43]
    ds_read_b128 v[92:95], v22 offset:23552
    s_waitcnt lgkmcnt(5)
    v_mfma_f32_16x16x32_bf16 v[36:39], v[104:107], v[72:75], v[36:39]
    v_mfma_f32_16x16x32_bf16 v[40:43], v[184:187], v[72:75], v[40:43]
    ds_read_b128 v[68:71], v22 offset:24576
    s_waitcnt lgkmcnt(5)
    v_mfma_f32_16x16x32_bf16 v[36:39], v[108:111], v[76:79], v[36:39]
    v_mfma_f32_16x16x32_bf16 v[40:43], v[188:191], v[76:79], v[40:43]
    ds_read_b128 v[72:75], v22 offset:25600
    s_waitcnt lgkmcnt(5)
    v_mfma_f32_16x16x32_bf16 v[36:39], v[112:115], v[80:83], v[36:39]
    v_mfma_f32_16x16x32_bf16 v[40:43], v[192:195], v[80:83], v[40:43]
    ds_read_b128 v[76:79], v22 offset:26624
    s_setprio 0
    v_fma_f32 v28, v44, v55, v28
    v_fma_f32 v29, v45, v55, v29
    v_fma_f32 v30, v46, v55, v30
    v_fma_f32 v31, v47, v55, v31
    v_fma_f32 v32, v48, v55, v32
    v_fma_f32 v33, v49, v55, v33
    v_fma_f32 v34, v50, v55, v34
    v_fma_f32 v35, v51, v55, v35
    v_mul_f32 v56, v28, v28
    v_mul_f32 v57, v29, v29
    v_mul_f32 v58, v30, v30
    v_mul_f32 v59, v31, v31
    v_mul_f32 v60, v32, v32
    v_mul_f32 v61, v33, v33
    v_mul_f32 v62, v34, v34
    v_mul_f32 v63, v35, v35
    v_fma_f32 v56, v56, v53, v52
    v_fma_f32 v57, v57, v53, v52
    v_fma_f32 v58, v58, v53, v52
    v_fma_f32 v59, v59, v53, v52
    v_fma_f32 v60, v60, v53, v52
    v_fma_f32 v61, v61, v53, v52
    v_fma_f32 v62, v62, v53, v52
    v_fma_f32 v63, v63, v53, v52
    v_mul_f32 v56, v56, v28
    v_mul_f32 v57, v57, v29
    v_mul_f32 v58, v58, v30
    v_mul_f32 v59, v59, v31
    v_mul_f32 v60, v60, v32
    v_mul_f32 v61, v61, v33
    v_mul_f32 v62, v62, v34
    v_mul_f32 v63, v63, v35
    v_exp_f32 v56, v56
    v_exp_f32 v57, v57
    v_exp_f32 v58, v58
    v_exp_f32 v59, v59
    v_exp_f32 v60, v60
    v_exp_f32 v61, v61
    v_exp_f32 v62, v62
    v_exp_f32 v63, v63
    v_fma_f32 v56, v56, v54, v54
    v_fma_f32 v57, v57, v54, v54
    v_fma_f32 v58, v58, v54, v54
    v_fma_f32 v59, v59, v54, v54
    v_fma_f32 v60, v60, v54, v54
    v_fma_f32 v61, v61, v54, v54
    v_fma_f32 v62, v62, v54, v54
    v_fma_f32 v63, v63, v54, v54
    v_rcp_f32 v56, v56
    v_rcp_f32 v57, v57
    v_rcp_f32 v58, v58
    v_rcp_f32 v59, v59
    v_rcp_f32 v60, v60
    v_rcp_f32 v61, v61
    v_rcp_f32 v62, v62
    v_rcp_f32 v63, v63
    v_mul_f32 v28, v28, v56
    v_mul_f32 v29, v29, v57
    v_mul_f32 v30, v30, v58
    v_mul_f32 v31, v31, v59
    v_mul_f32 v32, v32, v60
    v_mul_f32 v33, v33, v61
    v_mul_f32 v34, v34, v62
    v_mul_f32 v35, v35, v63
    v_cvt_pk_bf16_f32 v64, v28, v29
    v_cvt_pk_bf16_f32 v65, v30, v31
    v_cvt_pk_bf16_f32 v66, v32, v33
    v_cvt_pk_bf16_f32 v67, v34, v35
    s_cmp_lg_u32 s60, 0
    s_cbranch_scc1 L_m_pub_u1_0_s
    buffer_store_dwordx4 v[64:67], v2, s[20:23], s42 offen
L_m_pub_u1_0_d:
    s_add_u32 s42, s42, 49152
    s_setprio 3
    s_waitcnt lgkmcnt(5)
    v_mfma_f32_16x16x32_bf16 v[36:39], v[116:119], v[84:87], v[36:39]
    v_mfma_f32_16x16x32_bf16 v[40:43], v[196:199], v[84:87], v[40:43]
    ds_read_b128 v[80:83], v22 offset:27648
    s_waitcnt lgkmcnt(5)
    v_mfma_f32_16x16x32_bf16 v[36:39], v[120:123], v[88:91], v[36:39]
    v_mfma_f32_16x16x32_bf16 v[40:43], v[200:203], v[88:91], v[40:43]
    ds_read_b128 v[84:87], v22 offset:28672
    s_waitcnt lgkmcnt(5)
    v_mfma_f32_16x16x32_bf16 v[36:39], v[124:127], v[92:95], v[36:39]
    v_mfma_f32_16x16x32_bf16 v[40:43], v[204:207], v[92:95], v[40:43]
    ds_read_b128 v[88:91], v22 offset:29696
    s_waitcnt lgkmcnt(5)
    v_mfma_f32_16x16x32_bf16 v[36:39], v[128:131], v[68:71], v[36:39]
    v_mfma_f32_16x16x32_bf16 v[40:43], v[208:211], v[68:71], v[40:43]
    ds_read_b128 v[92:95], v22 offset:30720
    s_waitcnt lgkmcnt(5)
    v_mfma_f32_16x16x32_bf16 v[36:39], v[132:135], v[72:75], v[36:39]
    v_mfma_f32_16x16x32_bf16 v[40:43], v[212:215], v[72:75], v[40:43]
    ds_read_b128 v[68:71], v22 offset:31744
    s_waitcnt lgkmcnt(5)
    v_mfma_f32_16x16x32_bf16 v[36:39], v[136:139], v[76:79], v[36:39]
    v_mfma_f32_16x16x32_bf16 v[40:43], v[216:219], v[76:79], v[40:43]
    ds_read_b128 v[72:75], v22 offset:32768
    s_waitcnt lgkmcnt(5)
    v_mfma_f32_16x16x32_bf16 v[36:39], v[140:143], v[80:83], v[36:39]
    v_mfma_f32_16x16x32_bf16 v[40:43], v[220:223], v[80:83], v[40:43]
    ds_read_b128 v[76:79], v22 offset:33792
    ds_read_b128 v[52:55], v24 offset:256
    s_waitcnt lgkmcnt(6)
    v_mfma_f32_16x16x32_bf16 v[36:39], v[144:147], v[84:87], v[36:39]
    v_mfma_f32_16x16x32_bf16 v[40:43], v[224:227], v[84:87], v[40:43]
    ds_read_b128 v[80:83], v22 offset:34816
    s_waitcnt vmcnt(0) lgkmcnt(0)
    s_barrier
    s_waitcnt lgkmcnt(6)
    v_mfma_f32_16x16x32_bf16 v[36:39], v[148:151], v[88:91], v[36:39]
    v_mfma_f32_16x16x32_bf16 v[40:43], v[228:231], v[88:91], v[40:43]
    ds_read_b128 v[84:87], v22 offset:35840
    s_waitcnt lgkmcnt(6)
    v_mfma_f32_16x16x32_bf16 v[36:39], v[152:155], v[92:95], v[36:39]
    v_mfma_f32_16x16x32_bf16 v[40:43], v[232:235], v[92:95], v[40:43]
    ds_read_b128 v[88:91], v22 offset:36864
    s_waitcnt lgkmcnt(6)
    v_mfma_f32_16x16x32_bf16 v[36:39], v[156:159], v[68:71], v[36:39]
    v_mfma_f32_16x16x32_bf16 v[40:43], v[236:239], v[68:71], v[40:43]
    ds_read_b128 v[92:95], v22 offset:37888
    s_waitcnt lgkmcnt(6)
    v_mfma_f32_16x16x32_bf16 v[36:39], v[160:163], v[72:75], v[36:39]
    v_mfma_f32_16x16x32_bf16 v[40:43], v[240:243], v[72:75], v[40:43]
    ds_read_b128 v[68:71], v22 offset:38912
    s_waitcnt lgkmcnt(6)
    v_mfma_f32_16x16x32_bf16 v[36:39], v[164:167], v[76:79], v[36:39]
    v_mfma_f32_16x16x32_bf16 v[40:43], v[244:247], v[76:79], v[40:43]
    ds_read_b128 v[72:75], v22 offset:39936
    s_waitcnt lgkmcnt(5)
    v_mfma_f32_16x16x32_bf16 v[36:39], v[168:171], v[80:83], v[36:39]
    v_mfma_f32_16x16x32_bf16 v[40:43], v[248:251], v[80:83], v[40:43]
    ds_read_b128 v[76:79], v22 offset:40960
    s_waitcnt lgkmcnt(5)
    v_mfma_f32_16x16x32_bf16 v[36:39], v[172:175], v[84:87], v[36:39]
    v_mfma_f32_16x16x32_bf16 v[40:43], v[252:255], v[84:87], v[40:43]
    ds_read_b128 v[80:83], v22 offset:41984
    s_waitcnt lgkmcnt(5)
    v_mfma_f32_16x16x32_bf16 v[28:31], v[96:99], v[88:91], 0
    v_mfma_f32_16x16x32_bf16 v[32:35], v[176:179], v[88:91], 0
    ds_read_b128 v[84:87], v22 offset:43008
    s_waitcnt lgkmcnt(5)
    v_mfma_f32_16x16x32_bf16 v[28:31], v[100:103], v[92:95], v[28:31]
    v_mfma_f32_16x16x32_bf16 v[32:35], v[180:183], v[92:95], v[32:35]
    ds_read_b128 v[88:91], v22 offset:44032
    s_waitcnt lgkmcnt(5)
    v_mfma_f32_16x16x32_bf16 v[28:31], v[104:107], v[68:71], v[28:31]
    v_mfma_f32_16x16x32_bf16 v[32:35], v[184:187], v[68:71], v[32:35]
    ds_read_b128 v[92:95], v22 offset:45056
    s_waitcnt lgkmcnt(5)
    v_mfma_f32_16x16x32_bf16 v[28:31], v[108:111], v[72:75], v[28:31]
    v_mfma_f32_16x16x32_bf16 v[32:35], v[188:191], v[72:75], v[32:35]
    ds_read_b128 v[68:71], v22 offset:46080
    s_waitcnt lgkmcnt(5)
    v_mfma_f32_16x16x32_bf16 v[28:31], v[112:115], v[76:79], v[28:31]
    v_mfma_f32_16x16x32_bf16 v[32:35], v[192:195], v[76:79], v[32:35]
    ds_read_b128 v[72:75], v22 offset:47104
    s_setprio 0
    v_fma_f32 v36, v44, v55, v36
    v_fma_f32 v37, v45, v55, v37
    v_fma_f32 v38, v46, v55, v38
    v_fma_f32 v39, v47, v55, v39
    v_fma_f32 v40, v48, v55, v40
    v_fma_f32 v41, v49, v55, v41
    v_fma_f32 v42, v50, v55, v42
    v_fma_f32 v43, v51, v55, v43
    v_mul_f32 v56, v36, v36
    v_mul_f32 v57, v37, v37
    v_mul_f32 v58, v38, v38
    v_mul_f32 v59, v39, v39
    v_mul_f32 v60, v40, v40
    v_mul_f32 v61, v41, v41
    v_mul_f32 v62, v42, v42
    v_mul_f32 v63, v43, v43
    v_fma_f32 v56, v56, v53, v52
    v_fma_f32 v57, v57, v53, v52
    v_fma_f32 v58, v58, v53, v52
    v_fma_f32 v59, v59, v53, v52
    v_fma_f32 v60, v60, v53, v52
    v_fma_f32 v61, v61, v53, v52
    v_fma_f32 v62, v62, v53, v52
    v_fma_f32 v63, v63, v53, v52
    v_mul_f32 v56, v56, v36
    v_mul_f32 v57, v57, v37
    v_mul_f32 v58, v58, v38
    v_mul_f32 v59, v59, v39
    v_mul_f32 v60, v60, v40
    v_mul_f32 v61, v61, v41
    v_mul_f32 v62, v62, v42
    v_mul_f32 v63, v63, v43
    v_exp_f32 v56, v56
    v_exp_f32 v57, v57
    v_exp_f32 v58, v58
    v_exp_f32 v59, v59
    v_exp_f32 v60, v60
    v_exp_f32 v61, v61
    v_exp_f32 v62, v62
    v_exp_f32 v63, v63
    v_fma_f32 v56, v56, v54, v54
    v_fma_f32 v57, v57, v54, v54
    v_fma_f32 v58, v58, v54, v54
    v_fma_f32 v59, v59, v54, v54
    v_fma_f32 v60, v60, v54, v54
    v_fma_f32 v61, v61, v54, v54
    v_fma_f32 v62, v62, v54, v54
    v_fma_f32 v63, v63, v54, v54
    v_rcp_f32 v56, v56
    v_rcp_f32 v57, v57
    v_rcp_f32 v58, v58
    v_rcp_f32 v59, v59
    v_rcp_f32 v60, v60
    v_rcp_f32 v61, v61
    v_rcp_f32 v62, v62
    v_rcp_f32 v63, v63
    v_mul_f32 v36, v36, v56
    v_mul_f32 v37, v37, v57
    v_mul_f32 v38, v38, v58
    v_mul_f32 v39, v39, v59
    v_mul_f32 v40, v40, v60
    v_mul_f32 v41, v41, v61
    v_mul_f32 v42, v42, v62
    v_mul_f32 v43, v43, v63
    v_cvt_pk_bf16_f32 v64, v36, v37
    v_cvt_pk_bf16_f32 v65, v38, v39
    v_cvt_pk_bf16_f32 v66, v40, v41
    v_cvt_pk_bf16_f32 v67, v42, v43
    s_cmp_lg_u32 s60, 0
    s_cbranch_scc1 L_m_pub_u1_1_s
    buffer_store_dwordx4 v[64:67], v2, s[20:23], s42 offen
L_m_pub_u1_1_d:
    s_add_u32 s42, s42, 49152
    s_setprio 3
    s_waitcnt lgkmcnt(5)
    v_mfma_f32_16x16x32_bf16 v[28:31], v[116:119], v[80:83], v[28:31]
    v_mfma_f32_16x16x32_bf16 v[32:35], v[196:199], v[80:83], v[32:35]
    ds_read_b128 v[76:79], v22 offset:48128
    s_waitcnt lgkmcnt(5)
    v_mfma_f32_16x16x32_bf16 v[28:31], v[120:123], v[84:87], v[28:31]
    v_mfma_f32_16x16x32_bf16 v[32:35], v[200:203], v[84:87], v[32:35]
    ds_read_b128 v[80:83], v22 offset:49152
    s_waitcnt lgkmcnt(5)
    v_mfma_f32_16x16x32_bf16 v[28:31], v[124:127], v[88:91], v[28:31]
    v_mfma_f32_16x16x32_bf16 v[32:35], v[204:207], v[88:91], v[32:35]
    ds_read_b128 v[84:87], v22 offset:50176
    s_waitcnt lgkmcnt(5)
    v_mfma_f32_16x16x32_bf16 v[28:31], v[128:131], v[92:95], v[28:31]
    v_mfma_f32_16x16x32_bf16 v[32:35], v[208:211], v[92:95], v[32:35]
    ds_read_b128 v[88:91], v22 offset:51200
    s_waitcnt lgkmcnt(5)
    v_mfma_f32_16x16x32_bf16 v[28:31], v[132:135], v[68:71], v[28:31]
    v_mfma_f32_16x16x32_bf16 v[32:35], v[212:215], v[68:71], v[32:35]
    ds_read_b128 v[92:95], v22 offset:52224
    s_waitcnt lgkmcnt(5)
    v_mfma_f32_16x16x32_bf16 v[28:31], v[136:139], v[72:75], v[28:31]
    v_mfma_f32_16x16x32_bf16 v[32:35], v[216:219], v[72:75], v[32:35]
    ds_read_b128 v[68:71], v22 offset:53248
    s_waitcnt lgkmcnt(5)
    v_mfma_f32_16x16x32_bf16 v[28:31], v[140:143], v[76:79], v[28:31]
    v_mfma_f32_16x16x32_bf16 v[32:35], v[220:223], v[76:79], v[32:35]
    ds_read_b128 v[72:75], v22 offset:54272
    ds_read_b128 v[52:55], v24 offset:512
    s_waitcnt lgkmcnt(6)
    v_mfma_f32_16x16x32_bf16 v[28:31], v[144:147], v[80:83], v[28:31]
    v_mfma_f32_16x16x32_bf16 v[32:35], v[224:227], v[80:83], v[32:35]
    ds_read_b128 v[76:79], v22 offset:55296
    s_waitcnt lgkmcnt(6)
    v_mfma_f32_16x16x32_bf16 v[28:31], v[148:151], v[84:87], v[28:31]
    v_mfma_f32_16x16x32_bf16 v[32:35], v[228:231], v[84:87], v[32:35]
    ds_read_b128 v[80:83], v22 offset:56320
    s_waitcnt lgkmcnt(6)
    v_mfma_f32_16x16x32_bf16 v[28:31], v[152:155], v[88:91], v[28:31]
    v_mfma_f32_16x16x32_bf16 v[32:35], v[232:235], v[88:91], v[32:35]
    ds_read_b128 v[84:87], v22 offset:57344
    s_waitcnt lgkmcnt(6)
    v_mfma_f32_16x16x32_bf16 v[28:31], v[156:159], v[92:95], v[28:31]
    v_mfma_f32_16x16x32_bf16 v[32:35], v[236:239], v[92:95], v[32:35]
    ds_read_b128 v[88:91], v22 offset:58368
    s_waitcnt lgkmcnt(6)
    v_mfma_f32_16x16x32_bf16 v[28:31], v[160:163], v[68:71], v[28:31]
    v_mfma_f32_16x16x32_bf16 v[32:35], v[240:243], v[68:71], v[32:35]
    ds_read_b128 v[92:95], v22 offset:59392
    s_waitcnt lgkmcnt(6)
    v_mfma_f32_16x16x32_bf16 v[28:31], v[164:167], v[72:75], v[28:31]
    v_mfma_f32_16x16x32_bf16 v[32:35], v[244:247], v[72:75], v[32:35]
    ds_read_b128 v[68:71], v22 offset:60416
    s_waitcnt lgkmcnt(5)
    v_mfma_f32_16x16x32_bf16 v[28:31], v[168:171], v[76:79], v[28:31]
    v_mfma_f32_16x16x32_bf16 v[32:35], v[248:251], v[76:79], v[32:35]
    ds_read_b128 v[72:75], v22 offset:61440
    s_waitcnt lgkmcnt(5)
    v_mfma_f32_16x16x32_bf16 v[28:31], v[172:175], v[80:83], v[28:31]
    v_mfma_f32_16x16x32_bf16 v[32:35], v[252:255], v[80:83], v[32:35]
    ds_read_b128 v[76:79], v22 offset:62464
    s_waitcnt lgkmcnt(5)
    v_mfma_f32_16x16x32_bf16 v[36:39], v[96:99], v[84:87], 0
    v_mfma_f32_16x16x32_bf16 v[40:43], v[176:179], v[84:87], 0
    ds_read_b128 v[80:83], v22 offset:63488
    s_waitcnt lgkmcnt(5)
    v_mfma_f32_16x16x32_bf16 v[36:39], v[100:103], v[88:91], v[36:39]
    v_mfma_f32_16x16x32_bf16 v[40:43], v[180:183], v[88:91], v[40:43]
    ds_read_b128 v[84:87], v22 offset:64512
    s_waitcnt lgkmcnt(5)
    v_mfma_f32_16x16x32_bf16 v[36:39], v[104:107], v[92:95], v[36:39]
    v_mfma_f32_16x16x32_bf16 v[40:43], v[184:187], v[92:95], v[40:43]
    ds_read_b128 v[88:91], v23 offset:0
    s_waitcnt lgkmcnt(5)
    v_mfma_f32_16x16x32_bf16 v[36:39], v[108:111], v[68:71], v[36:39]
    v_mfma_f32_16x16x32_bf16 v[40:43], v[188:191], v[68:71], v[40:43]
    ds_read_b128 v[92:95], v23 offset:1024
    s_waitcnt lgkmcnt(5)
    v_mfma_f32_16x16x32_bf16 v[36:39], v[112:115], v[72:75], v[36:39]
    v_mfma_f32_16x16x32_bf16 v[40:43], v[192:195], v[72:75], v[40:43]
    ds_read_b128 v[68:71], v23 offset:2048
    s_setprio 0
    v_fma_f32 v28, v44, v55, v28
    v_fma_f32 v29, v45, v55, v29
    v_fma_f32 v30, v46, v55, v30
    v_fma_f32 v31, v47, v55, v31
    v_fma_f32 v32, v48, v55, v32
    v_fma_f32 v33, v49, v55, v33
    v_fma_f32 v34, v50, v55, v34
    v_fma_f32 v35, v51, v55, v35
    v_mul_f32 v56, v28, v28
    v_mul_f32 v57, v29, v29
    v_mul_f32 v58, v30, v30
    v_mul_f32 v59, v31, v31
    v_mul_f32 v60, v32, v32
    v_mul_f32 v61, v33, v33
    v_mul_f32 v62, v34, v34
    v_mul_f32 v63, v35, v35
    v_fma_f32 v56, v56, v53, v52
    v_fma_f32 v57, v57, v53, v52
    v_fma_f32 v58, v58, v53, v52
    v_fma_f32 v59, v59, v53, v52
    v_fma_f32 v60, v60, v53, v52
    v_fma_f32 v61, v61, v53, v52
    v_fma_f32 v62, v62, v53, v52
    v_fma_f32 v63, v63, v53, v52
    v_mul_f32 v56, v56, v28
    v_mul_f32 v57, v57, v29
    v_mul_f32 v58, v58, v30
    v_mul_f32 v59, v59, v31
    v_mul_f32 v60, v60, v32
    v_mul_f32 v61, v61, v33
    v_mul_f32 v62, v62, v34
    v_mul_f32 v63, v63, v35
    v_exp_f32 v56, v56
    v_exp_f32 v57, v57
    v_exp_f32 v58, v58
    v_exp_f32 v59, v59
    v_exp_f32 v60, v60
    v_exp_f32 v61, v61
    v_exp_f32 v62, v62
    v_exp_f32 v63, v63
    v_fma_f32 v56, v56, v54, v54
    v_fma_f32 v57, v57, v54, v54
    v_fma_f32 v58, v58, v54, v54
    v_fma_f32 v59, v59, v54, v54
    v_fma_f32 v60, v60, v54, v54
    v_fma_f32 v61, v61, v54, v54
    v_fma_f32 v62, v62, v54, v54
    v_fma_f32 v63, v63, v54, v54
    v_rcp_f32 v56, v56
    v_rcp_f32 v57, v57
    v_rcp_f32 v58, v58
    v_rcp_f32 v59, v59
    v_rcp_f32 v60, v60
    v_rcp_f32 v61, v61
    v_rcp_f32 v62, v62
    v_rcp_f32 v63, v63
    v_mul_f32 v28, v28, v56
    v_mul_f32 v29, v29, v57
    v_mul_f32 v30, v30, v58
    v_mul_f32 v31, v31, v59
    v_mul_f32 v32, v32, v60
    v_mul_f32 v33, v33, v61
    v_mul_f32 v34, v34, v62
    v_mul_f32 v35, v35, v63
    v_cvt_pk_bf16_f32 v64, v28, v29
    v_cvt_pk_bf16_f32 v65, v30, v31
    v_cvt_pk_bf16_f32 v66, v32, v33
    v_cvt_pk_bf16_f32 v67, v34, v35
    s_cmp_lg_u32 s60, 0
    s_cbranch_scc1 L_m_pub_u1_2_s
    buffer_store_dwordx4 v[64:67], v2, s[20:23], s42 offen
L_m_pub_u1_2_d:
    s_add_u32 s42, s42, 49152
    s_setprio 3
    s_waitcnt lgkmcnt(5)
    v_mfma_f32_16x16x32_bf16 v[36:39], v[116:119], v[76:79], v[36:39]
    v_mfma_f32_16x16x32_bf16 v[40:43], v[196:199], v[76:79], v[40:43]
    ds_read_b128 v[72:75], v23 offset:3072
    s_waitcnt lgkmcnt(5)
    v_mfma_f32_16x16x32_bf16 v[36:39], v[120:123], v[80:83], v[36:39]
    v_mfma_f32_16x16x32_bf16 v[40:43], v[200:203], v[80:83], v[40:43]
    ds_read_b128 v[76:79], v23 offset:4096
    s_waitcnt lgkmcnt(5)
    v_mfma_f32_16x16x32_bf16 v[36:39], v[124:127], v[84:87], v[36:39]
    v_mfma_f32_16x16x32_bf16 v[40:43], v[204:207], v[84:87], v[40:43]
    ds_read_b128 v[80:83], v23 offset:5120
    s_waitcnt lgkmcnt(5)
    v_mfma_f32_16x16x32_bf16 v[36:39], v[128:131], v[88:91], v[36:39]
    v_mfma_f32_16x16x32_bf16 v[40:43], v[208:211], v[88:91], v[40:43]
    ds_read_b128 v[84:87], v23 offset:6144
    s_waitcnt lgkmcnt(5)
    v_mfma_f32_16x16x32_bf16 v[36:39], v[132:135], v[92:95], v[36:39]
    v_mfma_f32_16x16x32_bf16 v[40:43], v[212:215], v[92:95], v[40:43]
    ds_read_b128 v[88:91], v23 offset:7168
    s_waitcnt lgkmcnt(5)
    v_mfma_f32_16x16x32_bf16 v[36:39], v[136:139], v[68:71], v[36:39]
    v_mfma_f32_16x16x32_bf16 v[40:43], v[216:219], v[68:71], v[40:43]
    ds_read_b128 v[92:95], v23 offset:8192
    ds_read_b128 v[52:55], v24 offset:768
    s_waitcnt lgkmcnt(6)
    v_mfma_f32_16x16x32_bf16 v[36:39], v[140:143], v[72:75], v[36:39]
    v_mfma_f32_16x16x32_bf16 v[40:43], v[220:223], v[72:75], v[40:43]
    ds_read_b128 v[68:71], v23 offset:9216
    s_waitcnt lgkmcnt(6)
    v_mfma_f32_16x16x32_bf16 v[36:39], v[144:147], v[76:79], v[36:39]
    v_mfma_f32_16x16x32_bf16 v[40:43], v[224:227], v[76:79], v[40:43]
    ds_read_b128 v[72:75], v23 offset:10240
    s_waitcnt lgkmcnt(6)
    v_mfma_f32_16x16x32_bf16 v[36:39], v[148:151], v[80:83], v[36:39]
    v_mfma_f32_16x16x32_bf16 v[40:43], v[228:231], v[80:83], v[40:43]
    ds_read_b128 v[76:79], v23 offset:11264
    s_waitcnt lgkmcnt(6)
    v_mfma_f32_16x16x32_bf16 v[36:39], v[152:155], v[84:87], v[36:39]
    v_mfma_f32_16x16x32_bf16 v[40:43], v[232:235], v[84:87], v[40:43]
    s_waitcnt lgkmcnt(5)
    v_mfma_f32_16x16x32_bf16 v[36:39], v[156:159], v[88:91], v[36:39]
    v_mfma_f32_16x16x32_bf16 v[40:43], v[236:239], v[88:91], v[40:43]
    s_waitcnt lgkmcnt(4)
    v_mfma_f32_16x16x32_bf16 v[36:39], v[160:163], v[92:95], v[36:39]
    v_mfma_f32_16x16x32_bf16 v[40:43], v[240:243], v[92:95], v[40:43]
    s_waitcnt lgkmcnt(2)
    v_mfma_f32_16x16x32_bf16 v[36:39], v[164:167], v[68:71], v[36:39]
    v_mfma_f32_16x16x32_bf16 v[40:43], v[244:247], v[68:71], v[40:43]
    s_waitcnt lgkmcnt(1)
    v_mfma_f32_16x16x32_bf16 v[36:39], v[168:171], v[72:75], v[36:39]
    v_mfma_f32_16x16x32_bf16 v[40:43], v[248:251], v[72:75], v[40:43]
    s_waitcnt lgkmcnt(0)
    v_mfma_f32_16x16x32_bf16 v[36:39], v[172:175], v[76:79], v[36:39]
    v_mfma_f32_16x16x32_bf16 v[40:43], v[252:255], v[76:79], v[40:43]
    s_waitcnt lgkmcnt(0)
    s_nop 6
    s_setprio 0
    v_fma_f32 v36, v44, v55, v36
    v_fma_f32 v37, v45, v55, v37
    v_fma_f32 v38, v46, v55, v38
    v_fma_f32 v39, v47, v55, v39
    v_fma_f32 v40, v48, v55, v40
    v_fma_f32 v41, v49, v55, v41
    v_fma_f32 v42, v50, v55, v42
    v_fma_f32 v43, v51, v55, v43
    v_mul_f32 v56, v36, v36
    v_mul_f32 v57, v37, v37
    v_mul_f32 v58, v38, v38
    v_mul_f32 v59, v39, v39
    v_mul_f32 v60, v40, v40
    v_mul_f32 v61, v41, v41
    v_mul_f32 v62, v42, v42
    v_mul_f32 v63, v43, v43
    v_fma_f32 v56, v56, v53, v52
    v_fma_f32 v57, v57, v53, v52
    v_fma_f32 v58, v58, v53, v52
    v_fma_f32 v59, v59, v53, v52
    v_fma_f32 v60, v60, v53, v52
    v_fma_f32 v61, v61, v53, v52
    v_fma_f32 v62, v62, v53, v52
    v_fma_f32 v63, v63, v53, v52
    v_mul_f32 v56, v56, v36
    v_mul_f32 v57, v57, v37
    v_mul_f32 v58, v58, v38
    v_mul_f32 v59, v59, v39
    v_mul_f32 v60, v60, v40
    v_mul_f32 v61, v61, v41
    v_mul_f32 v62, v62, v42
    v_mul_f32 v63, v63, v43
    v_exp_f32 v56, v56
    v_exp_f32 v57, v57
    v_exp_f32 v58, v58
    v_exp_f32 v59, v59
    v_exp_f32 v60, v60
    v_exp_f32 v61, v61
    v_exp_f32 v62, v62
    v_exp_f32 v63, v63
    v_fma_f32 v56, v56, v54, v54
    v_fma_f32 v57, v57, v54, v54
    v_fma_f32 v58, v58, v54, v54
    v_fma_f32 v59, v59, v54, v54
    v_fma_f32 v60, v60, v54, v54
    v_fma_f32 v61, v61, v54, v54
    v_fma_f32 v62, v62, v54, v54
    v_fma_f32 v63, v63, v54, v54
    v_rcp_f32 v56, v56
    v_rcp_f32 v57, v57
    v_rcp_f32 v58, v58
    v_rcp_f32 v59, v59
    v_rcp_f32 v60, v60
    v_rcp_f32 v61, v61
    v_rcp_f32 v62, v62
    v_rcp_f32 v63, v63
    v_mul_f32 v36, v36, v56
    v_mul_f32 v37, v37, v57
    v_mul_f32 v38, v38, v58
    v_mul_f32 v39, v39, v59
    v_mul_f32 v40, v40, v60
    v_mul_f32 v41, v41, v61
    v_mul_f32 v42, v42, v62
    v_mul_f32 v43, v43, v63
    v_cvt_pk_bf16_f32 v64, v36, v37
    v_cvt_pk_bf16_f32 v65, v38, v39
    v_cvt_pk_bf16_f32 v66, v40, v41
    v_cvt_pk_bf16_f32 v67, v42, v43
    s_cmp_lg_u32 s60, 0
    s_cbranch_scc1 L_m_pub_u1_3_s
    buffer_store_dwordx4 v[64:67], v2, s[20:23], s42 offen
L_m_pub_u1_3_d:
    s_add_u32 s42, s42, 49152
    s_setprio 3
    s_waitcnt vmcnt(0)
    s_barrier
    s_setprio 2
    v_add_u32 v21, 0, v2
    v_add_u32 v22, 65536, v2
    v_add_u32 v23, 131072, v2
    s_lshl_b32 s35, s24, 2
    s_add_u32 s35, s35, s43
    s_mul_i32 s36, s43, 49152
    s_add_u32 s36, s36, s44
    s_mul_i32 s32, s25, 798720
    s_add_u32 s32, s32, s33
    s_lshl_b32 s30, s35, 7
    s_add_u32 s30, s30, 32579584
    s_mov_b32 s58, 400000
    s_mov_b64 exec, 0xff
L_m_poll_u_1:
    buffer_load_dword v17, v20, s[20:23], s30 offen sc1
    s_sub_u32 s58, s58, 1
    s_waitcnt vmcnt(0)
    v_cmp_gt_u32 vcc, 1, v17
    s_cmp_eq_u32 s58, 0
    s_cbranch_scc1 L_m_poll_u_1_x
    s_cbranch_vccnz L_m_poll_u_1
L_m_poll_u_1_x:
    s_mov_b64 exec, -1
    s_add_u32 s31, s36, 0
    buffer_load_dwordx4 v[136:139], v2, s[20:23], s31 offen offset:0 sc1
    buffer_load_dwordx4 v[140:143], v2, s[20:23], s31 offen offset:1024 sc1
    buffer_load_dwordx4 v[144:147], v2, s[20:23], s31 offen offset:2048 sc1
    buffer_load_dwordx4 v[148:151], v2, s[20:23], s31 offen offset:3072 sc1
    s_add_u32 s31, s36, 4096
    buffer_load_dwordx4 v[152:155], v2, s[20:23], s31 offen offset:2048 sc1
    buffer_load_dwordx4 v[156:159], v2, s[20:23], s31 offen offset:3072 sc1
    s_add_u32 s31, s36, 8192
    buffer_load_dwordx4 v[160:163], v2, s[20:23], s31 offen offset:2048 sc1
    buffer_load_dwordx4 v[164:167], v2, s[20:23], s31 offen offset:3072 sc1
    ds_read_b128 v[96:99], v21 offset:20480
    ds_read_b128 v[100:103], v21 offset:24576
    ds_read_b128 v[104:107], v21 offset:28672
    ds_read_b128 v[108:111], v21 offset:32768
    ds_read_b128 v[112:115], v21 offset:36864
    ds_read_b128 v[116:119], v21 offset:21504
    ds_read_b128 v[120:123], v21 offset:25600
    ds_read_b128 v[124:127], v21 offset:29696
    ds_read_b128 v[128:131], v21 offset:33792
    s_waitcnt vmcnt(7) lgkmcnt(4)
    v_mfma_f32_16x16x32_bf16 v[28:31], v[96:99], v[136:139], 0
    s_add_u32 s31, s36, 12288
    buffer_load_dwordx4 v[168:171], v2, s[20:23], s31 offen offset:2048 sc1
    ds_read_b128 v[132:135], v21 offset:37888
    v_mfma_f32_16x16x32_bf16 v[32:35], v[100:103], v[136:139], 0
    ds_read_b128 v[96:99], v21 offset:22528
    v_mfma_f32_16x16x32_bf16 v[36:39], v[104:107], v[136:139], 0
    ds_read_b128 v[100:103], v21 offset:26624
    v_mfma_f32_16x16x32_bf16 v[40:43], v[108:111], v[136:139], 0
    ds_read_b128 v[104:107], v21 offset:30720
    v_mfma_f32_16x16x32_bf16 v[44:47], v[112:115], v[136:139], 0
    ds_read_b128 v[108:111], v21 offset:34816
    s_waitcnt vmcnt(7) lgkmcnt(4)
    v_mfma_f32_16x16x32_bf16 v[28:31], v[116:119], v[140:143], v[28:31]
    buffer_load_dwordx4 v[172:175], v2, s[20:23], s31 offen offset:3072 sc1
    ds_read_b128 v[112:115], v21 offset:38912
    v_mfma_f32_16x16x32_bf16 v[32:35], v[120:123], v[140:143], v[32:35]
    ds_read_b128 v[116:119], v21 offset:23552
    v_mfma_f32_16x16x32_bf16 v[36:39], v[124:127], v[140:143], v[36:39]
    ds_read_b128 v[120:123], v21 offset:27648
    v_mfma_f32_16x16x32_bf16 v[40:43], v[128:131], v[140:143], v[40:43]
    ds_read_b128 v[124:127], v21 offset:31744
    v_mfma_f32_16x16x32_bf16 v[44:47], v[132:135], v[140:143], v[44:47]
    ds_read_b128 v[128:131], v21 offset:35840
    s_waitcnt vmcnt(7) lgkmcnt(4)
    v_mfma_f32_16x16x32_bf16 v[28:31], v[96:99], v[144:147], v[28:31]
    s_add_u32 s31, s36, 16384
    buffer_load_dwordx4 v[176:179], v2, s[20:23], s31 offen offset:2048 sc1
    ds_read_b128 v[132:135], v21 offset:39936
    v_mfma_f32_16x16x32_bf16 v[32:35], v[100:103], v[144:147], v[32:35]
    ds_read_b128 v[96:99], v21 offset:43008
    v_mfma_f32_16x16x32_bf16 v[36:39], v[104:107], v[144:147], v[36:39]
    ds_read_b128 v[100:103], v21 offset:47104
    v_mfma_f32_16x16x32_bf16 v[40:43], v[108:111], v[144:147], v[40:43]
    ds_read_b128 v[104:107], v21 offset:51200
    v_mfma_f32_16x16x32_bf16 v[44:47], v[112:115], v[144:147], v[44:47]
    ds_read_b128 v[108:111], v21 offset:55296
    s_waitcnt vmcnt(7) lgkmcnt(4)
    v_mfma_f32_16x16x32_bf16 v[28:31], v[116:119], v[148:151], v[28:31]
    buffer_load_dwordx4 v[180:183], v2, s[20:23], s31 offen offset:3072 sc1
    ds_read_b128 v[112:115], v21 offset:59392
    v_mfma_f32_16x16x32_bf16 v[32:35], v[120:123], v[148:151], v[32:35]
    ds_read_b128 v[116:119], v21 offset:44032
    v_mfma_f32_16x16x32_bf16 v[36:39], v[124:127], v[148:151], v[36:39]
    ds_read_b128 v[120:123], v21 offset:48128
    v_mfma_f32_16x16x32_bf16 v[40:43], v[128:131], v[148:151], v[40:43]
    ds_read_b128 v[124:127], v21 offset:52224
    v_mfma_f32_16x16x32_bf16 v[44:47], v[132:135], v[148:151], v[44:47]
    ds_read_b128 v[128:131], v21 offset:56320
    s_waitcnt vmcnt(7) lgkmcnt(4)
    v_mfma_f32_16x16x32_bf16 v[28:31], v[96:99], v[152:155], v[28:31]
    s_add_u32 s31, s36, 20480
    buffer_load_dwordx4 v[184:187], v2, s[20:23], s31 offen offset:2048 sc1
    ds_read_b128 v[132:135], v21 offset:60416
    v_mfma_f32_16x16x32_bf16 v[32:35], v[100:103], v[152:155], v[32:35]
    ds_read_b128 v[96:99], v21 offset:2048
    v_mfma_f32_16x16x32_bf16 v[36:39], v[104:107], v[152:155], v[36:39]
    ds_read_b128 v[100:103], v21 offset:6144
    v_mfma_f32_16x16x32_bf16 v[40:43], v[108:111], v[152:155], v[40:43]
    ds_read_b128 v[104:107], v21 offset:10240
    v_mfma_f32_16x16x32_bf16 v[44:47], v[112:115], v[152:155], v[44:47]
    ds_read_b128 v[108:111], v21 offset:14336
    s_waitcnt vmcnt(7) lgkmcnt(4)
    v_mfma_f32_16x16x32_bf16 v[28:31], v[116:119], v[156:159], v[28:31]
    buffer_load_dwordx4 v[188:191], v2, s[20:23], s31 offen offset:3072 sc1
    ds_read_b128 v[112:115], v21 offset:18432
    v_mfma_f32_16x16x32_bf16 v[32:35], v[120:123], v[156:159], v[32:35]
    ds_read_b128 v[116:119], v21 offset:3072
    v_mfma_f32_16x16x32_bf16 v[36:39], v[124:127], v[156:159], v[36:39]
    ds_read_b128 v[120:123], v21 offset:7168
    v_mfma_f32_16x16x32_bf16 v[40:43], v[128:131], v[156:159], v[40:43]
    ds_read_b128 v[124:127], v21 offset:11264
    v_mfma_f32_16x16x32_bf16 v[44:47], v[132:135], v[156:159], v[44:47]
    ds_read_b128 v[128:131], v21 offset:15360
    s_waitcnt vmcnt(7) lgkmcnt(4)
    v_mfma_f32_16x16x32_bf16 v[28:31], v[96:99], v[160:163], v[28:31]
    s_add_u32 s31, s36, 24576
    buffer_load_dwordx4 v[192:195], v2, s[20:23], s31 offen offset:2048 sc1
    ds_read_b128 v[132:135], v21 offset:19456
    s_barrier
    s_add_u32 m0, s33, 40960
    s_add_u32 s30, s32, 26406912
    buffer_load_dwordx4 v2, s[20:23], s30 offen offset:0 sc1 lds
    buffer_load_dwordx4 v2, s[20:23], s30 offen offset:1024 sc1 lds
    buffer_load_dwordx4 v2, s[20:23], s30 offen offset:2048 sc1 lds
    buffer_load_dwordx4 v2, s[20:23], s30 offen offset:3072 sc1 lds
    s_add_u32 m0, s33, 45056
    s_add_u32 s30, s32, 26411008
    buffer_load_dwordx4 v2, s[20:23], s30 offen offset:0 sc1 lds
    v_mfma_f32_16x16x32_bf16 v[32:35], v[100:103], v[160:163], v[32:35]
    ds_read_b128 v[96:99], v21 offset:63488
    v_mfma_f32_16x16x32_bf16 v[36:39], v[104:107], v[160:163], v[36:39]
    ds_read_b128 v[100:103], v22 offset:2048
    v_mfma_f32_16x16x32_bf16 v[40:43], v[108:111], v[160:163], v[40:43]
    ds_read_b128 v[104:107], v22 offset:6144
    v_mfma_f32_16x16x32_bf16 v[44:47], v[112:115], v[160:163], v[44:47]
    ds_read_b128 v[108:111], v22 offset:10240
    s_waitcnt vmcnt(12) lgkmcnt(4)
    v_mfma_f32_16x16x32_bf16 v[28:31], v[116:119], v[164:167], v[28:31]
    buffer_load_dwordx4 v[196:199], v2, s[20:23], s31 offen offset:3072 sc1
    ds_read_b128 v[112:115], v22 offset:14336
    v_mfma_f32_16x16x32_bf16 v[32:35], v[120:123], v[164:167], v[32:35]
    ds_read_b128 v[116:119], v21 offset:64512
    v_mfma_f32_16x16x32_bf16 v[36:39], v[124:127], v[164:167], v[36:39]
    ds_read_b128 v[120:123], v22 offset:3072
    v_mfma_f32_16x16x32_bf16 v[40:43], v[128:131], v[164:167], v[40:43]
    ds_read_b128 v[124:127], v22 offset:7168
    v_mfma_f32_16x16x32_bf16 v[44:47], v[132:135], v[164:167], v[44:47]
    ds_read_b128 v[128:131], v22 offset:11264
    s_waitcnt vmcnt(12) lgkmcnt(4)
    v_mfma_f32_16x16x32_bf16 v[28:31], v[96:99], v[168:171], v[28:31]
    s_add_u32 s31, s36, 28672
    buffer_load_dwordx4 v[200:203], v2, s[20:23], s31 offen offset:2048 sc1
    ds_read_b128 v[132:135], v22 offset:15360
    v_mfma_f32_16x16x32_bf16 v[32:35], v[100:103], v[168:171], v[32:35]
    ds_read_b128 v[96:99], v22 offset:18432
    v_mfma_f32_16x16x32_bf16 v[36:39], v[104:107], v[168:171], v[36:39]
    ds_read_b128 v[100:103], v22 offset:22528
    v_mfma_f32_16x16x32_bf16 v[40:43], v[108:111], v[168:171], v[40:43]
    ds_read_b128 v[104:107], v22 offset:26624
    v_mfma_f32_16x16x32_bf16 v[44:47], v[112:115], v[168:171], v[44:47]
    ds_read_b128 v[108:111], v22 offset:30720
    s_waitcnt vmcnt(12) lgkmcnt(4)
    v_mfma_f32_16x16x32_bf16 v[28:31], v[116:119], v[172:175], v[28:31]
    buffer_load_dwordx4 v[204:207], v2, s[20:23], s31 offen offset:3072 sc1
    ds_read_b128 v[112:115], v22 offset:34816
    v_mfma_f32_16x16x32_bf16 v[32:35], v[120:123], v[172:175], v[32:35]
    ds_read_b128 v[116:119], v22 offset:19456
    v_mfma_f32_16x16x32_bf16 v[36:39], v[124:127], v[172:175], v[36:39]
    ds_read_b128 v[120:123], v22 offset:23552
    v_mfma_f32_16x16x32_bf16 v[40:43], v[128:131], v[172:175], v[40:43]
    ds_read_b128 v[124:127], v22 offset:27648
    v_mfma_f32_16x16x32_bf16 v[44:47], v[132:135], v[172:175], v[44:47]
    ds_read_b128 v[128:131], v22 offset:31744
    s_waitcnt vmcnt(12) lgkmcnt(4)
    v_mfma_f32_16x16x32_bf16 v[28:31], v[96:99], v[176:179], v[28:31]
    s_add_u32 s31, s36, 32768
    buffer_load_dwordx4 v[208:211], v2, s[20:23], s31 offen offset:2048 sc1
    ds_read_b128 v[132:135], v22 offset:35840
    s_barrier
    s_add_u32 m0, s33, 61440
    s_add_u32 s30, s32, 26447872
    buffer_load_dwordx4 v2, s[20:23], s30 offen offset:0 sc1 lds
    buffer_load_dwordx4 v2, s[20:23], s30 offen offset:1024 sc1 lds
    buffer_load_dwordx4 v2, s[20:23], s30 offen offset:2048 sc1 lds
    buffer_load_dwordx4 v2, s[20:23], s30 offen offset:3072 sc1 lds
    s_add_u32 m0, s33, 65536
    s_add_u32 s30, s32, 26451968
    buffer_load_dwordx4 v2, s[20:23], s30 offen offset:0 sc1 lds
    v_mfma_f32_16x16x32_bf16 v[32:35], v[100:103], v[176:179], v[32:35]
    ds_read_b128 v[96:99], v22 offset:38912
    v_mfma_f32_16x16x32_bf16 v[36:39], v[104:107], v[176:179], v[36:39]
    ds_read_b128 v[100:103], v22 offset:43008
    v_mfma_f32_16x16x32_bf16 v[40:43], v[108:111], v[176:179], v[40:43]
    ds_read_b128 v[104:107], v22 offset:47104
    v_mfma_f32_16x16x32_bf16 v[44:47], v[112:115], v[176:179], v[44:47]
    ds_read_b128 v[108:111], v22 offset:51200
    s_waitcnt vmcnt(17) lgkmcnt(4)
    v_mfma_f32_16x16x32_bf16 v[28:31], v[116:119], v[180:183], v[28:31]
    buffer_load_dwordx4 v[212:215], v2, s[20:23], s31 offen offset:3072 sc1
    ds_read_b128 v[112:115], v22 offset:55296
    v_mfma_f32_16x16x32_bf16 v[32:35], v[120:123], v[180:183], v[32:35]
    ds_read_b128 v[116:119], v22 offset:39936
    v_mfma_f32_16x16x32_bf16 v[36:39], v[124:127], v[180:183], v[36:39]
    ds_read_b128 v[120:123], v22 offset:44032
    v_mfma_f32_16x16x32_bf16 v[40:43], v[128:131], v[180:183], v[40:43]
    ds_read_b128 v[124:127], v22 offset:48128
    v_mfma_f32_16x16x32_bf16 v[44:47], v[132:135], v[180:183], v[44:47]
    ds_read_b128 v[128:131], v22 offset:52224
    s_waitcnt vmcnt(17) lgkmcnt(4)
    v_mfma_f32_16x16x32_bf16 v[28:31], v[96:99], v[184:187], v[28:31]
    s_add_u32 s31, s36, 36864
    buffer_load_dwordx4 v[216:219], v2, s[20:23], s31 offen offset:2048 sc1
    ds_read_b128 v[132:135], v22 offset:56320
    v_mfma_f32_16x16x32_bf16 v[32:35], v[100:103], v[184:187], v[32:35]
    ds_read_b128 v[96:99], v22 offset:59392
    v_mfma_f32_16x16x32_bf16 v[36:39], v[104:107], v[184:187], v[36:39]
    ds_read_b128 v[100:103], v22 offset:63488
    v_mfma_f32_16x16x32_bf16 v[40:43], v[108:111], v[184:187], v[40:43]
    ds_read_b128 v[104:107], v23 offset:2048
    v_mfma_f32_16x16x32_bf16 v[44:47], v[112:115], v[184:187], v[44:47]
    ds_read_b128 v[108:111], v23 offset:6144
    s_waitcnt vmcnt(17) lgkmcnt(4)
    v_mfma_f32_16x16x32_bf16 v[28:31], v[116:119], v[188:191], v[28:31]
    buffer_load_dwordx4 v[220:223], v2, s[20:23], s31 offen offset:3072 sc1
    ds_read_b128 v[112:115], v23 offset:10240
    v_mfma_f32_16x16x32_bf16 v[32:35], v[120:123], v[188:191], v[32:35]
    ds_read_b128 v[116:119], v22 offset:60416
    v_mfma_f32_16x16x32_bf16 v[36:39], v[124:127], v[188:191], v[36:39]
    ds_read_b128 v[120:123], v22 offset:64512
    v_mfma_f32_16x16x32_bf16 v[40:43], v[128:131], v[188:191], v[40:43]
    ds_read_b128 v[124:127], v23 offset:3072
    v_mfma_f32_16x16x32_bf16 v[44:47], v[132:135], v[188:191], v[44:47]
    ds_read_b128 v[128:131], v23 offset:7168
    s_waitcnt vmcnt(17) lgkmcnt(4)
    v_mfma_f32_16x16x32_bf16 v[28:31], v[96:99], v[192:195], v[28:31]
    s_add_u32 s31, s36, 40960
    buffer_load_dwordx4 v[224:227], v2, s[20:23], s31 offen offset:2048 sc1
    ds_read_b128 v[132:135], v23 offset:11264
    s_waitcnt vmcnt(13)
    s_barrier
    s_add_u32 m0, s33, 81920
    s_add_u32 s30, s32, 26468352
    buffer_load_dwordx4 v2, s[20:23], s30 offen offset:0 sc1 lds
    buffer_load_dwordx4 v2, s[20:23], s30 offen offset:1024 sc1 lds
    buffer_load_dwordx4 v2, s[20:23], s30 offen offset:2048 sc1 lds
    buffer_load_dwordx4 v2, s[20:23], s30 offen offset:3072 sc1 lds
    s_add_u32 m0, s33, 86016
    s_add_u32 s30, s32, 26472448
    buffer_load_dwordx4 v2, s[20:23], s30 offen offset:0 sc1 lds
    v_mfma_f32_16x16x32_bf16 v[32:35], v[100:103], v[192:195], v[32:35]
    ds_read_b128 v[96:99], v21 offset:22528
    v_mfma_f32_16x16x32_bf16 v[36:39], v[104:107], v[192:195], v[36:39]
    ds_read_b128 v[100:103], v21 offset:26624
    v_mfma_f32_16x16x32_bf16 v[40:43], v[108:111], v[192:195], v[40:43]
    ds_read_b128 v[104:107], v21 offset:30720
    v_mfma_f32_16x16x32_bf16 v[44:47], v[112:115], v[192:195], v[44:47]
    ds_read_b128 v[108:111], v21 offset:34816
    s_waitcnt vmcnt(17) lgkmcnt(4)
    v_mfma_f32_16x16x32_bf16 v[28:31], v[116:119], v[196:199], v[28:31]
    buffer_load_dwordx4 v[228:231], v2, s[20:23], s31 offen offset:3072 sc1
    ds_read_b128 v[112:115], v21 offset:38912
    v_mfma_f32_16x16x32_bf16 v[32:35], v[120:123], v[196:199], v[32:35]
    ds_read_b128 v[116:119], v21 offset:23552
    v_mfma_f32_16x16x32_bf16 v[36:39], v[124:127], v[196:199], v[36:39]
    ds_read_b128 v[120:123], v21 offset:27648
    v_mfma_f32_16x16x32_bf16 v[40:43], v[128:131], v[196:199], v[40:43]
    ds_read_b128 v[124:127], v21 offset:31744
    v_mfma_f32_16x16x32_bf16 v[44:47], v[132:135], v[196:199], v[44:47]
    ds_read_b128 v[128:131], v21 offset:35840
    s_waitcnt vmcnt(17) lgkmcnt(4)
    v_mfma_f32_16x16x32_bf16 v[28:31], v[96:99], v[200:203], v[28:31]
    s_add_u32 s31, s36, 45056
    buffer_load_dwordx4 v[232:235], v2, s[20:23], s31 offen offset:2048 sc1
    ds_read_b128 v[132:135], v21 offset:39936
    v_mfma_f32_16x16x32_bf16 v[32:35], v[100:103], v[200:203], v[32:35]
    ds_read_b128 v[96:99], v21 offset:43008
    v_mfma_f32_16x16x32_bf16 v[36:39], v[104:107], v[200:203], v[36:39]
    ds_read_b128 v[100:103], v21 offset:47104
    v_mfma_f32_16x16x32_bf16 v[40:43], v[108:111], v[200:203], v[40:43]
    ds_read_b128 v[104:107], v21 offset:51200
    v_mfma_f32_16x16x32_bf16 v[44:47], v[112:115], v[200:203], v[44:47]
    ds_read_b128 v[108:111], v21 offset:55296
    s_waitcnt vmcnt(17) lgkmcnt(4)
    v_mfma_f32_16x16x32_bf16 v[28:31], v[116:119], v[204:207], v[28:31]
    buffer_load_dwordx4 v[236:239], v2, s[20:23], s31 offen offset:3072 sc1
    ds_read_b128 v[112:115], v21 offset:59392
    v_mfma_f32_16x16x32_bf16 v[32:35], v[120:123], v[204:207], v[32:35]
    ds_read_b128 v[116:119], v21 offset:44032
    v_mfma_f32_16x16x32_bf16 v[36:39], v[124:127], v[204:207], v[36:39]
    ds_read_b128 v[120:123], v21 offset:48128
    v_mfma_f32_16x16x32_bf16 v[40:43], v[128:131], v[204:207], v[40:43]
    ds_read_b128 v[124:127], v21 offset:52224
    v_mfma_f32_16x16x32_bf16 v[44:47], v[132:135], v[204:207], v[44:47]
    ds_read_b128 v[128:131], v21 offset:56320
    s_waitcnt vmcnt(17) lgkmcnt(4)
    v_mfma_f32_16x16x32_bf16 v[28:31], v[96:99], v[208:211], v[28:31]
    ds_read_b128 v[132:135], v21 offset:60416
    s_waitcnt vmcnt(12)
    s_barrier
    v_mfma_f32_16x16x32_bf16 v[32:35], v[100:103], v[208:211], v[32:35]
    ds_read_b128 v[96:99], v21 offset:2048
    v_mfma_f32_16x16x32_bf16 v[36:39], v[104:107], v[208:211], v[36:39]
    ds_read_b128 v[100:103], v21 offset:6144
    v_mfma_f32_16x16x32_bf16 v[40:43], v[108:111], v[208:211], v[40:43]
    ds_read_b128 v[104:107], v21 offset:10240
    v_mfma_f32_16x16x32_bf16 v[44:47], v[112:115], v[208:211], v[44:47]
    ds_read_b128 v[108:111], v21 offset:14336
    s_waitcnt vmcnt(11) lgkmcnt(4)
    v_mfma_f32_16x16x32_bf16 v[28:31], v[116:119], v[212:215], v[28:31]
    ds_read_b128 v[112:115], v21 offset:18432
    v_mfma_f32_16x16x32_bf16 v[32:35], v[120:123], v[212:215], v[32:35]
    ds_read_b128 v[116:119], v21 offset:3072
    v_mfma_f32_16x16x32_bf16 v[36:39], v[124:127], v[212:215], v[36:39]
    ds_read_b128 v[120:123], v21 offset:7168
    v_mfma_f32_16x16x32_bf16 v[40:43], v[128:131], v[212:215], v[40:43]
    ds_read_b128 v[124:127], v21 offset:11264
    v_mfma_f32_16x16x32_bf16 v[44:47], v[132:135], v[212:215], v[44:47]
    ds_read_b128 v[128:131], v21 offset:15360
    s_waitcnt vmcnt(10) lgkmcnt(4)
    v_mfma_f32_16x16x32_bf16 v[28:31], v[96:99], v[216:219], v[28:31]
    ds_read_b128 v[132:135], v21 offset:19456
    v_mfma_f32_16x16x32_bf16 v[32:35], v[100:103], v[216:219], v[32:35]
    ds_read_b128 v[96:99], v21 offset:63488
    v_mfma_f32_16x16x32_bf16 v[36:39], v[104:107], v[216:219], v[36:39]
    ds_read_b128 v[100:103], v22 offset:2048
    v_mfma_f32_16x16x32_bf16 v[40:43], v[108:111], v[216:219], v[40:43]
    ds_read_b128 v[104:107], v22 offset:6144
    v_mfma_f32_16x16x32_bf16 v[44:47], v[112:115], v[216:219], v[44:47]
    ds_read_b128 v[108:111], v22 offset:10240
    s_waitcnt vmcnt(9) lgkmcnt(4)
    v_mfma_f32_16x16x32_bf16 v[28:31], v[116:119], v[220:223], v[28:31]
    ds_read_b128 v[112:115], v22 offset:14336
    v_mfma_f32_16x16x32_bf16 v[32:35], v[120:123], v[220:223], v[32:35]
    ds_read_b128 v[116:119], v21 offset:64512
    v_mfma_f32_16x16x32_bf16 v[36:39], v[124:127], v[220:223], v[36:39]
    ds_read_b128 v[120:123], v22 offset:3072
    v_mfma_f32_16x16x32_bf16 v[40:43], v[128:131], v[220:223], v[40:43]
    ds_read_b128 v[124:127], v22 offset:7168
    v_mfma_f32_16x16x32_bf16 v[44:47], v[132:135], v[220:223], v[44:47]
    ds_read_b128 v[128:131], v22 offset:11264
    s_waitcnt vmcnt(8) lgkmcnt(4)
    v_mfma_f32_16x16x32_bf16 v[28:31], v[96:99], v[224:227], v[28:31]
    ds_read_b128 v[132:135], v22 offset:15360
    s_waitcnt vmcnt(3)
    s_barrier
    v_mfma_f32_16x16x32_bf16 v[32:35], v[100:103], v[224:227], v[32:35]
    ds_read_b128 v[96:99], v22 offset:18432
    v_mfma_f32_16x16x32_bf16 v[36:39], v[104:107], v[224:227], v[36:39]
    ds_read_b128 v[100:103], v22 offset:22528
    v_mfma_f32_16x16x32_bf16 v[40:43], v[108:111], v[224:227], v[40:43]
    ds_read_b128 v[104:107], v22 offset:26624
    v_mfma_f32_16x16x32_bf16 v[44:47], v[112:115], v[224:227], v[44:47]
    ds_read_b128 v[108:111], v22 offset:30720
    s_waitcnt vmcnt(2) lgkmcnt(4)
    v_mfma_f32_16x16x32_bf16 v[28:31], v[116:119], v[228:231], v[28:31]
    ds_read_b128 v[112:115], v22 offset:34816
    v_mfma_f32_16x16x32_bf16 v[32:35], v[120:123], v[228:231], v[32:35]
    ds_read_b128 v[116:119], v22 offset:19456
    v_mfma_f32_16x16x32_bf16 v[36:39], v[124:127], v[228:231], v[36:39]
    ds_read_b128 v[120:123], v22 offset:23552
    v_mfma_f32_16x16x32_bf16 v[40:43], v[128:131], v[228:231], v[40:43]
    ds_read_b128 v[124:127], v22 offset:27648
    v_mfma_f32_16x16x32_bf16 v[44:47], v[132:135], v[228:231], v[44:47]
    ds_read_b128 v[128:131], v22 offset:31744
    s_waitcnt vmcnt(1) lgkmcnt(4)
    v_mfma_f32_16x16x32_bf16 v[28:31], v[96:99], v[232:235], v[28:31]
    ds_read_b128 v[132:135], v22 offset:35840
    v_mfma_f32_16x16x32_bf16 v[32:35], v[100:103], v[232:235], v[32:35]
    v_mfma_f32_16x16x32_bf16 v[36:39], v[104:107], v[232:235], v[36:39]
    v_mfma_f32_16x16x32_bf16 v[40:43], v[108:111], v[232:235], v[40:43]
    v_mfma_f32_16x16x32_bf16 v[44:47], v[112:115], v[232:235], v[44:47]
    s_waitcnt vmcnt(0) lgkmcnt(0)
    v_mfma_f32_16x16x32_bf16 v[28:31], v[116:119], v[236:239], v[28:31]
    v_mfma_f32_16x16x32_bf16 v[32:35], v[120:123], v[236:239], v[32:35]
    v_mfma_f32_16x16x32_bf16 v[36:39], v[124:127], v[236:239], v[36:39]
    v_mfma_f32_16x16x32_bf16 v[40:43], v[128:131], v[236:239], v[40:43]
    v_mfma_f32_16x16x32_bf16 v[44:47], v[132:135], v[236:239], v[44:47]
    s_add_u32 s30, s33, 102400
    v_add_u32 v9, s30, v2
    s_nop 5
    ds_write_b128 v9, v[28:31] offset:0
    ds_write_b128 v9, v[32:35] offset:1024
    ds_write_b128 v9, v[36:39] offset:2048
    ds_write_b128 v9, v[40:43] offset:3072
    ds_write_b128 v9, v[44:47] offset:4096
    s_waitcnt lgkmcnt(0)
    s_barrier
L_m_end:
    s_endpgm
L_m_pub_u1_0_s:
    buffer_store_dwordx4 v[64:67], v2, s[20:23], s42 offen sc1
    s_branch L_m_pub_u1_0_d
L_m_pub_u1_1_s:
    buffer_store_dwordx4 v[64:67], v2, s[20:23], s42 offen sc1
    s_branch L_m_pub_u1_1_d
L_m_pub_u1_2_s:
    buffer_store_dwordx4 v[64:67], v2, s[20:23], s42 offen sc1
    s_branch L_m_pub_u1_2_d
L_m_pub_u1_3_s:
    buffer_store_dwordx4 v[64:67], v2, s[20:23], s42 offen sc1
    s_branch L_m_pub_u1_3_d
L_m_Hredo:
    s_barrier
    s_branch L_m_H0
L_m_last:
    s_endpgm

.section .rodata,"a"
.p2align 6
.amdhsa_kernel sequential_preLN__softmax_full_mha__mixer_s_mlp__prompt_kernel
  .amdhsa_next_free_vgpr 256
  .amdhsa_next_free_sgpr 70
  .amdhsa_accum_offset 256
  .amdhsa_group_segment_fixed_size 0
  .amdhsa_kernarg_size 88
  .amdhsa_user_sgpr_count 2
  .amdhsa_user_sgpr_kernarg_segment_ptr 1
  .amdhsa_system_sgpr_workgroup_id_x 1
.end_amdhsa_kernel
```
